```python
import torch

def _softmax(x, axis=-1):
    return torch.softmax(x, dim=axis)
def _gelu(x):
    return torch.nn.functional.gelu(x, approximate="tanh")
def _silu(x):
    return torch.nn.functional.silu(x)
def _sigmoid(x):
    return torch.sigmoid(x)
def _layernorm(x, axis=-1, eps=1e-5):
    m = x.mean(dim=axis, keepdim=True)
    v = x.var(dim=axis, keepdim=True, unbiased=False)
    return (x - m) / torch.sqrt(v + eps)
def _scatter_add(tgt, idx, src, axis=0):
    return tgt.clone().index_add_(axis, idx, src)
def _segment_sum(src, seg, n):
    out = torch.zeros((n,) + src.shape[1:], dtype=src.dtype)
    return out.index_add_(0, seg, src)
def _pad(x, pw):
    flat = tuple(v for pair in reversed(pw) for v in pair)
    return torch.nn.functional.pad(x, flat)

kernel_name = 'recurrent_scan__ssm_conv_s4__moe_arch_mod__prompt'

def setup_inputs():

    _w = (lambda a: (lambda t: t.to(torch.bfloat16) if t.is_floating_point() else t)(torch.as_tensor(a)))
    def _A_setup():
        B, L, D, N = 1, 2048, 576, 128
        A_re = -(lambda _x: torch.exp(torch.as_tensor(_x)))((lambda *s: torch.randn(*s, dtype=torch.bfloat16) * 6.4)(D, N))
        A_im = torch.pi * (lambda *s: torch.randn(*s, dtype=torch.bfloat16) * 0.05)(D, N)
        B_re = (lambda *s: torch.randn(*s, dtype=torch.bfloat16) * 0.1)(D, N)
        B_im = (lambda *s: torch.randn(*s, dtype=torch.bfloat16) * 0.1)(D, N)
        C_re = (lambda *s: torch.randn(*s, dtype=torch.bfloat16) * 0.1)(D, N)
        C_im = (lambda *s: torch.randn(*s, dtype=torch.bfloat16) * 0.1)(D, N)
        log_dt = (lambda *s: torch.randn(*s, dtype=torch.bfloat16) * 0.05)(D) * 0.5 - 4.0
        Dskip = (lambda *s: torch.randn(*s, dtype=torch.bfloat16) * 0.05)(D)
        return {
            "u": _w((lambda *s: torch.randn(*s, dtype=torch.bfloat16) * 0.05)(B, L, D)),
            "A_re": _w(A_re),
            "A_im": _w(A_im),
            "B_re": _w(B_re),
            "B_im": _w(B_im),
            "C_re": _w(C_re),
            "C_im": _w(C_im),
            "log_dt": _w(log_dt),
            "Dskip": _w(Dskip),
        }
    _A_in = _A_setup()

    def _B_setup():
        B, S, D, F, C = 1, 2048, 576, 4608, 8
        return {
            "x": _w((lambda *s: torch.randn(*s, dtype=torch.bfloat16) * 0.05)(B, S, D)),
            "w_r": _w((lambda *s: torch.randn(*s, dtype=torch.bfloat16) * 0.05)(D)),
            "w_gate": _w((lambda *s: torch.randn(*s, dtype=torch.bfloat16) * 0.05)(D, F)),
            "w_up": _w((lambda *s: torch.randn(*s, dtype=torch.bfloat16) * 0.05)(D, F)),
            "w_down": _w((lambda *s: torch.randn(*s, dtype=torch.bfloat16) * 0.05)(F, D)),
        }
    _B_in = _B_setup()

    return {
        "A_u": _A_in["u"],
        "A_A_re": _A_in["A_re"],
        "A_A_im": _A_in["A_im"],
        "A_B_re": _A_in["B_re"],
        "A_B_im": _A_in["B_im"],
        "A_C_re": _A_in["C_re"],
        "A_C_im": _A_in["C_im"],
        "A_log_dt": _A_in["log_dt"],
        "A_Dskip": _A_in["Dskip"],
        "B_x": _B_in["x"],
        "B_w_r": _B_in["w_r"],
        "B_w_gate": _B_in["w_gate"],
        "B_w_up": _B_in["w_up"],
        "B_w_down": _B_in["w_down"],
    }

def reference(A_u, A_A_re, A_A_im, A_B_re, A_B_im, A_C_re, A_C_im, A_log_dt, A_Dskip, B_x, B_w_r, B_w_gate, B_w_up, B_w_down):
    def _A_ref(u, A_re, A_im, B_re, B_im, C_re, C_im, log_dt, Dskip):
        Bsz, L, D = u.shape
        dt = torch.exp(log_dt)[:, None]
        A = A_re + 1j * A_im
        Bc = B_re + 1j * B_im
        Cc = C_re + 1j * C_im
        logdA = dt * A
        dB = dt * Bc
        l = (lambda x, dt: x.to(dt))(torch.arange(L), A_re.dtype)
        P = torch.exp(logdA[:, :, None] * l[None, None, :])
        K = torch.einsum("dn,dnl,dn->dl", Cc, P, dB).real
        L2 = 2 * L
        Kp = _pad(K, ((0, 0), (0, L)))
        up = (lambda x, *d: x.permute(*d))(u, 0, 2, 1)
        up = _pad(up, ((0, 0), (0, 0), (0, L)))
        Kf = (lambda x, axes=(-2,-1): torch.fft.rfft2(x.float(), dim=axes))(Kp[:, None, :], axes=(-2, -1))
        Uf = (lambda x, axes=(-2,-1): torch.fft.rfft2(x.float(), dim=axes))(up[:, :, None, :], axes=(-2, -1))
        Yf = Uf * Kf[None, :, :, :]
        y = (lambda x, s, axes=(-2,-1): torch.fft.irfft2(x, s=s, dim=axes).to(torch.bfloat16))(Yf, (1, L2), axes=(-2, -1))[:, :, 0, :L]
        y = (lambda x, *d: x.permute(*d))(y, 0, 2, 1) + u * Dskip[None, None, :]
        return y

    def _B_ref(x, w_r, w_gate, w_up, w_down):
        B, S, D = x.shape
        C = 8
        r = x @ w_r
        idx = torch.argsort(-r, axis=-1)[:, :C]
        idx_e = (lambda x, n, axis: torch.repeat_interleave(x, n, dim=axis))(idx.reshape(B, C, 1), D, axis=2)
        x_sel = (lambda x, i, axis: torch.take_along_dim(x, i, dim=axis))(x, idx_e, axis=1)
        g = _silu(x_sel @ w_gate)
        u = x_sel @ w_up
        y = (g * u) @ w_down
        r_sel = _sigmoid((lambda x, i, axis: torch.take_along_dim(x, i, dim=axis))(r, idx, axis=1))
        y = y * r_sel.reshape(B, C, 1)
        b_off = (torch.arange(B) * S).reshape(B, 1)
        flat_idx = (idx + b_off).reshape(B * C)
        zero = (x * 0.0).reshape(B * S, D)
        upd = _scatter_add(zero, flat_idx, y.reshape(B * C, D), axis=0)
        return x + upd.reshape(B, S, D)

    x = A_u
    xn = _layernorm(x, axis=-1)
    s = _A_ref(xn, A_A_re, A_A_im, A_B_re, A_B_im, A_C_re, A_C_im, A_log_dt, A_Dskip)
    g = _silu(_B_ref(xn, B_w_r, B_w_gate, B_w_up, B_w_down))
    return x + s * g
```

```asm
; @launch grid=(256,1,1) block=(512,1,1) lds=149440
.amdgcn_target "amdgcn-amd-amdhsa--gfx950"
.text
.globl recurrent_scan__ssm_conv_s4__moe_arch_mod__prompt_kernel
.p2align 8
.type recurrent_scan__ssm_conv_s4__moe_arch_mod__prompt_kernel,@function
recurrent_scan__ssm_conv_s4__moe_arch_mod__prompt_kernel:
    s_load_dwordx16 s[4:19], s[0:1], 0
    s_load_dwordx16 s[20:35], s[0:1], 64
    s_load_dwordx2 s[36:37], s[0:1], 128
    v_lshrrev_b32 v2, 6, v0
    s_lshr_b32 s40, s2, 3
    v_readfirstlane_b32 s38, v2
    v_and_b32 v1, 63, v0
    s_and_b32 s39, s2, 7
    s_cmp_ge_u32 s2, 256
    s_cbranch_scc1 L_exit0
    s_cmp_lt_u32 s39, 2
    s_cselect_b32 s43, 24, 16
    s_sub_u32 s63, s40, s43
    s_lshl4_add_u32 s62, s39, s40
    s_lshl3_add_u32 s43, s39, s40
    s_add_u32 s43, s43, 112
    s_cmp_lt_u32 s40, 16
    s_cselect_b32 s62, s62, s43
    s_cmp_lt_u32 s38, 4
    s_cbranch_scc1 L_lo
    s_andn2_b32 s42, s2, 15
    s_lshl1_add_u32 s42, s39, s42
    s_and_b32 s43, s40, 1
    s_add_u32 s42, s42, s43
    s_lshl_b32 s42, s42, 3
    v_lshrrev_b32 v3, 5, v0
    v_add3_u32 v3, s42, v3, -8
    v_mul_u32_u24 v4, 1152, v3
    v_and_b32 v5, 31, v1
    v_lshlrev_b32 v8, 4, v5
    v_lshlrev_b32 v9, 2, v5
    v_add_u32 v6, v8, v4
    v_add_u32 v4, v9, v4
    s_waitcnt lgkmcnt(0)
    global_load_dwordx4 v[72:75], v6, s[4:5]
    global_load_dwordx4 v[76:79], v6, s[4:5] offset:512
    global_load_dword v80, v4, s[4:5] offset:1024
    global_load_dwordx4 v[84:87], v8, s[24:25]
    global_load_dwordx4 v[88:91], v8, s[24:25] offset:512
    global_load_dword v92, v9, s[24:25] offset:1024
    s_load_dword s41, s[36:37], 0
    s_branch L_ln2
L_exit0:
    s_endpgm
L_lo:
    s_cmp_ge_i32 s63, 0
    s_cbranch_scc1 L_roles
L_conv:
    s_getpc_b64 s[42:43]
    s_and_b32 s44, s40, 15
    s_lshl2_add_u32 s44, s44, s38
    s_mul_i32 s44, s44, 5
    v_add_u32 v4, s44, v1
    v_min_u32 v4, (L_codeend-L_conv-256)/128, v4
    v_lshlrev_b32 v4, 7, v4
    v_mov_b32 v5, 0
    v_lshl_add_u64 v[4:5], v[4:5], 0, s[42:43]
    s_mov_b64 exec, 31
    global_load_dword v255, v[4:5], off offset:128
    s_mov_b64 exec, -1
    s_lshl_b32 s63, s62, 3
    s_lshl_b32 s43, s62, 8
    v_add_lshl_u32 v2, v0, s43, 2
    v_mov_b32 v6, 0
    v_mov_b32 v4, 147328
    ds_write_b32 v4, v6 offset:4
    s_waitcnt lgkmcnt(0)
    s_load_dwordx2 s[44:45], s[18:19], s63
    global_load_dword v140, v2, s[6:7]
    global_load_dword v141, v2, s[8:9]
    global_load_dword v142, v2, s[10:11]
    global_load_dword v143, v2, s[12:13]
    global_load_dword v144, v2, s[14:15]
    global_load_dword v145, v2, s[16:17]
    s_barrier
    s_branch L_low
L_roles:
    s_waitcnt lgkmcnt(0)
    s_load_dword s41, s[36:37], 0
    s_mov_b32 s64, 1
    s_waitcnt lgkmcnt(0)
    s_mul_i32 s41, s41, 1664525
    s_add_u32 s41, s41, 1013904223
    s_branch L_roles2
L_ln2:
    s_cmp_lt_i32 s63, 0
    s_cbranch_scc1 L_ln3
    s_cmp_eq_u32 s38, 7
    s_cbranch_scc1 L_lnx
    s_branch L_ln4
L_ln3:
    s_barrier
L_ln4:
    s_setprio 3
    v_mov_b32 v46, 0x3f803f80
    v_lshlrev_b32 v3, 3, v3
    v_add_u32 v3, 4088, v3
    s_mov_b32 s64, 0
    s_waitcnt lgkmcnt(0)
    s_mul_i32 s41, s41, 1664525
    s_add_u32 s41, s41, 1013904223
    v_mov_b32 v59, s41
    s_lshr_b32 s52, s41, 4
    s_xor_b32 s52, s52, s41
    s_and_b32 s52, s52, 15
    s_cselect_b32 s52, 0, 16
    s_xor_b32 s52, s52, s41
    s_bfe_u32 s48, s52, 0x40000
    s_mul_i32 s48, s48, 0x08002000
    s_and_b32 s48, s48, 0x60006000
    s_bfe_u32 s49, s52, 0x40004
    s_mul_i32 s49, s49, 0x08002000
    s_and_b32 s49, s49, 0x60006000
    s_bfe_u32 s50, s52, 0x40008
    s_mul_i32 s50, s50, 0x08002000
    s_and_b32 s50, s50, 0x60006000
    s_bfe_u32 s51, s52, 0x4000c
    s_mul_i32 s51, s51, 0x08002000
    s_and_b32 s51, s51, 0x60006000
    s_waitcnt vmcnt(5)
    v_dot2_f32_bf16 v48, v72, v46, 0
    v_dot2_f32_bf16 v49, v72, v72, 0
    v_dot2_f32_bf16 v48, v73, v46, v48
    v_dot2_f32_bf16 v49, v73, v73, v49
    v_dot2_f32_bf16 v48, v74, v46, v48
    v_dot2_f32_bf16 v49, v74, v74, v49
    v_dot2_f32_bf16 v48, v75, v46, v48
    v_dot2_f32_bf16 v49, v75, v75, v49
    s_waitcnt vmcnt(4)
    v_dot2_f32_bf16 v48, v76, v46, v48
    v_dot2_f32_bf16 v49, v76, v76, v49
    v_dot2_f32_bf16 v48, v77, v46, v48
    v_dot2_f32_bf16 v49, v77, v77, v49
    v_dot2_f32_bf16 v48, v78, v46, v48
    v_dot2_f32_bf16 v49, v78, v78, v49
    v_dot2_f32_bf16 v48, v79, v46, v48
    v_dot2_f32_bf16 v49, v79, v79, v49
    s_waitcnt vmcnt(3)
    v_dot2_f32_bf16 v48, v80, v46, v48
    v_dot2_f32_bf16 v49, v80, v80, v49
    s_waitcnt vmcnt(2)
    v_dot2_f32_bf16 v51, v84, v46, 0
    v_dot2_f32_bf16 v50, v72, v84, 0
    v_dot2_f32_bf16 v51, v85, v46, v51
    v_dot2_f32_bf16 v50, v73, v85, v50
    v_dot2_f32_bf16 v51, v86, v46, v51
    v_dot2_f32_bf16 v50, v74, v86, v50
    v_dot2_f32_bf16 v51, v87, v46, v51
    v_dot2_f32_bf16 v50, v75, v87, v50
    s_waitcnt vmcnt(1)
    v_dot2_f32_bf16 v51, v88, v46, v51
    v_dot2_f32_bf16 v50, v76, v88, v50
    v_dot2_f32_bf16 v51, v89, v46, v51
    v_dot2_f32_bf16 v50, v77, v89, v50
    v_dot2_f32_bf16 v51, v90, v46, v51
    v_dot2_f32_bf16 v50, v78, v90, v50
    v_dot2_f32_bf16 v51, v91, v46, v51
    v_dot2_f32_bf16 v50, v79, v91, v50
    s_waitcnt vmcnt(0)
    v_dot2_f32_bf16 v51, v92, v46, v51
    v_dot2_f32_bf16 v50, v80, v92, v50
    v_add_f32_dpp v48, v48, v48 row_ror:8 row_mask:0xf bank_mask:0xf
    v_add_f32_dpp v49, v49, v49 row_ror:8 row_mask:0xf bank_mask:0xf
    v_add_f32_dpp v51, v51, v51 row_ror:8 row_mask:0xf bank_mask:0xf
    v_add_f32_dpp v50, v50, v50 row_ror:8 row_mask:0xf bank_mask:0xf
    v_add_f32_dpp v48, v48, v48 row_ror:4 row_mask:0xf bank_mask:0xf
    v_add_f32_dpp v49, v49, v49 row_ror:4 row_mask:0xf bank_mask:0xf
    v_add_f32_dpp v51, v51, v51 row_ror:4 row_mask:0xf bank_mask:0xf
    v_add_f32_dpp v50, v50, v50 row_ror:4 row_mask:0xf bank_mask:0xf
    v_add_f32_dpp v48, v48, v48 row_ror:2 row_mask:0xf bank_mask:0xf
    v_add_f32_dpp v49, v49, v49 row_ror:2 row_mask:0xf bank_mask:0xf
    v_add_f32_dpp v51, v51, v51 row_ror:2 row_mask:0xf bank_mask:0xf
    v_add_f32_dpp v50, v50, v50 row_ror:2 row_mask:0xf bank_mask:0xf
    v_add_f32_dpp v48, v48, v48 row_ror:1 row_mask:0xf bank_mask:0xf
    v_add_f32_dpp v49, v49, v49 row_ror:1 row_mask:0xf bank_mask:0xf
    v_add_f32_dpp v51, v51, v51 row_ror:1 row_mask:0xf bank_mask:0xf
    v_add_f32_dpp v50, v50, v50 row_ror:1 row_mask:0xf bank_mask:0xf
    v_add_f32_dpp v48, v48, v48 row_bcast:15 row_mask:0xa bank_mask:0xf
    v_add_f32_dpp v49, v49, v49 row_bcast:15 row_mask:0xa bank_mask:0xf
    v_add_f32_dpp v51, v51, v51 row_bcast:15 row_mask:0xa bank_mask:0xf
    v_add_f32_dpp v50, v50, v50 row_bcast:15 row_mask:0xa bank_mask:0xf
    v_mul_f32 v48, 0x3ae38e39, v48
    v_mul_f32 v49, 0x3ae38e39, v49
    v_fma_f32 v49, -v48, v48, v49
    v_max_f32 v49, 0, v49
    v_cvt_pk_bf16_f32 v52, v48, v49
    v_lshlrev_b32 v54, 16, v52
    v_and_b32 v52, 4294901760, v52
    v_add_f32 v52, 0x3727c5ac, v52
    v_cvt_pk_bf16_f32 v52, v52, v52
    v_and_b32 v52, 4294901760, v52
    v_sqrt_f32 v52, v52
    v_fma_f32 v50, -v54, v51, v50
    v_cvt_pk_bf16_f32 v56, v48, v52
    v_and_b32 v53, 4294901760, v56
    v_rcp_f32 v53, v53
    v_mov_b32 v57, v56
    v_mul_f32 v50, v50, v53
    v_cvt_pk_bf16_f32 v55, v50, v50
    v_ashrrev_i32 v61, 31, v55
    v_or_b32 v61, 0x80008000, v61
    v_xor_b32 v60, v55, v61
    v_xor_b32 v55, v55, v61
    v_permlane32_swap_b32 v56, v57
    s_mov_b32 s43, 0x07060100
    v_permlane32_swap_b32 v55, v60
    s_mov_b32 exec_lo, 0
    s_mov_b32 exec_hi, 0x10000
    v_perm_b32 v58, v60, v55, s43
    global_store_dwordx4 v3, v[56:59], s[36:37] sc1
    s_mov_b64 exec, -1
    s_setprio 0
    s_cmp_lt_i32 s63, 0
    s_cbranch_scc1 L_helper
    s_barrier
L_roles2:
    s_mov_b32 s60, 0x10001a0a
    s_mov_b32 s61, 0x3e342a20
    s_lshl_b32 s59, s39, 3
    s_lshr_b64 s[60:61], s[60:61], s59
    s_and_b32 s60, s60, 0xff
    s_lshl_b32 s59, s39, 2
    s_lshr_b32 s61, 0xaaaaaa66, s59
    s_and_b32 s61, s61, 15
    s_movk_i32 s59, 10923
    s_cmp_eq_u32 s61, 10
    s_cselect_b32 s59, 6554, s59
    s_cmp_ge_u32 s63, s61
    s_cbranch_scc1 L_pref
    s_add_u32 s42, s60, s63
    s_cmp_ge_u32 s38, 4
    s_cbranch_scc1 L_dn
    s_lshl_b32 s43, s42, 7
    s_mul_i32 s44, s38, 1327104
    s_add_u32 s43, s43, s44
    v_lshrrev_b32 v2, 5, v1
    v_mul_u32_u24 v2, 331776, v2
    v_bfe_u32 v3, v1, 4, 1
    v_mul_u32_u24 v6, 313344, v3
    v_add_u32 v6, v6, v2
    v_mul_u32_u24 v3, 18432, v3
    v_add3_u32 v2, v2, v3, s43
    v_and_b32 v3, 7, v1
    v_lshl_add_u32 v2, v3, 4, v2
    v_mov_b32 v3, 0
    v_bfe_i32 v4, v1, 3, 1
    v_add_u32 v6, 147456, v6
    v_mov_b32 v7, 0
    s_mov_b32 s48, 9216
    s_mov_b32 s49, 0
    s_mov_b32 s50, 156672
    s_mov_b32 s51, 0
    s_mov_b32 s52, 488448
    s_mov_b32 s53, 0
    s_mov_b32 s54, 4294165504
    s_mov_b32 s55, -1
    s_sub_u32 s46, s28, s26
    s_subb_u32 s47, s29, s27
    v_lshl_add_u64 v[2:3], v[2:3], 0, s[26:27]
    v_and_b32 v5, s47, v4
    v_and_b32 v4, s46, v4
    v_lshl_add_u64 v[2:3], v[2:3], 0, v[4:5]
    v_lshl_add_u64 v[4:5], v[2:3], 0, v[6:7]
    global_load_dwordx4 v[72:75], v[2:3], off nt
    v_lshl_add_u64 v[2:3], v[2:3], 0, s[48:49]
    global_load_dwordx4 v[76:79], v[2:3], off nt
    v_lshl_add_u64 v[2:3], v[2:3], 0, s[50:51]
    global_load_dwordx4 v[80:83], v[2:3], off nt
    v_lshl_add_u64 v[2:3], v[2:3], 0, s[48:49]
    global_load_dwordx4 v[84:87], v[2:3], off nt
    v_lshl_add_u64 v[2:3], v[2:3], 0, s[52:53]
    global_load_dwordx4 v[104:107], v[2:3], off nt
    v_lshl_add_u64 v[2:3], v[2:3], 0, s[48:49]
    s_barrier
    global_load_dwordx4 v[108:111], v[2:3], off nt
    v_lshl_add_u64 v[2:3], v[2:3], 0, s[50:51]
    global_load_dwordx4 v[112:115], v[2:3], off nt
    v_lshl_add_u64 v[2:3], v[2:3], 0, s[48:49]
    global_load_dwordx4 v[116:119], v[2:3], off nt
    v_lshl_add_u64 v[2:3], v[2:3], 0, s[54:55]
    global_load_dwordx4 v[88:91], v[2:3], off nt
    v_lshl_add_u64 v[2:3], v[2:3], 0, s[48:49]
    global_load_dwordx4 v[92:95], v[2:3], off nt
    v_lshl_add_u64 v[2:3], v[2:3], 0, s[50:51]
    global_load_dwordx4 v[96:99], v[2:3], off nt
    v_lshl_add_u64 v[2:3], v[2:3], 0, s[48:49]
    global_load_dwordx4 v[100:103], v[2:3], off nt
    v_lshl_add_u64 v[2:3], v[2:3], 0, s[52:53]
    global_load_dwordx4 v[120:123], v[2:3], off nt
    v_lshl_add_u64 v[2:3], v[2:3], 0, s[48:49]
    global_load_dwordx4 v[124:127], v[2:3], off nt
    v_lshl_add_u64 v[2:3], v[2:3], 0, s[50:51]
    global_load_dwordx4 v[128:131], v[2:3], off nt
    v_lshl_add_u64 v[2:3], v[2:3], 0, s[48:49]
    global_load_dwordx4 v[132:135], v[2:3], off nt
    v_lshl_add_u64 v[2:3], v[2:3], 0, s[54:55]
    global_load_dwordx4 v[136:139], v[2:3], off nt
    v_lshl_add_u64 v[2:3], v[2:3], 0, s[48:49]
    global_load_dwordx4 v[140:143], v[2:3], off nt
    v_lshl_add_u64 v[2:3], v[2:3], 0, s[50:51]
    global_load_dwordx4 v[144:147], v[2:3], off nt
    v_lshl_add_u64 v[2:3], v[2:3], 0, s[48:49]
    global_load_dwordx4 v[148:151], v[2:3], off nt
    v_lshl_add_u64 v[2:3], v[2:3], 0, s[52:53]
    global_load_dwordx4 v[168:171], v[2:3], off nt
    v_lshl_add_u64 v[2:3], v[2:3], 0, s[48:49]
    global_load_dwordx4 v[172:175], v[2:3], off nt
    v_lshl_add_u64 v[2:3], v[2:3], 0, s[50:51]
    global_load_dwordx4 v[176:179], v[2:3], off nt
    v_lshl_add_u64 v[2:3], v[2:3], 0, s[48:49]
    global_load_dwordx4 v[180:183], v[2:3], off nt
    v_lshl_add_u64 v[2:3], v[2:3], 0, s[54:55]
    s_barrier
    global_load_dwordx4 v[152:155], v[2:3], off nt
    v_lshl_add_u64 v[2:3], v[2:3], 0, s[48:49]
    global_load_dwordx4 v[156:159], v[2:3], off nt
    v_lshl_add_u64 v[2:3], v[2:3], 0, s[50:51]
    global_load_dwordx4 v[160:163], v[2:3], off nt
    v_lshl_add_u64 v[2:3], v[2:3], 0, s[48:49]
    global_load_dwordx4 v[164:167], v[2:3], off nt
    v_lshl_add_u64 v[2:3], v[2:3], 0, s[52:53]
    global_load_dwordx4 v[184:187], v[2:3], off nt
    v_lshl_add_u64 v[2:3], v[2:3], 0, s[48:49]
    global_load_dwordx4 v[188:191], v[2:3], off nt
    v_lshl_add_u64 v[2:3], v[2:3], 0, s[50:51]
    global_load_dwordx4 v[192:195], v[2:3], off nt
    v_lshl_add_u64 v[2:3], v[2:3], 0, s[48:49]
    global_load_dwordx4 v[196:199], v[2:3], off nt
    global_load_dwordx4 v[200:203], v[4:5], off nt
    v_lshl_add_u64 v[4:5], v[4:5], 0, s[48:49]
    global_load_dwordx4 v[204:207], v[4:5], off nt
    v_lshl_add_u64 v[4:5], v[4:5], 0, s[50:51]
    global_load_dwordx4 v[208:211], v[4:5], off nt
    v_lshl_add_u64 v[4:5], v[4:5], 0, s[48:49]
    global_load_dwordx4 v[212:215], v[4:5], off nt
    s_barrier
    v_lshrrev_b32 v252, 4, v1
    v_and_b32 v248, 15, v1
    v_lshlrev_b32 v248, 3, v248
    v_lshl_add_u32 v248, v252, 8, v248
    s_lshl_b32 s44, s38, 10
    v_add_u32 v248, s44, v248
    v_add_u32 v249, 128, v248
    s_and_b32 s44, s38, 1
    s_lshl_b32 s44, s44, 8
    s_and_b32 s45, s38, 2
    s_add_u32 s44, s44, s45
    v_lshl_add_u32 v250, v252, 6, s44
    v_bfe_u32 v252, v1, 3, 1
    v_lshl_add_u32 v250, v252, 9, v250
    v_and_b32 v252, 4, v1
    v_add_u32 v250, v250, v252
    v_and_b32 v252, 1, v1
    v_lshl_add_u32 v250, v252, 3, v250
    v_bfe_u32 v252, v1, 1, 1
    v_lshl_add_u32 v250, v252, 5, v250
    s_mov_b32 s58, 0x6f800000
    v_mul_u32_u24 v251, 0xaaaa, v252
    v_add_u32 v251, 0x4444, v251
    s_mov_b32 s46, 0x05040100
    s_mov_b32 s47, 0x07060302
    s_mul_i32 s44, s38, 3072
    s_lshl_b32 s45, s39, 14
    s_add_u32 s45, s45, 65536
    s_mov_b32 s59, 0
    s_add_u32 s44, s44, 65536
    s_add_u32 s44, s44, s59
    v_lshl_add_u32 v6, v1, 4, s44
    s_lshl_b32 s44, s38, 12
    v_lshl_add_u32 v7, v1, 4, s44
    v_bfe_i32 v253, v1, 1, 1
    v_not_b32 v252, v253
    s_mul_i32 s44, s42, 16
    s_lshl_b32 s45, s38, 15
    s_add_u32 s44, s44, s45
    s_add_u32 s44, s44, 262144
    s_cmp_eq_u32 s42, 11
    s_cselect_b32 s45, 0, 0x20000
    s_add_u32 s44, s44, s45
    v_mov_b32 v230, s44
    v_mov_b32 v231, s41
    s_waitcnt vmcnt(34)
    v_perm_b32 v8, v76, v72, s46
    v_perm_b32 v16, v76, v72, s47
    v_perm_b32 v24, v77, v73, s46
    v_perm_b32 v32, v77, v73, s47
    v_perm_b32 v40, v78, v74, s46
    v_perm_b32 v48, v78, v74, s47
    v_perm_b32 v56, v79, v75, s46
    v_perm_b32 v64, v79, v75, s47
    s_waitcnt vmcnt(32)
    v_perm_b32 v9, v84, v80, s46
    v_perm_b32 v17, v84, v80, s47
    v_perm_b32 v25, v85, v81, s46
    v_perm_b32 v33, v85, v81, s47
    v_perm_b32 v41, v86, v82, s46
    v_perm_b32 v49, v86, v82, s47
    v_perm_b32 v57, v87, v83, s46
    v_perm_b32 v65, v87, v83, s47
    s_waitcnt vmcnt(30)
    v_perm_b32 v12, v108, v104, s46
    v_perm_b32 v20, v108, v104, s47
    v_perm_b32 v28, v109, v105, s46
    v_perm_b32 v36, v109, v105, s47
    v_perm_b32 v44, v110, v106, s46
    v_perm_b32 v52, v110, v106, s47
    v_perm_b32 v60, v111, v107, s46
    v_perm_b32 v68, v111, v107, s47
    s_waitcnt vmcnt(28)
    v_perm_b32 v13, v116, v112, s46
    v_perm_b32 v21, v116, v112, s47
    v_perm_b32 v29, v117, v113, s46
    v_perm_b32 v37, v117, v113, s47
    v_perm_b32 v45, v118, v114, s46
    v_perm_b32 v53, v118, v114, s47
    v_perm_b32 v61, v119, v115, s46
    v_perm_b32 v69, v119, v115, s47
    s_waitcnt vmcnt(26)
    v_perm_b32 v10, v92, v88, s46
    v_perm_b32 v18, v92, v88, s47
    v_perm_b32 v26, v93, v89, s46
    v_perm_b32 v34, v93, v89, s47
    v_perm_b32 v42, v94, v90, s46
    v_perm_b32 v50, v94, v90, s47
    v_perm_b32 v58, v95, v91, s46
    v_perm_b32 v66, v95, v91, s47
    s_waitcnt vmcnt(24)
    v_perm_b32 v11, v100, v96, s46
    v_perm_b32 v19, v100, v96, s47
    v_perm_b32 v27, v101, v97, s46
    v_perm_b32 v35, v101, v97, s47
    v_perm_b32 v43, v102, v98, s46
    v_perm_b32 v51, v102, v98, s47
    v_perm_b32 v59, v103, v99, s46
    v_perm_b32 v67, v103, v99, s47
    s_waitcnt vmcnt(22)
    v_perm_b32 v14, v124, v120, s46
    v_perm_b32 v22, v124, v120, s47
    v_perm_b32 v30, v125, v121, s46
    v_perm_b32 v38, v125, v121, s47
    v_perm_b32 v46, v126, v122, s46
    v_perm_b32 v54, v126, v122, s47
    v_perm_b32 v62, v127, v123, s46
    v_perm_b32 v70, v127, v123, s47
    s_waitcnt vmcnt(20)
    v_perm_b32 v15, v132, v128, s46
    v_perm_b32 v23, v132, v128, s47
    v_perm_b32 v31, v133, v129, s46
    v_perm_b32 v39, v133, v129, s47
    v_perm_b32 v47, v134, v130, s46
    v_perm_b32 v55, v134, v130, s47
    v_perm_b32 v63, v135, v131, s46
    v_perm_b32 v71, v135, v131, s47
    s_waitcnt vmcnt(18)
    v_perm_b32 v72, v140, v136, s46
    v_perm_b32 v80, v140, v136, s47
    v_perm_b32 v88, v141, v137, s46
    v_perm_b32 v96, v141, v137, s47
    v_perm_b32 v104, v142, v138, s46
    v_perm_b32 v112, v142, v138, s47
    v_perm_b32 v120, v143, v139, s46
    v_perm_b32 v128, v143, v139, s47
    s_waitcnt vmcnt(16)
    v_perm_b32 v73, v148, v144, s46
    v_perm_b32 v81, v148, v144, s47
    v_perm_b32 v89, v149, v145, s46
    v_perm_b32 v97, v149, v145, s47
    v_perm_b32 v105, v150, v146, s46
    v_perm_b32 v113, v150, v146, s47
    v_perm_b32 v121, v151, v147, s46
    v_perm_b32 v129, v151, v147, s47
    s_waitcnt vmcnt(14)
    v_perm_b32 v76, v172, v168, s46
    v_perm_b32 v84, v172, v168, s47
    v_perm_b32 v92, v173, v169, s46
    v_perm_b32 v100, v173, v169, s47
    v_perm_b32 v108, v174, v170, s46
    v_perm_b32 v116, v174, v170, s47
    v_perm_b32 v124, v175, v171, s46
    v_perm_b32 v132, v175, v171, s47
    s_waitcnt vmcnt(12)
    v_perm_b32 v77, v180, v176, s46
    v_perm_b32 v85, v180, v176, s47
    v_perm_b32 v93, v181, v177, s46
    v_perm_b32 v101, v181, v177, s47
    v_perm_b32 v109, v182, v178, s46
    v_perm_b32 v117, v182, v178, s47
    v_perm_b32 v125, v183, v179, s46
    v_perm_b32 v133, v183, v179, s47
    s_waitcnt vmcnt(10)
    s_setprio 3
    global_load_dwordx4 v[216:219], v6, s[36:37] offset:0 sc1
    global_load_dwordx4 v[220:223], v6, s[36:37] offset:1024 sc1
    global_load_dwordx4 v[224:227], v6, s[36:37] offset:2048 sc1
    s_barrier
    v_perm_b32 v74, v156, v152, s46
    v_perm_b32 v82, v156, v152, s47
    v_perm_b32 v90, v157, v153, s46
    v_perm_b32 v98, v157, v153, s47
    v_perm_b32 v106, v158, v154, s46
    v_perm_b32 v114, v158, v154, s47
    v_perm_b32 v122, v159, v155, s46
    v_perm_b32 v130, v159, v155, s47
    s_waitcnt vmcnt(11)
    v_perm_b32 v75, v164, v160, s46
    v_perm_b32 v83, v164, v160, s47
    v_perm_b32 v91, v165, v161, s46
    v_perm_b32 v99, v165, v161, s47
    v_perm_b32 v107, v166, v162, s46
    v_perm_b32 v115, v166, v162, s47
    v_perm_b32 v123, v167, v163, s46
    v_perm_b32 v131, v167, v163, s47
    s_waitcnt vmcnt(9)
    v_perm_b32 v78, v188, v184, s46
    v_perm_b32 v86, v188, v184, s47
    v_perm_b32 v94, v189, v185, s46
    v_perm_b32 v102, v189, v185, s47
    v_perm_b32 v110, v190, v186, s46
    v_perm_b32 v118, v190, v186, s47
    v_perm_b32 v126, v191, v187, s46
    v_perm_b32 v134, v191, v187, s47
    s_waitcnt vmcnt(7)
    v_perm_b32 v79, v196, v192, s46
    v_perm_b32 v87, v196, v192, s47
    v_perm_b32 v95, v197, v193, s46
    v_perm_b32 v103, v197, v193, s47
    v_perm_b32 v111, v198, v194, s46
    v_perm_b32 v119, v198, v194, s47
    v_perm_b32 v127, v199, v195, s46
    v_perm_b32 v135, v199, v195, s47
    s_waitcnt vmcnt(5)
    v_perm_b32 v136, v204, v200, s46
    v_perm_b32 v138, v204, v200, s47
    v_perm_b32 v140, v205, v201, s46
    v_perm_b32 v142, v205, v201, s47
    v_perm_b32 v144, v206, v202, s46
    v_perm_b32 v146, v206, v202, s47
    v_perm_b32 v148, v207, v203, s46
    v_perm_b32 v150, v207, v203, s47
    s_waitcnt vmcnt(3)
    v_perm_b32 v137, v212, v208, s46
    v_perm_b32 v139, v212, v208, s47
    v_perm_b32 v141, v213, v209, s46
    v_perm_b32 v143, v213, v209, s47
    v_perm_b32 v145, v214, v210, s46
    v_perm_b32 v147, v214, v210, s47
    v_perm_b32 v149, v215, v211, s46
    v_perm_b32 v151, v215, v211, s47
    s_mov_b32 s48, 0
    s_waitcnt vmcnt(0)
    v_and_b32 v228, v252, v226
    v_and_b32 v229, v253, v226
    v_cmp_ne_u32 s[50:51], s41, v219
    v_cmp_ne_u32 s[52:53], s41, v223
    v_cmp_ne_u32 vcc, s41, v227
L_pollM_done:
    v_mfma_f32_16x16x16_bf16 v[152:155], v[228:229], v[136:137], 0
    s_or_b64 s[50:51], s[50:51], s[52:53]
    s_or_b64 vcc, vcc, s[50:51]
    s_cbranch_vccnz L_pollM
    s_lshl2_add_u32 s44, s42, s38
    s_cmp_lg_u32 s44, 44
    s_cbranch_scc1 L_nofl
    s_mov_b64 exec, 1
    global_store_dword v230, v231, s[36:37] sc1
    s_mov_b64 exec, -1
L_nofl:
    v_swap_b32 v217, v218
    v_mfma_f32_16x16x16_bf16 v[156:159], v[228:229], v[138:139], 0
    v_mov_b32 v219, v220
    v_mfma_f32_16x16x16_bf16 v[160:163], v[228:229], v[140:141], 0
    v_mov_b32 v220, v221
    v_mfma_f32_16x16x16_bf16 v[164:167], v[228:229], v[142:143], 0
    v_mov_b32 v221, v224
    v_mfma_f32_16x16x16_bf16 v[168:171], v[228:229], v[144:145], 0
    v_mov_b32 v223, v225
    v_mfma_f32_16x16x16_bf16 v[172:175], v[228:229], v[146:147], 0
    v_mfma_f32_16x16x16_bf16 v[176:179], v[228:229], v[148:149], 0
    v_mfma_f32_16x16x16_bf16 v[180:183], v[228:229], v[150:151], 0
    v_smfmac_f32_16x16x64_bf16 v[152:155], v[216:219], v[8:15], v251
    v_smfmac_f32_16x16x64_bf16 v[152:155], v[220:223], v[72:79], v251
    v_smfmac_f32_16x16x64_bf16 v[156:159], v[216:219], v[16:23], v251
    v_smfmac_f32_16x16x64_bf16 v[156:159], v[220:223], v[80:87], v251
    v_smfmac_f32_16x16x64_bf16 v[160:163], v[216:219], v[24:31], v251
    v_smfmac_f32_16x16x64_bf16 v[160:163], v[220:223], v[88:95], v251
    v_smfmac_f32_16x16x64_bf16 v[164:167], v[216:219], v[32:39], v251
    v_smfmac_f32_16x16x64_bf16 v[164:167], v[220:223], v[96:103], v251
    s_nop 1
    v_add_f32 v184, v152, v154
    v_add_f32 v185, v153, v155
    v_smfmac_f32_16x16x64_bf16 v[168:171], v[216:219], v[40:47], v251
    v_smfmac_f32_16x16x64_bf16 v[168:171], v[220:223], v[104:111], v251
    v_add_f32 v186, v156, v158
    v_add_f32 v187, v157, v159
    ds_write_b128 v7, v[184:187] offset:0
    v_smfmac_f32_16x16x64_bf16 v[172:175], v[216:219], v[48:55], v251
    v_smfmac_f32_16x16x64_bf16 v[172:175], v[220:223], v[112:119], v251
    v_add_f32 v188, v160, v162
    v_add_f32 v189, v161, v163
    v_smfmac_f32_16x16x64_bf16 v[176:179], v[216:219], v[56:63], v251
    v_smfmac_f32_16x16x64_bf16 v[176:179], v[220:223], v[120:127], v251
    v_add_f32 v190, v164, v166
    v_add_f32 v191, v165, v167
    ds_write_b128 v7, v[188:191] offset:1024
    v_smfmac_f32_16x16x64_bf16 v[180:183], v[216:219], v[64:71], v251
    v_smfmac_f32_16x16x64_bf16 v[180:183], v[220:223], v[128:135], v251
    v_add_f32 v192, v168, v170
    v_add_f32 v193, v169, v171
    v_add_f32 v194, v172, v174
    v_add_f32 v195, v173, v175
    ds_write_b128 v7, v[192:195] offset:2048
    v_add_f32 v196, v176, v178
    v_add_f32 v197, v177, v179
    s_nop 0
    v_add_f32 v198, v180, v182
    v_add_f32 v199, v181, v183
    ds_write_b128 v7, v[196:199] offset:3072
    s_waitcnt lgkmcnt(0)
    s_barrier
    ds_read2st64_b64 v[104:107], v248 offset0:0 offset1:8
    ds_read2st64_b64 v[108:111], v248 offset0:16 offset1:24
    ds_read2st64_b64 v[112:115], v249 offset0:0 offset1:8
    ds_read2st64_b64 v[116:119], v249 offset0:16 offset1:24
    s_waitcnt lgkmcnt(2)
    v_pk_add_f32 v[104:105], v[104:105], v[106:107]
    v_pk_add_f32 v[108:109], v[108:109], v[110:111]
    v_pk_add_f32 v[104:105], v[104:105], v[108:109]
    v_mul_f32 v106, 3216550459, v104
    v_mul_f32 v107, 3216550459, v105
    v_exp_f32 v106, v106
    v_exp_f32 v107, v107
    s_waitcnt lgkmcnt(0)
    v_pk_add_f32 v[112:113], v[112:113], v[114:115]
    v_fma_f32 v106, v106, s58, s58
    v_fma_f32 v107, v107, s58, s58
    v_rcp_f32 v106, v106
    v_rcp_f32 v107, v107
    v_pk_add_f32 v[116:117], v[116:117], v[118:119]
    v_pk_add_f32 v[112:113], v[112:113], v[116:117]
    v_pk_mul_f32 v[104:105], v[104:105], v[106:107]
    v_pk_mul_f32 v[104:105], v[104:105], v[112:113]
    v_cvt_pk_bf16_f32 v104, v104, v105
    ds_write_b16 v250, v104 offset:16384
    ds_write_b16_d16_hi v250, v104 offset:16400
    s_waitcnt lgkmcnt(0)
    s_barrier
    s_endpgm
L_pollM:
    v_mov_b32 v228, 77836
    s_mov_b64 exec, 1
L_pollMh:
    global_load_dword v229, v228, s[36:37] sc1
    s_add_u32 s48, s48, 1
    s_cmp_ge_u32 s48, 65536
    s_cbranch_scc1 L_pollMx
    s_waitcnt vmcnt(0)
    v_cmp_ne_u32 vcc, s41, v229
    s_cbranch_vccnz L_pollMh
L_pollMx:
    s_mov_b64 exec, -1
    s_waitcnt vmcnt(0)
    global_load_dwordx4 v[216:219], v6, s[36:37] offset:0 sc1
    global_load_dwordx4 v[220:223], v6, s[36:37] offset:1024 sc1
    global_load_dwordx4 v[224:227], v6, s[36:37] offset:2048 sc1
    s_add_u32 s48, s48, 1
    s_waitcnt vmcnt(0)
    v_and_b32 v228, v252, v226
    v_and_b32 v229, v253, v226
    v_cmp_ne_u32 s[50:51], s41, v219
    v_cmp_ne_u32 s[52:53], s41, v223
    v_cmp_ne_u32 vcc, s41, v227
    s_or_b64 s[50:51], s[50:51], s[52:53]
    s_or_b64 vcc, vcc, s[50:51]
    s_cbranch_vccz L_pollM_done
    s_cmp_lt_u32 s48, 65536
    s_cbranch_scc1 L_pollM
    s_mov_b64 s[50:51], 0
    s_mov_b64 s[52:53], 0
    s_mov_b64 vcc, 0
    s_branch L_pollM_done
L_lnx:
    s_mov_b32 s60, 0x10001a0a
    s_mov_b32 s61, 0x3e342a20
    s_lshl_b32 s59, s39, 3
    s_lshr_b64 s[60:61], s[60:61], s59
    s_and_b32 s60, s60, 0xff
    s_lshl_b32 s59, s39, 2
    s_lshr_b32 s61, 0xaaaaaa66, s59
    s_and_b32 s61, s61, 15
    s_movk_i32 s59, 10923
    s_cmp_eq_u32 s61, 10
    s_cselect_b32 s59, 6554, s59
    s_cmp_ge_u32 s63, s61
    s_cbranch_scc1 L_ln4
    s_add_u32 s42, s60, s63
    s_mul_i32 s45, s42, 73728
    v_lshrrev_b32 v4, 4, v1
    v_mul_u32_u24 v4, 1152, v4
    v_and_b32 v5, 15, v1
    v_lshl_add_u32 v4, v5, 3, v4
    v_add_u32 v4, s45, v4
    global_load_dwordx2 v[168:169], v4, s[30:31] offset:1024
    v_add_u32 v4, 4608, v4
    global_load_dwordx2 v[170:171], v4, s[30:31] offset:1024
    v_add_u32 v4, 4608, v4
    global_load_dwordx2 v[172:173], v4, s[30:31] offset:1024
    v_add_u32 v4, 4608, v4
    global_load_dwordx2 v[174:175], v4, s[30:31] offset:1024
    v_add_u32 v4, 4608, v4
    global_load_dwordx2 v[176:177], v4, s[30:31] offset:1024
    v_add_u32 v4, 4608, v4
    global_load_dwordx2 v[178:179], v4, s[30:31] offset:1024
    v_add_u32 v4, 4608, v4
    global_load_dwordx2 v[180:181], v4, s[30:31] offset:1024
    v_add_u32 v4, 4608, v4
    global_load_dwordx2 v[182:183], v4, s[30:31] offset:1024
    v_add_u32 v4, 4608, v4
    global_load_dwordx2 v[184:185], v4, s[30:31] offset:1024
    v_add_u32 v4, 4608, v4
    global_load_dwordx2 v[186:187], v4, s[30:31] offset:1024
    v_add_u32 v4, 4608, v4
    global_load_dwordx2 v[188:189], v4, s[30:31] offset:1024
    v_add_u32 v4, 4608, v4
    global_load_dwordx2 v[190:191], v4, s[30:31] offset:1024
    v_add_u32 v4, 4608, v4
    global_load_dwordx2 v[192:193], v4, s[30:31] offset:1024
    v_add_u32 v4, 4608, v4
    global_load_dwordx2 v[194:195], v4, s[30:31] offset:1024
    v_add_u32 v4, 4608, v4
    global_load_dwordx2 v[196:197], v4, s[30:31] offset:1024
    v_add_u32 v4, 4608, v4
    global_load_dwordx2 v[198:199], v4, s[30:31] offset:1024
    s_setprio 3
    v_mov_b32 v46, 0x3f803f80
    v_lshlrev_b32 v3, 3, v3
    v_add_u32 v3, 4088, v3
    s_mov_b32 s64, 0
    s_waitcnt lgkmcnt(0)
    s_mul_i32 s41, s41, 1664525
    s_add_u32 s41, s41, 1013904223
    v_mov_b32 v59, s41
    s_lshr_b32 s52, s41, 4
    s_xor_b32 s52, s52, s41
    s_and_b32 s52, s52, 15
    s_cselect_b32 s52, 0, 16
    s_xor_b32 s52, s52, s41
    s_bfe_u32 s48, s52, 0x40000
    s_mul_i32 s48, s48, 0x08002000
    s_and_b32 s48, s48, 0x60006000
    s_bfe_u32 s49, s52, 0x40004
    s_mul_i32 s49, s49, 0x08002000
    s_and_b32 s49, s49, 0x60006000
    s_bfe_u32 s50, s52, 0x40008
    s_mul_i32 s50, s50, 0x08002000
    s_and_b32 s50, s50, 0x60006000
    s_bfe_u32 s51, s52, 0x4000c
    s_mul_i32 s51, s51, 0x08002000
    s_and_b32 s51, s51, 0x60006000
    s_waitcnt vmcnt(21)
    v_dot2_f32_bf16 v48, v72, v46, 0
    v_dot2_f32_bf16 v49, v72, v72, 0
    v_dot2_f32_bf16 v48, v73, v46, v48
    v_dot2_f32_bf16 v49, v73, v73, v49
    v_dot2_f32_bf16 v48, v74, v46, v48
    v_dot2_f32_bf16 v49, v74, v74, v49
    v_dot2_f32_bf16 v48, v75, v46, v48
    v_dot2_f32_bf16 v49, v75, v75, v49
    s_waitcnt vmcnt(20)
    v_dot2_f32_bf16 v48, v76, v46, v48
    v_dot2_f32_bf16 v49, v76, v76, v49
    v_dot2_f32_bf16 v48, v77, v46, v48
    v_dot2_f32_bf16 v49, v77, v77, v49
    v_dot2_f32_bf16 v48, v78, v46, v48
    v_dot2_f32_bf16 v49, v78, v78, v49
    v_dot2_f32_bf16 v48, v79, v46, v48
    v_dot2_f32_bf16 v49, v79, v79, v49
    s_waitcnt vmcnt(19)
    v_dot2_f32_bf16 v48, v80, v46, v48
    v_dot2_f32_bf16 v49, v80, v80, v49
    s_waitcnt vmcnt(18)
    v_dot2_f32_bf16 v51, v84, v46, 0
    v_dot2_f32_bf16 v50, v72, v84, 0
    v_dot2_f32_bf16 v51, v85, v46, v51
    v_dot2_f32_bf16 v50, v73, v85, v50
    v_dot2_f32_bf16 v51, v86, v46, v51
    v_dot2_f32_bf16 v50, v74, v86, v50
    v_dot2_f32_bf16 v51, v87, v46, v51
    v_dot2_f32_bf16 v50, v75, v87, v50
    s_waitcnt vmcnt(17)
    v_dot2_f32_bf16 v51, v88, v46, v51
    v_dot2_f32_bf16 v50, v76, v88, v50
    v_dot2_f32_bf16 v51, v89, v46, v51
    v_dot2_f32_bf16 v50, v77, v89, v50
    v_dot2_f32_bf16 v51, v90, v46, v51
    v_dot2_f32_bf16 v50, v78, v90, v50
    v_dot2_f32_bf16 v51, v91, v46, v51
    v_dot2_f32_bf16 v50, v79, v91, v50
    s_waitcnt vmcnt(16)
    v_dot2_f32_bf16 v51, v92, v46, v51
    v_dot2_f32_bf16 v50, v80, v92, v50
    v_add_f32_dpp v48, v48, v48 row_ror:8 row_mask:0xf bank_mask:0xf
    v_add_f32_dpp v49, v49, v49 row_ror:8 row_mask:0xf bank_mask:0xf
    v_add_f32_dpp v51, v51, v51 row_ror:8 row_mask:0xf bank_mask:0xf
    v_add_f32_dpp v50, v50, v50 row_ror:8 row_mask:0xf bank_mask:0xf
    v_add_f32_dpp v48, v48, v48 row_ror:4 row_mask:0xf bank_mask:0xf
    v_add_f32_dpp v49, v49, v49 row_ror:4 row_mask:0xf bank_mask:0xf
    v_add_f32_dpp v51, v51, v51 row_ror:4 row_mask:0xf bank_mask:0xf
    v_add_f32_dpp v50, v50, v50 row_ror:4 row_mask:0xf bank_mask:0xf
    v_add_f32_dpp v48, v48, v48 row_ror:2 row_mask:0xf bank_mask:0xf
    v_add_f32_dpp v49, v49, v49 row_ror:2 row_mask:0xf bank_mask:0xf
    v_add_f32_dpp v51, v51, v51 row_ror:2 row_mask:0xf bank_mask:0xf
    v_add_f32_dpp v50, v50, v50 row_ror:2 row_mask:0xf bank_mask:0xf
    v_add_f32_dpp v48, v48, v48 row_ror:1 row_mask:0xf bank_mask:0xf
    v_add_f32_dpp v49, v49, v49 row_ror:1 row_mask:0xf bank_mask:0xf
    v_add_f32_dpp v51, v51, v51 row_ror:1 row_mask:0xf bank_mask:0xf
    v_add_f32_dpp v50, v50, v50 row_ror:1 row_mask:0xf bank_mask:0xf
    v_add_f32_dpp v48, v48, v48 row_bcast:15 row_mask:0xa bank_mask:0xf
    v_add_f32_dpp v49, v49, v49 row_bcast:15 row_mask:0xa bank_mask:0xf
    v_add_f32_dpp v51, v51, v51 row_bcast:15 row_mask:0xa bank_mask:0xf
    v_add_f32_dpp v50, v50, v50 row_bcast:15 row_mask:0xa bank_mask:0xf
    v_mul_f32 v48, 0x3ae38e39, v48
    v_mul_f32 v49, 0x3ae38e39, v49
    v_fma_f32 v49, -v48, v48, v49
    v_max_f32 v49, 0, v49
    v_cvt_pk_bf16_f32 v52, v48, v49
    v_lshlrev_b32 v54, 16, v52
    v_and_b32 v52, 4294901760, v52
    v_add_f32 v52, 0x3727c5ac, v52
    v_cvt_pk_bf16_f32 v52, v52, v52
    v_and_b32 v52, 4294901760, v52
    v_sqrt_f32 v52, v52
    v_fma_f32 v50, -v54, v51, v50
    v_cvt_pk_bf16_f32 v56, v48, v52
    v_and_b32 v53, 4294901760, v56
    v_rcp_f32 v53, v53
    v_mov_b32 v57, v56
    v_mul_f32 v50, v50, v53
    v_cvt_pk_bf16_f32 v55, v50, v50
    v_ashrrev_i32 v61, 31, v55
    v_or_b32 v61, 0x80008000, v61
    v_xor_b32 v60, v55, v61
    v_xor_b32 v55, v55, v61
    v_permlane32_swap_b32 v56, v57
    s_mov_b32 s43, 0x07060100
    v_permlane32_swap_b32 v55, v60
    s_mov_b32 exec_lo, 0
    s_mov_b32 exec_hi, 0x10000
    v_perm_b32 v58, v60, v55, s43
    global_store_dwordx4 v3, v[56:59], s[36:37] sc1
    s_mov_b64 exec, -1
    s_setprio 0
    s_barrier
    s_branch L_roles2
L_dn:
    s_sub_u32 s43, s38, 4
    s_mul_i32 s45, s42, 73728
    v_lshrrev_b32 v3, 4, v1
    v_mul_u32_u24 v2, 1152, v3
    v_and_b32 v5, 15, v1
    v_add_u32 v2, s45, v2
    v_lshl_add_u32 v4, v5, 3, v2
    v_lshl_add_u32 v2, v5, 4, v2
    s_lshl_b32 s44, s43, 8
    v_add_u32 v2, s44, v2
    s_lshl_b32 s45, s42, 7
    s_add_u32 s45, s45, 1048576
    v_lshl_add_u32 v3, v3, 4, s45
    v_and_b32 v6, 1, v1
    v_lshl_add_u32 v3, v6, 6, v3
    v_lshrrev_b32 v5, 1, v5
    v_mul_u32_u24 v5, 9216, v5
    v_add_u32 v7, v3, v5
    v_add_u32 v5, v7, v5
    s_mul_i32 s44, s43, 147456
    v_add_u32 v5, s44, v5
    v_add_u32 v6, 9216, v5
    v_add_u32 v7, 589824, v7
    v_lshlrev_b32 v253, 4, v1
    v_mov_b32 v254, 0x9fff9fff
    v_bfe_u32 v252, v1, 1, 1
    v_mul_u32_u24 v251, 0xaaaa, v252
    v_add_u32 v251, 0x4444, v251
    s_mov_b32 s46, 0x05040100
    s_mov_b32 s47, 0x07060302
    v_mov_b32 v200, 0
    v_mov_b32 v201, 0
    v_mov_b32 v202, 0
    v_mov_b32 v203, 0
    v_mov_b32 v204, 0
    v_mov_b32 v205, 0
    v_mov_b32 v206, 0
    v_mov_b32 v207, 0
    v_mov_b32 v208, 0
    v_mov_b32 v209, 0
    v_mov_b32 v210, 0
    v_mov_b32 v211, 0
    v_mov_b32 v212, 0
    v_mov_b32 v213, 0
    v_mov_b32 v214, 0
    v_mov_b32 v215, 0
    v_mov_b32 v216, 0
    v_mov_b32 v217, 0
    v_mov_b32 v218, 0
    v_mov_b32 v219, 0
    v_mov_b32 v220, 0
    v_mov_b32 v221, 0
    v_mov_b32 v222, 0
    v_mov_b32 v223, 0
    v_mov_b32 v224, 0
    v_mov_b32 v225, 0
    v_mov_b32 v226, 0
    v_mov_b32 v227, 0
    v_mov_b32 v228, 0
    v_mov_b32 v229, 0
    v_mov_b32 v230, 0
    v_mov_b32 v231, 0
    v_mov_b32 v232, 0
    v_mov_b32 v233, 0
    v_mov_b32 v234, 0
    v_mov_b32 v235, 0
    v_mov_b32 v236, 0
    v_mov_b32 v237, 0
    v_mov_b32 v238, 0
    v_mov_b32 v239, 0
    v_mov_b32 v240, 0
    v_mov_b32 v241, 0
    v_mov_b32 v242, 0
    v_mov_b32 v243, 0
    v_mov_b32 v244, 0
    v_mov_b32 v245, 0
    v_mov_b32 v246, 0
    v_mov_b32 v247, 0
    s_cmp_eq_u32 s38, 7
    s_cbranch_scc1 L_dnx
    s_barrier
    s_barrier
    global_load_dwordx4 v[104:107], v2, s[30:31] nt
    v_add_u32 v2, 4608, v2
    global_load_dwordx4 v[108:111], v2, s[30:31] nt
    v_add_u32 v2, 4608, v2
    global_load_dwordx4 v[112:115], v2, s[30:31] nt
    v_add_u32 v2, 4608, v2
    global_load_dwordx4 v[116:119], v2, s[30:31] nt
    v_add_u32 v2, 4608, v2
    s_barrier
    global_load_dwordx4 v[120:123], v2, s[30:31] nt
    v_add_u32 v2, 4608, v2
    global_load_dwordx4 v[124:127], v2, s[30:31] nt
    v_add_u32 v2, 4608, v2
    global_load_dwordx4 v[128:131], v2, s[30:31] nt
    v_add_u32 v2, 4608, v2
    global_load_dwordx4 v[132:135], v2, s[30:31] nt
    v_add_u32 v2, 4608, v2
    global_load_dwordx4 v[136:139], v2, s[30:31] nt
    v_add_u32 v2, 4608, v2
    global_load_dwordx4 v[140:143], v2, s[30:31] nt
    s_waitcnt vmcnt(8)
    v_perm_b32 v8, v108, v104, s46
    v_perm_b32 v16, v108, v104, s47
    v_perm_b32 v24, v109, v105, s46
    v_perm_b32 v32, v109, v105, s47
    v_perm_b32 v40, v110, v106, s46
    v_perm_b32 v48, v110, v106, s47
    v_perm_b32 v56, v111, v107, s46
    v_perm_b32 v64, v111, v107, s47
    v_add_u32 v2, 4608, v2
    global_load_dwordx4 v[144:147], v2, s[30:31] nt
    v_add_u32 v2, 4608, v2
    global_load_dwordx4 v[148:151], v2, s[30:31] nt
    s_waitcnt vmcnt(8)
    v_perm_b32 v9, v116, v112, s46
    v_perm_b32 v17, v116, v112, s47
    v_perm_b32 v25, v117, v113, s46
    v_perm_b32 v33, v117, v113, s47
    v_perm_b32 v41, v118, v114, s46
    v_perm_b32 v49, v118, v114, s47
    v_perm_b32 v57, v119, v115, s46
    v_perm_b32 v65, v119, v115, s47
    v_add_u32 v2, 4608, v2
    global_load_dwordx4 v[152:155], v2, s[30:31] nt
    v_add_u32 v2, 4608, v2
    global_load_dwordx4 v[156:159], v2, s[30:31] nt
    s_waitcnt vmcnt(8)
    v_perm_b32 v10, v124, v120, s46
    v_perm_b32 v18, v124, v120, s47
    v_perm_b32 v26, v125, v121, s46
    v_perm_b32 v34, v125, v121, s47
    v_perm_b32 v42, v126, v122, s46
    v_perm_b32 v50, v126, v122, s47
    v_perm_b32 v58, v127, v123, s46
    v_perm_b32 v66, v127, v123, s47
    v_add_u32 v2, 4608, v2
    global_load_dwordx4 v[160:163], v2, s[30:31] nt
    v_add_u32 v2, 4608, v2
    global_load_dwordx4 v[164:167], v2, s[30:31] nt
    s_waitcnt vmcnt(8)
    v_perm_b32 v11, v132, v128, s46
    v_perm_b32 v19, v132, v128, s47
    v_perm_b32 v27, v133, v129, s46
    v_perm_b32 v35, v133, v129, s47
    v_perm_b32 v43, v134, v130, s46
    v_perm_b32 v51, v134, v130, s47
    v_perm_b32 v59, v135, v131, s46
    v_perm_b32 v67, v135, v131, s47
    s_barrier
    s_waitcnt vmcnt(6)
    v_perm_b32 v12, v140, v136, s46
    v_perm_b32 v20, v140, v136, s47
    v_perm_b32 v28, v141, v137, s46
    v_perm_b32 v36, v141, v137, s47
    v_perm_b32 v44, v142, v138, s46
    v_perm_b32 v52, v142, v138, s47
    v_perm_b32 v60, v143, v139, s46
    v_perm_b32 v68, v143, v139, s47
    s_waitcnt vmcnt(4)
    v_perm_b32 v13, v148, v144, s46
    v_perm_b32 v21, v148, v144, s47
    v_perm_b32 v29, v149, v145, s46
    v_perm_b32 v37, v149, v145, s47
    v_perm_b32 v45, v150, v146, s46
    v_perm_b32 v53, v150, v146, s47
    v_perm_b32 v61, v151, v147, s46
    v_perm_b32 v69, v151, v147, s47
    s_waitcnt vmcnt(2)
    v_perm_b32 v14, v156, v152, s46
    v_perm_b32 v22, v156, v152, s47
    v_perm_b32 v30, v157, v153, s46
    v_perm_b32 v38, v157, v153, s47
    v_perm_b32 v46, v158, v154, s46
    v_perm_b32 v54, v158, v154, s47
    v_perm_b32 v62, v159, v155, s46
    v_perm_b32 v70, v159, v155, s47
    s_waitcnt vmcnt(0)
    v_perm_b32 v15, v164, v160, s46
    v_perm_b32 v23, v164, v160, s47
    v_perm_b32 v31, v165, v161, s46
    v_perm_b32 v39, v165, v161, s47
    v_perm_b32 v47, v166, v162, s46
    v_perm_b32 v55, v166, v162, s47
    v_perm_b32 v63, v167, v163, s46
    v_perm_b32 v71, v167, v163, s47
    s_barrier
    ds_read_b128 v[112:115], v253 offset:16384
    s_waitcnt lgkmcnt(0)
    v_smfmac_f32_16x16x64_bf16 v[200:203], v[112:115], v[8:15], v251
    s_nop 0
    s_nop 0
    v_smfmac_f32_16x16x64_bf16 v[204:207], v[112:115], v[16:23], v251
    s_nop 0
    s_nop 0
    v_smfmac_f32_16x16x64_bf16 v[208:211], v[112:115], v[24:31], v251
    s_nop 0
    s_nop 0
    v_smfmac_f32_16x16x64_bf16 v[212:215], v[112:115], v[32:39], v251
    v_add_f32 v200, v200, v202
    v_add_f32 v201, v201, v203
    v_smfmac_f32_16x16x64_bf16 v[216:219], v[112:115], v[40:47], v251
    v_cvt_pk_bf16_f32 v120, v200, v201
    v_and_or_b32 v120, v120, v254, s48
    v_smfmac_f32_16x16x64_bf16 v[220:223], v[112:115], v[48:55], v251
    v_add_f32 v204, v204, v206
    v_add_f32 v205, v205, v207
    v_smfmac_f32_16x16x64_bf16 v[224:227], v[112:115], v[56:63], v251
    v_cvt_pk_bf16_f32 v121, v204, v205
    v_and_or_b32 v121, v121, v254, s49
    v_smfmac_f32_16x16x64_bf16 v[228:231], v[112:115], v[64:71], v251
    v_add_f32 v208, v208, v210
    v_add_f32 v209, v209, v211
    v_cvt_pk_bf16_f32 v122, v208, v209
    v_and_or_b32 v122, v122, v254, s50
    v_add_f32 v212, v212, v214
    v_add_f32 v213, v213, v215
    v_cvt_pk_bf16_f32 v123, v212, v213
    v_and_or_b32 v123, v123, v254, s51
    global_store_dwordx4 v5, v[120:123], s[36:37] sc1
    v_pk_add_f32 v[216:217], v[216:217], v[218:219]
    v_cvt_pk_bf16_f32 v124, v216, v217
    v_and_or_b32 v124, v124, v254, s48
    v_pk_add_f32 v[220:221], v[220:221], v[222:223]
    v_cvt_pk_bf16_f32 v125, v220, v221
    v_and_or_b32 v125, v125, v254, s49
    v_pk_add_f32 v[224:225], v[224:225], v[226:227]
    v_cvt_pk_bf16_f32 v126, v224, v225
    v_and_or_b32 v126, v126, v254, s50
    v_pk_add_f32 v[228:229], v[228:229], v[230:231]
    v_cvt_pk_bf16_f32 v127, v228, v229
    v_and_or_b32 v127, v127, v254, s51
    global_store_dwordx4 v6, v[124:127], s[36:37] sc1
    s_endpgm
L_dnx:
    s_barrier
    s_waitcnt vmcnt(0)
    v_perm_b32 v72, v170, v168, s46
    v_perm_b32 v80, v170, v168, s47
    v_perm_b32 v88, v171, v169, s46
    v_perm_b32 v96, v171, v169, s47
    v_perm_b32 v73, v174, v172, s46
    v_perm_b32 v81, v174, v172, s47
    v_perm_b32 v89, v175, v173, s46
    v_perm_b32 v97, v175, v173, s47
    v_perm_b32 v74, v178, v176, s46
    v_perm_b32 v82, v178, v176, s47
    v_perm_b32 v90, v179, v177, s46
    v_perm_b32 v98, v179, v177, s47
    v_perm_b32 v75, v182, v180, s46
    v_perm_b32 v83, v182, v180, s47
    v_perm_b32 v91, v183, v181, s46
    v_perm_b32 v99, v183, v181, s47
    v_perm_b32 v76, v186, v184, s46
    v_perm_b32 v84, v186, v184, s47
    v_perm_b32 v92, v187, v185, s46
    v_perm_b32 v100, v187, v185, s47
    v_perm_b32 v77, v190, v188, s46
    v_perm_b32 v85, v190, v188, s47
    v_perm_b32 v93, v191, v189, s46
    v_perm_b32 v101, v191, v189, s47
    v_perm_b32 v78, v194, v192, s46
    v_perm_b32 v86, v194, v192, s47
    v_perm_b32 v94, v195, v193, s46
    v_perm_b32 v102, v195, v193, s47
    v_perm_b32 v79, v198, v196, s46
    v_perm_b32 v87, v198, v196, s47
    v_perm_b32 v95, v199, v197, s46
    v_perm_b32 v103, v199, v197, s47
    s_mul_i32 s44, s42, 16
    s_add_u32 s44, s44, 262144
    s_cmp_eq_u32 s42, 11
    s_cselect_b32 s45, 262144, 0
    s_add_u32 s44, s44, s45
    v_mov_b32 v249, s44
    v_mov_b32 v250, s41
    s_barrier
    global_load_dwordx4 v[104:107], v2, s[30:31] nt
    v_add_u32 v2, 4608, v2
    global_load_dwordx4 v[108:111], v2, s[30:31] nt
    v_add_u32 v2, 4608, v2
    global_load_dwordx4 v[112:115], v2, s[30:31] nt
    v_add_u32 v2, 4608, v2
    global_load_dwordx4 v[116:119], v2, s[30:31] nt
    v_add_u32 v2, 4608, v2
    s_barrier
    global_load_dwordx4 v[120:123], v2, s[30:31] nt
    v_add_u32 v2, 4608, v2
    global_load_dwordx4 v[124:127], v2, s[30:31] nt
    v_add_u32 v2, 4608, v2
    global_load_dwordx4 v[128:131], v2, s[30:31] nt
    v_add_u32 v2, 4608, v2
    global_load_dwordx4 v[132:135], v2, s[30:31] nt
    v_add_u32 v2, 4608, v2
    global_load_dwordx4 v[136:139], v2, s[30:31] nt
    v_add_u32 v2, 4608, v2
    global_load_dwordx4 v[140:143], v2, s[30:31] nt
    s_mov_b64 exec, 1
    global_store_dword v249, v250, s[36:37] sc1
    s_mov_b64 exec, -1
    s_waitcnt vmcnt(8)
    v_perm_b32 v8, v108, v104, s46
    v_perm_b32 v16, v108, v104, s47
    v_perm_b32 v24, v109, v105, s46
    v_perm_b32 v32, v109, v105, s47
    v_perm_b32 v40, v110, v106, s46
    v_perm_b32 v48, v110, v106, s47
    v_perm_b32 v56, v111, v107, s46
    v_perm_b32 v64, v111, v107, s47
    v_add_u32 v2, 4608, v2
    global_load_dwordx4 v[144:147], v2, s[30:31] nt
    v_add_u32 v2, 4608, v2
    global_load_dwordx4 v[148:151], v2, s[30:31] nt
    s_waitcnt vmcnt(8)
    v_perm_b32 v9, v116, v112, s46
    v_perm_b32 v17, v116, v112, s47
    v_perm_b32 v25, v117, v113, s46
    v_perm_b32 v33, v117, v113, s47
    v_perm_b32 v41, v118, v114, s46
    v_perm_b32 v49, v118, v114, s47
    v_perm_b32 v57, v119, v115, s46
    v_perm_b32 v65, v119, v115, s47
    v_add_u32 v2, 4608, v2
    global_load_dwordx4 v[152:155], v2, s[30:31] nt
    v_add_u32 v2, 4608, v2
    global_load_dwordx4 v[156:159], v2, s[30:31] nt
    s_waitcnt vmcnt(8)
    v_perm_b32 v10, v124, v120, s46
    v_perm_b32 v18, v124, v120, s47
    v_perm_b32 v26, v125, v121, s46
    v_perm_b32 v34, v125, v121, s47
    v_perm_b32 v42, v126, v122, s46
    v_perm_b32 v50, v126, v122, s47
    v_perm_b32 v58, v127, v123, s46
    v_perm_b32 v66, v127, v123, s47
    v_add_u32 v2, 4608, v2
    global_load_dwordx4 v[160:163], v2, s[30:31] nt
    v_add_u32 v2, 4608, v2
    global_load_dwordx4 v[164:167], v2, s[30:31] nt
    s_waitcnt vmcnt(8)
    v_perm_b32 v11, v132, v128, s46
    v_perm_b32 v19, v132, v128, s47
    v_perm_b32 v27, v133, v129, s46
    v_perm_b32 v35, v133, v129, s47
    v_perm_b32 v43, v134, v130, s46
    v_perm_b32 v51, v134, v130, s47
    v_perm_b32 v59, v135, v131, s46
    v_perm_b32 v67, v135, v131, s47
    s_barrier
    s_waitcnt vmcnt(6)
    v_perm_b32 v12, v140, v136, s46
    v_perm_b32 v20, v140, v136, s47
    v_perm_b32 v28, v141, v137, s46
    v_perm_b32 v36, v141, v137, s47
    v_perm_b32 v44, v142, v138, s46
    v_perm_b32 v52, v142, v138, s47
    v_perm_b32 v60, v143, v139, s46
    v_perm_b32 v68, v143, v139, s47
    s_waitcnt vmcnt(4)
    v_perm_b32 v13, v148, v144, s46
    v_perm_b32 v21, v148, v144, s47
    v_perm_b32 v29, v149, v145, s46
    v_perm_b32 v37, v149, v145, s47
    v_perm_b32 v45, v150, v146, s46
    v_perm_b32 v53, v150, v146, s47
    v_perm_b32 v61, v151, v147, s46
    v_perm_b32 v69, v151, v147, s47
    s_waitcnt vmcnt(2)
    v_perm_b32 v14, v156, v152, s46
    v_perm_b32 v22, v156, v152, s47
    v_perm_b32 v30, v157, v153, s46
    v_perm_b32 v38, v157, v153, s47
    v_perm_b32 v46, v158, v154, s46
    v_perm_b32 v54, v158, v154, s47
    v_perm_b32 v62, v159, v155, s46
    v_perm_b32 v70, v159, v155, s47
    s_waitcnt vmcnt(0)
    v_perm_b32 v15, v164, v160, s46
    v_perm_b32 v23, v164, v160, s47
    v_perm_b32 v31, v165, v161, s46
    v_perm_b32 v39, v165, v161, s47
    v_perm_b32 v47, v166, v162, s46
    v_perm_b32 v55, v166, v162, s47
    v_perm_b32 v63, v167, v163, s46
    v_perm_b32 v71, v167, v163, s47
    s_barrier
    ds_read_b128 v[112:115], v253 offset:16384
    s_waitcnt lgkmcnt(0)
    v_smfmac_f32_16x16x64_bf16 v[200:203], v[112:115], v[8:15], v251
    s_nop 0
    s_nop 0
    v_smfmac_f32_16x16x64_bf16 v[204:207], v[112:115], v[16:23], v251
    s_nop 0
    s_nop 0
    v_smfmac_f32_16x16x64_bf16 v[208:211], v[112:115], v[24:31], v251
    s_nop 0
    s_nop 0
    v_smfmac_f32_16x16x64_bf16 v[212:215], v[112:115], v[32:39], v251
    v_add_f32 v200, v200, v202
    v_add_f32 v201, v201, v203
    v_smfmac_f32_16x16x64_bf16 v[216:219], v[112:115], v[40:47], v251
    v_cvt_pk_bf16_f32 v120, v200, v201
    v_and_or_b32 v120, v120, v254, s48
    v_smfmac_f32_16x16x64_bf16 v[220:223], v[112:115], v[48:55], v251
    v_add_f32 v204, v204, v206
    v_add_f32 v205, v205, v207
    v_smfmac_f32_16x16x64_bf16 v[224:227], v[112:115], v[56:63], v251
    v_cvt_pk_bf16_f32 v121, v204, v205
    v_and_or_b32 v121, v121, v254, s49
    v_smfmac_f32_16x16x64_bf16 v[228:231], v[112:115], v[64:71], v251
    v_add_f32 v208, v208, v210
    v_add_f32 v209, v209, v211
    v_smfmac_f32_16x16x64_bf16 v[232:235], v[112:115], v[72:79], v251
    v_cvt_pk_bf16_f32 v122, v208, v209
    v_and_or_b32 v122, v122, v254, s50
    v_smfmac_f32_16x16x64_bf16 v[236:239], v[112:115], v[80:87], v251
    v_add_f32 v212, v212, v214
    v_add_f32 v213, v213, v215
    v_smfmac_f32_16x16x64_bf16 v[240:243], v[112:115], v[88:95], v251
    v_cvt_pk_bf16_f32 v123, v212, v213
    v_and_or_b32 v123, v123, v254, s51
    v_smfmac_f32_16x16x64_bf16 v[244:247], v[112:115], v[96:103], v251
    global_store_dwordx4 v5, v[120:123], s[36:37] sc1
    v_add_f32 v216, v216, v218
    v_add_f32 v217, v217, v219
    v_cvt_pk_bf16_f32 v124, v216, v217
    v_and_or_b32 v124, v124, v254, s48
    v_add_f32 v220, v220, v222
    v_add_f32 v221, v221, v223
    v_cvt_pk_bf16_f32 v125, v220, v221
    v_and_or_b32 v125, v125, v254, s49
    v_pk_add_f32 v[224:225], v[224:225], v[226:227]
    v_cvt_pk_bf16_f32 v126, v224, v225
    v_and_or_b32 v126, v126, v254, s50
    v_pk_add_f32 v[228:229], v[228:229], v[230:231]
    v_cvt_pk_bf16_f32 v127, v228, v229
    v_and_or_b32 v127, v127, v254, s51
    global_store_dwordx4 v6, v[124:127], s[36:37] sc1
    v_pk_add_f32 v[232:233], v[232:233], v[234:235]
    v_cvt_pk_bf16_f32 v128, v232, v233
    v_and_or_b32 v128, v128, v254, s48
    v_pk_add_f32 v[236:237], v[236:237], v[238:239]
    v_cvt_pk_bf16_f32 v129, v236, v237
    v_and_or_b32 v129, v129, v254, s49
    v_pk_add_f32 v[240:241], v[240:241], v[242:243]
    v_cvt_pk_bf16_f32 v130, v240, v241
    v_and_or_b32 v130, v130, v254, s50
    v_pk_add_f32 v[244:245], v[244:245], v[246:247]
    v_cvt_pk_bf16_f32 v131, v244, v245
    v_and_or_b32 v131, v131, v254, s51
    global_store_dwordx4 v7, v[128:131], s[36:37] sc1
    s_endpgm
L_pref:
    s_cmp_ge_u32 s2, 255
    s_cbranch_scc1 L_sel_lo
    s_sub_u32 s43, s63, s61
    s_cmp_lt_u32 s39, 2
    s_cselect_b32 s47, 8, 16
    s_sub_u32 s47, s47, s61
    s_cmp_ge_u32 s39, 7
    s_subb_u32 s47, s47, 0
    s_mul_i32 s42, s38, s47
    s_add_u32 s42, s42, s43
    s_mul_i32 s47, s47, 8
    s_mul_i32 s46, s60, 73728
    s_movk_i32 s52, 42
    s_cmp_eq_u32 s61, 10
    s_cselect_b32 s52, 58, s52
    s_movk_i32 s53, 0
    s_cmp_eq_u32 s61, 10
    s_cselect_b32 s53, 80, s53
    s_movk_i32 s54, 18
    s_cmp_eq_u32 s61, 10
    s_cselect_b32 s54, 10, s54
    v_lshlrev_b32 v2, 7, v1
    s_cmp_lt_u32 s38, 2
    s_cbranch_scc1 L_pf_e
    s_cmp_eq_u32 s64, 0
    s_cbranch_scc1 L_lb_pf2
    s_barrier
L_lb_pf2:
    s_mov_b32 s64, 0
L_pf_e:
    s_cmp_ge_u32 s42, s53
    s_cbranch_scc1 L_pf_d0
    s_mul_i32 s44, s42, s59
    s_lshr_b32 s44, s44, 16
    s_mul_i32 s45, s44, s61
    s_sub_u32 s45, s42, s45
    v_lshl_add_u32 v4, s45, 6, v1
    v_mul_u32_u24 v5, s59, v4
    v_lshrrev_b32 v5, 16, v5
    v_mul_u32_u24 v6, s61, v5
    v_sub_u32 v6, v4, v6
    v_and_b32 v7, 31, v5
    v_lshrrev_b32 v5, 5, v5
    v_mul_u32_u24 v7, 18, v7
    s_andn2_b32 s45, s44, 1
    s_add_u32 s45, s45, s54
    v_add3_u32 v5, v5, v7, s45
    v_mul_u32_u24 v5, 9216, v5
    v_add_u32 v6, s60, v6
    v_lshl_add_u32 v5, v6, 7, v5
    s_bitcmp0_b32 s44, 0
    s_cselect_b64 s[56:57], s[26:27], s[28:29]
    global_load_dword v10, v5, s[56:57]
    s_branch L_pf_n0
L_pf_d0:
    s_sub_u32 s45, s42, s53
    s_cmp_ge_u32 s45, s52
    s_cbranch_scc1 L_pref_done
    s_mul_i32 s43, s45, s59
    s_lshr_b32 s43, s43, 16
    s_mul_i32 s44, s43, s61
    s_sub_u32 s44, s45, s44
    s_mul_i32 s44, s44, 73728
    s_lshl_b32 s43, s43, 13
    s_add_u32 s43, s43, s44
    s_add_u32 s43, s43, s46
    v_add_u32 v3, s43, v2
    global_load_dword v10, v3, s[30:31]
L_pf_n0:
    s_add_u32 s42, s42, s47
    s_cmp_eq_u32 s64, 0
    s_cbranch_scc1 L_lb_pf3
    s_barrier
L_lb_pf3:
    s_cmp_ge_u32 s42, s53
    s_cbranch_scc1 L_pf_d1
    s_mul_i32 s44, s42, s59
    s_lshr_b32 s44, s44, 16
    s_mul_i32 s45, s44, s61
    s_sub_u32 s45, s42, s45
    v_lshl_add_u32 v4, s45, 6, v1
    v_mul_u32_u24 v5, s59, v4
    v_lshrrev_b32 v5, 16, v5
    v_mul_u32_u24 v6, s61, v5
    v_sub_u32 v6, v4, v6
    v_and_b32 v7, 31, v5
    v_lshrrev_b32 v5, 5, v5
    v_mul_u32_u24 v7, 18, v7
    s_andn2_b32 s45, s44, 1
    s_add_u32 s45, s45, s54
    v_add3_u32 v5, v5, v7, s45
    v_mul_u32_u24 v5, 9216, v5
    v_add_u32 v6, s60, v6
    v_lshl_add_u32 v5, v6, 7, v5
    s_bitcmp0_b32 s44, 0
    s_cselect_b64 s[56:57], s[26:27], s[28:29]
    global_load_dword v11, v5, s[56:57]
    s_branch L_pf_n1
L_pf_d1:
    s_sub_u32 s45, s42, s53
    s_cmp_ge_u32 s45, s52
    s_cbranch_scc1 L_pref_done
    s_mul_i32 s43, s45, s59
    s_lshr_b32 s43, s43, 16
    s_mul_i32 s44, s43, s61
    s_sub_u32 s44, s45, s44
    s_mul_i32 s44, s44, 73728
    s_lshl_b32 s43, s43, 13
    s_add_u32 s43, s43, s44
    s_add_u32 s43, s43, s46
    v_add_u32 v3, s43, v2
    global_load_dword v11, v3, s[30:31]
L_pf_n1:
    s_add_u32 s42, s42, s47
    s_cmp_ge_u32 s42, s53
    s_cbranch_scc1 L_pf_d2
    s_mul_i32 s44, s42, s59
    s_lshr_b32 s44, s44, 16
    s_mul_i32 s45, s44, s61
    s_sub_u32 s45, s42, s45
    v_lshl_add_u32 v4, s45, 6, v1
    v_mul_u32_u24 v5, s59, v4
    v_lshrrev_b32 v5, 16, v5
    v_mul_u32_u24 v6, s61, v5
    v_sub_u32 v6, v4, v6
    v_and_b32 v7, 31, v5
    v_lshrrev_b32 v5, 5, v5
    v_mul_u32_u24 v7, 18, v7
    s_andn2_b32 s45, s44, 1
    s_add_u32 s45, s45, s54
    v_add3_u32 v5, v5, v7, s45
    v_mul_u32_u24 v5, 9216, v5
    v_add_u32 v6, s60, v6
    v_lshl_add_u32 v5, v6, 7, v5
    s_bitcmp0_b32 s44, 0
    s_cselect_b64 s[56:57], s[26:27], s[28:29]
    global_load_dword v12, v5, s[56:57]
    s_branch L_pf_n2
L_pf_d2:
    s_sub_u32 s45, s42, s53
    s_cmp_ge_u32 s45, s52
    s_cbranch_scc1 L_pref_done
    s_mul_i32 s43, s45, s59
    s_lshr_b32 s43, s43, 16
    s_mul_i32 s44, s43, s61
    s_sub_u32 s44, s45, s44
    s_mul_i32 s44, s44, 73728
    s_lshl_b32 s43, s43, 13
    s_add_u32 s43, s43, s44
    s_add_u32 s43, s43, s46
    v_add_u32 v3, s43, v2
    global_load_dword v12, v3, s[30:31]
L_pf_n2:
    s_add_u32 s42, s42, s47
    s_cmp_ge_u32 s42, s53
    s_cbranch_scc1 L_pf_d3
    s_mul_i32 s44, s42, s59
    s_lshr_b32 s44, s44, 16
    s_mul_i32 s45, s44, s61
    s_sub_u32 s45, s42, s45
    v_lshl_add_u32 v4, s45, 6, v1
    v_mul_u32_u24 v5, s59, v4
    v_lshrrev_b32 v5, 16, v5
    v_mul_u32_u24 v6, s61, v5
    v_sub_u32 v6, v4, v6
    v_and_b32 v7, 31, v5
    v_lshrrev_b32 v5, 5, v5
    v_mul_u32_u24 v7, 18, v7
    s_andn2_b32 s45, s44, 1
    s_add_u32 s45, s45, s54
    v_add3_u32 v5, v5, v7, s45
    v_mul_u32_u24 v5, 9216, v5
    v_add_u32 v6, s60, v6
    v_lshl_add_u32 v5, v6, 7, v5
    s_bitcmp0_b32 s44, 0
    s_cselect_b64 s[56:57], s[26:27], s[28:29]
    global_load_dword v13, v5, s[56:57]
    s_branch L_pf_n3
L_pf_d3:
    s_sub_u32 s45, s42, s53
    s_cmp_ge_u32 s45, s52
    s_cbranch_scc1 L_pref_done
    s_mul_i32 s43, s45, s59
    s_lshr_b32 s43, s43, 16
    s_mul_i32 s44, s43, s61
    s_sub_u32 s44, s45, s44
    s_mul_i32 s44, s44, 73728
    s_lshl_b32 s43, s43, 13
    s_add_u32 s43, s43, s44
    s_add_u32 s43, s43, s46
    v_add_u32 v3, s43, v2
    global_load_dword v13, v3, s[30:31]
L_pf_n3:
    s_add_u32 s42, s42, s47
L_pref_done:
    s_endpgm
L_sel_lo:
    v_mov_b32 v2, 0
    v_lshlrev_b32 v3, 2, v1
    ds_write_b32 v3, v2 offset:8192
    ds_write_b32 v2, v2 offset:16640
    ds_write_b32 v2, v2 offset:16644
    s_cmp_eq_u32 s64, 0
    s_cbranch_scc1 L_lb_sel
    s_barrier
L_lb_sel:
    v_lshlrev_b32 v2, 4, v0
    v_add_u32 v3, 12288, v2
    v_add_u32 v2, 4096, v2
    v_lshlrev_b32 v4, 1, v0
    v_sub_u32 v4, 2047, v4
    v_add_u32 v5, -1, v4
    v_add_u32 v6, 0xfffffc00, v4
    v_add_u32 v7, 0xfffffc00, v5
    v_lshlrev_b32 v8, 3, v0
    s_mul_i32 s44, s38, 43
    s_lshr_b32 s44, s44, 7
    s_mul_i32 s44, s44, 252
    s_mul_i32 s45, s38, 12
    s_add_u32 s44, s44, s45
    v_lshrrev_b32 v9, 4, v1
    v_mul_u32_u24 v9, 72, v9
    v_bfe_u32 v10, v1, 1, 1
    v_mul_u32_u24 v10, 36, v10
    v_add_u32 v10, v9, v10
    v_add_u32 v9, s44, v10
    s_cmp_eq_u32 s38, 0
    s_cselect_b32 s44, 0, 252
    s_add_u32 s44, s44, s45
    s_add_u32 s44, s44, 600
    v_add_u32 v10, s44, v10
    s_mov_b32 s43, 65536
    v_lshl_add_u32 v11, v0, 4, s43
    v_add_u32 v12, 8192, v11
    v_lshrrev_b32 v13, 3, v0
    v_lshlrev_b32 v13, 2, v13
    v_and_b32 v61, 7, v1
    v_lshlrev_b32 v61, 5, v61
    s_mov_b32 s56, 0xff00ff00
    s_mov_b32 s57, 0xff00ff00
    s_mov_b32 s59, 0
    s_mov_b32 s65, 8
    s_movk_i32 s58, 1152
    s_mov_b32 s60, 0x01010101
    s_mov_b32 s61, 0x01010101
    v_mov_b32 v14, 0
    v_mov_b32 v15, 4
    v_and_b32 v16, 15, v1
    v_lshlrev_b32 v16, 2, v16
    v_and_b32 v17, 0x30, v1
    v_and_b32 v18, 12, v1
    v_and_b32 v19, 1, v1
    v_lshl_add_u32 v18, v19, 4, v18
    s_mov_b32 s42, 0
    s_mov_b32 s54, 0xffff
    s_mov_b32 s55, 4294901760
    v_mov_b32 v39, s41
    v_mov_b32 v43, s41
    v_mov_b32 v47, s41
    s_waitcnt vmcnt(0) lgkmcnt(0)
    s_barrier
L_pollS:
    global_load_dwordx4 v[20:23], v2, s[36:37] sc1
    global_load_dwordx4 v[24:27], v3, s[36:37] sc1
    s_add_u32 s42, s42, 1
    s_cmp_ge_u32 s42, 65536
    s_cbranch_scc1 L_pollS_done
    s_waitcnt vmcnt(0)
    v_cmp_ne_u32 s[46:47], s41, v23
    v_cmp_ne_u32 vcc, s41, v27
    s_nop 0
    s_or_b64 exec, vcc, s[46:47]
    s_cbranch_scc1 L_pollS
L_pollS_done:
    s_mov_b64 exec, -1
    s_waitcnt vmcnt(0)
    v_and_b32 v28, s54, v22
    v_lshrrev_b32 v29, 16, v22
    v_and_b32 v30, s54, v26
    v_lshrrev_b32 v31, 16, v26
    v_lshl_or_b32 v28, v28, 11, v4
    v_lshl_or_b32 v29, v29, 11, v5
    v_lshl_or_b32 v30, v30, 11, v6
    v_lshl_or_b32 v31, v31, 11, v7
    v_max3_u32 v32, v28, v29, v30
    v_med3_u32 v33, v28, v29, v30
    v_med3_u32 v33, v32, v33, v31
    v_max_u32 v32, v32, v31
    s_nop 1
    v_min_u32_dpp v34, v32, v32 row_ror:8 row_mask:0xf bank_mask:0xf
    v_max_u32_dpp v32, v32, v32 row_ror:8 row_mask:0xf bank_mask:0xf
    v_max_u32_dpp v33, v33, v33 row_ror:8 row_mask:0xf bank_mask:0xf
    v_max_u32 v33, v33, v34
    v_min_u32_dpp v34, v32, v32 row_ror:4 row_mask:0xf bank_mask:0xf
    v_max_u32_dpp v32, v32, v32 row_ror:4 row_mask:0xf bank_mask:0xf
    v_max_u32_dpp v33, v33, v33 row_ror:4 row_mask:0xf bank_mask:0xf
    v_max_u32 v33, v33, v34
    v_min_u32_dpp v34, v32, v32 row_ror:2 row_mask:0xf bank_mask:0xf
    v_max_u32_dpp v32, v32, v32 row_ror:2 row_mask:0xf bank_mask:0xf
    v_max_u32_dpp v33, v33, v33 row_ror:2 row_mask:0xf bank_mask:0xf
    v_max_u32 v33, v33, v34
    v_min_u32_dpp v34, v32, v32 row_ror:1 row_mask:0xf bank_mask:0xf
    v_max_u32_dpp v32, v32, v32 row_ror:1 row_mask:0xf bank_mask:0xf
    v_max_u32_dpp v33, v33, v33 row_ror:1 row_mask:0xf bank_mask:0xf
    v_max_u32 v33, v33, v34
    v_cndmask_b32 v34, v32, v33, s[56:57]
    ds_write_b32 v13, v34 offset:16384
    s_waitcnt lgkmcnt(0)
    s_barrier
    ds_read_b128 v[48:51], v61 offset:16384
    ds_read_b128 v[52:55], v61 offset:16400
    s_waitcnt lgkmcnt(1)
    v_sub_u32 v48, v34, v48
    v_alignbit_b32 v35, 0, v48, 31
    v_sub_u32 v49, v34, v49
    v_alignbit_b32 v35, v35, v49, 31
    v_sub_u32 v50, v34, v50
    v_alignbit_b32 v35, v35, v50, 31
    v_sub_u32 v51, v34, v51
    v_alignbit_b32 v35, v35, v51, 31
    s_waitcnt lgkmcnt(0)
    v_sub_u32 v52, v34, v52
    v_alignbit_b32 v35, v35, v52, 31
    v_sub_u32 v53, v34, v53
    v_alignbit_b32 v35, v35, v53, 31
    v_sub_u32 v54, v34, v54
    v_alignbit_b32 v35, v35, v54, 31
    v_sub_u32 v55, v34, v55
    v_alignbit_b32 v35, v35, v55, 31
    v_bcnt_u32_b32 v35, v35, 0
    s_nop 1
    v_add_u32_dpp v35, v35, v35 quad_perm:[1,0,3,2] row_mask:0xf bank_mask:0xf
    s_nop 1
    v_add_u32_dpp v35, v35, v35 quad_perm:[2,3,0,1] row_mask:0xf bank_mask:0xf
    s_nop 1
    v_add_u32_dpp v35, v35, v35 row_half_mirror row_mask:0xf bank_mask:0xf
    v_min_u32 v35, 8, v35
    v_lshlrev_b32 v35, 2, v35
    ds_write_b32 v35, v34 offset:16672
    s_waitcnt lgkmcnt(0)
    s_barrier
L_sel_got:
    ds_read_b32 v34, v18 offset:16672
    ds_read_b32 v33, v14 offset:16700
    s_waitcnt lgkmcnt(1)
    v_and_b32 v36, 2047, v34
    v_sub_u32 v36, 2047, v36
    v_mad_u32_u24 v62, v36, s58, v9
    global_load_dwordx3 v[40:42], v62, s[4:5]
    s_cmp_ge_u32 s38, 4
    s_cbranch_scc1 L_sel_one
    v_mad_u32_u24 v62, v36, s58, v10
    global_load_dwordx3 v[44:46], v62, s[4:5]
L_sel_one:
    ds_write_b64 v8, v[20:21] offset:0
    ds_write_b64 v8, v[24:25] offset:4096
    s_waitcnt lgkmcnt(2)
    v_cmp_le_u32 s[46:47], v33, v28
    v_cmp_le_u32 s[48:49], v33, v29
    v_cmp_le_u32 s[50:51], v33, v30
    v_cmp_le_u32 s[52:53], v33, v31
    v_lshlrev_b32 v19, 2, v36
    s_bcnt1_i32_b64 s44, s[46:47]
    s_bcnt1_i32_b64 s45, s[48:49]
    s_bcnt1_i32_b64 s62, s[50:51]
    s_bcnt1_i32_b64 s63, s[52:53]
    s_add_u32 s44, s44, s45
    s_add_u32 s62, s62, s63
    s_add_u32 s44, s44, s62
    v_mov_b32 v35, s44
    s_mov_b64 exec, 1
    ds_add_u32 v14, v35 offset:16644
    s_mov_b64 exec, -1
    s_waitcnt lgkmcnt(0)
    s_barrier
    ds_read_b32 v35, v14 offset:16644
    ds_read_b32 v37, v19 offset:0
    s_waitcnt lgkmcnt(0)
    v_max_u32 v35, s59, v35
    v_cmp_ne_u32 vcc, s65, v35
    s_cbranch_vccnz L_sel_fb
    v_and_b32 v50, s55, v37
    v_rcp_f32 v50, v50
    v_lshlrev_b32 v48, 16, v37
    v_mul_f32 v48, v48, v50
    s_cmp_ge_u32 s38, 4
    s_cbranch_scc1 L_sel_w
    s_waitcnt vmcnt(1)
    v_lshlrev_b32 v52, 16, v40
    v_and_b32 v53, s55, v40
    v_lshlrev_b32 v54, 16, v41
    v_and_b32 v55, s55, v41
    v_lshlrev_b32 v56, 16, v42
    v_and_b32 v57, s55, v42
    v_pk_fma_f32 v[52:53], v[52:53], v[50:51], v[48:49] op_sel_hi:[1,0,0] neg_lo:[0,0,1] neg_hi:[0,0,1]
    v_pk_fma_f32 v[54:55], v[54:55], v[50:51], v[48:49] op_sel_hi:[1,0,0] neg_lo:[0,0,1] neg_hi:[0,0,1]
    v_pk_fma_f32 v[56:57], v[56:57], v[50:51], v[48:49] op_sel_hi:[1,0,0] neg_lo:[0,0,1] neg_hi:[0,0,1]
    v_cvt_pk_bf16_f32 v40, v52, v53
    v_cvt_pk_bf16_f32 v41, v54, v55
    v_cvt_pk_bf16_f32 v42, v56, v57
    global_store_dwordx4 v11, v[40:43], s[36:37] sc1
    s_waitcnt vmcnt(1)
    v_lshlrev_b32 v52, 16, v44
    v_and_b32 v53, s55, v44
    v_lshlrev_b32 v54, 16, v45
    v_and_b32 v55, s55, v45
    v_lshlrev_b32 v56, 16, v46
    v_and_b32 v57, s55, v46
    v_pk_fma_f32 v[52:53], v[52:53], v[50:51], v[48:49] op_sel_hi:[1,0,0] neg_lo:[0,0,1] neg_hi:[0,0,1]
    v_pk_fma_f32 v[54:55], v[54:55], v[50:51], v[48:49] op_sel_hi:[1,0,0] neg_lo:[0,0,1] neg_hi:[0,0,1]
    v_pk_fma_f32 v[56:57], v[56:57], v[50:51], v[48:49] op_sel_hi:[1,0,0] neg_lo:[0,0,1] neg_hi:[0,0,1]
    v_cvt_pk_bf16_f32 v44, v52, v53
    v_cvt_pk_bf16_f32 v45, v54, v55
    v_cvt_pk_bf16_f32 v46, v56, v57
    global_store_dwordx4 v12, v[44:47], s[36:37] sc1
    s_branch L_sel_done
L_sel_w:
    s_waitcnt vmcnt(0)
    v_lshlrev_b32 v52, 16, v40
    v_and_b32 v53, s55, v40
    v_lshlrev_b32 v54, 16, v41
    v_and_b32 v55, s55, v41
    v_lshlrev_b32 v56, 16, v42
    v_and_b32 v57, s55, v42
    v_pk_fma_f32 v[52:53], v[52:53], v[50:51], v[48:49] op_sel_hi:[1,0,0] neg_lo:[0,0,1] neg_hi:[0,0,1]
    v_pk_fma_f32 v[54:55], v[54:55], v[50:51], v[48:49] op_sel_hi:[1,0,0] neg_lo:[0,0,1] neg_hi:[0,0,1]
    v_pk_fma_f32 v[56:57], v[56:57], v[50:51], v[48:49] op_sel_hi:[1,0,0] neg_lo:[0,0,1] neg_hi:[0,0,1]
    v_cvt_pk_bf16_f32 v40, v52, v53
    v_cvt_pk_bf16_f32 v41, v54, v55
    v_cvt_pk_bf16_f32 v42, v56, v57
    global_store_dwordx4 v11, v[40:43], s[36:37] sc1
    s_lshl3_add_u32 s44, s2, s38
    s_cmp_lg_u32 s44, 2047
    s_cbranch_scc1 L_sel_done
    v_lshlrev_b32 v38, 5, v34
    v_and_b32 v38, s55, v38
    v_ashrrev_i32 v35, 31, v38
    v_not_b32 v35, v35
    v_or_b32 v35, 0x80000000, v35
    v_xor_b32 v38, v38, v35
    v_and_b32 v38, s55, v38
    v_mul_f32 v38, 3216550459, v38
    v_exp_f32 v38, v38
    s_nop 0
    v_add_f32 v38, 1.0, v38
    v_rcp_f32 v38, v38
    s_nop 0
    v_cvt_pk_bf16_f32 v38, v38, v38
    v_and_b32 v38, s55, v38
    s_add_u32 s43, s43, 12288
    v_lshl_add_u32 v35, v18, 2, s43
    s_mov_b64 exec, 0x3333
    global_store_dwordx4 v35, v[36:39], s[36:37] sc1
    s_mov_b64 exec, -1
L_sel_done:
    s_cmp_lg_u32 s38, 4
    s_cbranch_scc1 L_agg_done
    v_mul_u32_u24 v2, 16, v1
    v_add_u32 v2, 262144, v2
    v_and_b32 v3, 7, v1
    v_mul_u32_u24 v3, 16, v3
    v_add_u32 v3, 263168, v3
    v_mov_b32 v6, 278528
    s_mov_b32 s42, 0
L_agg:
    global_load_dword v4, v2, s[36:37] sc1
    global_load_dword v5, v3, s[36:37] sc1
    s_add_u32 s42, s42, 1
    s_cmp_ge_u32 s42, 65536
    s_cbranch_scc1 L_agg_go
    s_waitcnt vmcnt(0)
    v_cmp_ne_u32 s[46:47], s41, v4
    v_cmp_ne_u32 vcc, s41, v5
    s_nop 0
    s_or_b64 exec, vcc, s[46:47]
    s_cbranch_scc1 L_agg
L_agg_go:
    s_mov_b64 exec, 1
    global_store_dword v6, v39, s[36:37] sc1
L_agg_done:
L_sel_end:
    s_endpgm
L_sel_fb:
    s_mov_b32 s59, -1
    s_mov_b32 s65, -1
    s_waitcnt vmcnt(0)
    s_mov_b64 exec, s[46:47]
    ds_add_rtn_u32 v52, v14, v15 offset:16640
    s_mov_b64 exec, s[48:49]
    ds_add_rtn_u32 v53, v14, v15 offset:16640
    s_mov_b64 exec, s[50:51]
    ds_add_rtn_u32 v54, v14, v15 offset:16640
    s_mov_b64 exec, s[52:53]
    ds_add_rtn_u32 v55, v14, v15 offset:16640
    s_waitcnt lgkmcnt(0)
    ds_write_b32 v55, v31 offset:8192
    s_mov_b64 exec, s[50:51]
    ds_write_b32 v54, v30 offset:8192
    s_mov_b64 exec, s[48:49]
    ds_write_b32 v53, v29 offset:8192
    s_mov_b64 exec, s[46:47]
    ds_write_b32 v52, v28 offset:8192
    s_mov_b64 exec, -1
    s_waitcnt lgkmcnt(0)
    s_barrier
    ds_read_b32 v34, v16 offset:8192
    ds_read_b128 v[48:51], v17 offset:8192
    ds_read_b32 v33, v14 offset:16640
    s_waitcnt lgkmcnt(1)
    v_sub_u32 v48, v34, v48
    v_sub_u32 v49, v34, v49
    v_sub_u32 v50, v34, v50
    v_sub_u32 v51, v34, v51
    v_lshrrev_b32 v48, 31, v48
    v_lshrrev_b32 v49, 31, v49
    v_lshrrev_b32 v50, 31, v50
    v_lshrrev_b32 v51, 31, v51
    v_add3_u32 v48, v48, v49, v50
    v_add_u32 v35, v48, v51
    v_add_u32 v48, v48, v51
    s_nop 1
    v_permlane16_swap_b32 v35, v48
    v_add_u32 v49, v35, v48
    v_add_u32 v35, v35, v48
    s_nop 1
    v_permlane32_swap_b32 v35, v49
    v_add_u32 v35, v35, v49
    v_cmp_gt_u32 vcc, 8, v35
    v_lshlrev_b32 v35, 2, v35
    s_waitcnt lgkmcnt(0)
    v_readfirstlane_b32 s45, v33
    s_mov_b64 exec, vcc
    ds_write_b32 v35, v34 offset:16672
    s_mov_b64 exec, -1
    s_cmp_gt_u32 s45, 64
    s_cbranch_scc1 L_sel_slow
    s_branch L_sel_got
L_sel_slow:
    s_waitcnt lgkmcnt(0)
    s_barrier
    v_lshlrev_b32 v16, 2, v0
    s_mov_b32 s47, 0
L_slow_outer:
    ds_read_b32 v34, v16 offset:8192
    v_mov_b32 v35, 0
    v_mov_b32 v17, 0
    s_mov_b32 s46, 0
L_slow_inner:
    ds_read_b32 v36, v17 offset:8192
    v_add_u32 v17, 4, v17
    s_add_u32 s46, s46, 4
    s_waitcnt lgkmcnt(0)
    v_cmp_gt_u32 vcc, v36, v34
    s_nop 1
    v_addc_co_u32 v35, vcc, 0, v35, vcc
    s_cmp_lt_u32 s46, s45
    s_cbranch_scc1 L_slow_inner
    v_cmp_gt_u32 vcc, 8, v35
    v_cmp_gt_u32 s[48:49], s45, v16
    v_lshlrev_b32 v35, 2, v35
    s_and_b64 exec, vcc, s[48:49]
    ds_write_b32 v35, v34 offset:16672
    s_mov_b64 exec, -1
    v_add_u32 v16, 2048, v16
    s_add_u32 s47, s47, 2048
    s_cmp_lt_u32 s47, s45
    s_cbranch_scc1 L_slow_outer
    s_waitcnt lgkmcnt(0)
    s_barrier
    s_branch L_sel_got
L_helper:
    v_mov_b32 v42, 147328
    v_mov_b32 v4, 1
    s_mov_b64 exec, 1
    ds_write_b32 v42, v59
    ds_add_u32 v42, v4 offset:4
    s_mov_b64 exec, -1
    s_lshl_b32 s63, s62, 3
    v_add_u32 v8, 0xffffff00, v0
    v_mul_u32_u24 v64, 2304, v8
    v_add_u32 v64, s63, v64
    v_add_u32 v65, 1152, v64
    v_add_u32 v66, 589824, v64
    v_add_u32 v67, 589824, v65
    v_add_u32 v68, 1179648, v64
    v_add_u32 v69, 1179648, v65
    v_add_u32 v70, 1769472, v64
    v_add_u32 v71, 1769472, v65
    s_mov_b32 s42, 0
L_hsync:
    ds_read_b32 v4, v42 offset:4
    s_add_u32 s42, s42, 1
    s_cmp_ge_u32 s42, 65536
    s_cbranch_scc1 L_hs_out
    s_waitcnt lgkmcnt(0)
    v_cmp_ne_u32 vcc, 4, v4
    s_cbranch_vccnz L_hsync
L_hs_out:
    global_load_dwordx2 v[10:11], v64, s[4:5]
    global_load_dwordx2 v[12:13], v65, s[4:5]
    global_load_dwordx2 v[14:15], v66, s[4:5]
    global_load_dwordx2 v[16:17], v67, s[4:5]
    v_lshlrev_b32 v2, 4, v8
    v_add_u32 v2, 8192, v2
    v_add_u32 v3, 8192, v2
    v_lshlrev_b32 v9, 2, v8
    v_lshrrev_b32 v42, 7, v8
    v_mul_u32_u24 v42, 1280, v42
    v_bfe_u32 v43, v8, 1, 2
    v_mul_u32_u24 v43, 320, v43
    v_add_u32 v42, v42, v43
    v_bfe_u32 v43, v8, 3, 4
    v_lshl_add_u32 v42, v43, 4, v42
    v_and_b32 v43, 1, v8
    v_add_u32 v8, 109952, v9
    v_lshl_add_u32 v9, v43, 3, v42
    s_mov_b32 s48, 4294901760
    v_and_b32 v240, 15, v1
    v_lshrrev_b32 v241, 1, v1
    v_and_b32 v241, 24, v241
    s_mov_b32 s51, 0x05040100
    s_and_b32 s56, s38, 3
    s_mov_b32 s53, 0x3f803f80
    s_lshl_b32 s57, s56, 2
    s_lshr_b32 s49, 0xc4536b, s57
    s_lshr_b32 s58, 0x297353, s57
    s_and_b32 s49, s49, 15
    s_and_b32 s58, s58, 15
    s_bfm_b32 s49, s58, s49
    s_lshl_b32 s56, s56, 10
    s_add_u32 s56, s56, 141184
    v_lshlrev_b32 v242, v240, s49
    v_lshrrev_b32 v242, v241, v242
    v_lshl_add_u32 v245, v1, 4, s56
    v_bfe_i32 v243, v242, 0, 1
    v_bfe_i32 v244, v242, 1, 1
    v_perm_b32 v243, v244, v243, s51
    v_and_b32 v248, s53, v243
    v_bfe_i32 v243, v242, 2, 1
    v_bfe_i32 v244, v242, 3, 1
    v_perm_b32 v243, v244, v243, s51
    v_and_b32 v249, s53, v243
    v_bfe_i32 v243, v242, 4, 1
    v_bfe_i32 v244, v242, 5, 1
    v_perm_b32 v243, v244, v243, s51
    v_and_b32 v250, s53, v243
    v_bfe_i32 v243, v242, 6, 1
    v_bfe_i32 v244, v242, 7, 1
    v_perm_b32 v243, v244, v243, s51
    v_and_b32 v251, s53, v243
    ds_write_b128 v245, v[248:251]
    s_and_b32 s56, s38, 1
    s_cselect_b32 s53, -1, s53
    s_or_b32 s56, s56, 4
    s_lshl_b32 s57, s56, 2
    s_lshr_b32 s49, 0xc4536b, s57
    s_lshr_b32 s58, 0x297353, s57
    s_and_b32 s49, s49, 15
    s_and_b32 s58, s58, 15
    s_bfm_b32 s49, s58, s49
    s_lshl_b32 s56, s56, 10
    s_add_u32 s56, s56, 141184
    v_lshlrev_b32 v242, v240, s49
    v_lshrrev_b32 v242, v241, v242
    v_lshl_add_u32 v245, v1, 4, s56
    v_bfe_i32 v243, v242, 0, 1
    v_bfe_i32 v244, v242, 1, 1
    v_perm_b32 v243, v244, v243, s51
    v_and_b32 v248, s53, v243
    v_bfe_i32 v243, v242, 2, 1
    v_bfe_i32 v244, v242, 3, 1
    v_perm_b32 v243, v244, v243, s51
    v_and_b32 v249, s53, v243
    v_bfe_i32 v243, v242, 4, 1
    v_bfe_i32 v244, v242, 5, 1
    v_perm_b32 v243, v244, v243, s51
    v_and_b32 v250, s53, v243
    v_bfe_i32 v243, v242, 6, 1
    v_bfe_i32 v244, v242, 7, 1
    v_perm_b32 v243, v244, v243, s51
    v_and_b32 v251, s53, v243
    ds_write_b128 v245, v[248:251]
    s_mov_b32 s60, 0x10001a0a
    s_mov_b32 s61, 0x3e342a20
    s_lshl_b32 s59, s39, 3
    s_lshr_b64 s[60:61], s[60:61], s59
    s_and_b32 s60, s60, 0xff
    s_lshl_b32 s59, s39, 2
    s_lshr_b32 s61, 0xaaaaaa66, s59
    s_and_b32 s61, s61, 15
    s_movk_i32 s59, 10923
    s_cmp_eq_u32 s61, 10
    s_cselect_b32 s59, 6554, s59
    s_cmp_lt_u32 s39, 2
    s_cselect_b32 s42, 24, 16
    s_sub_u32 s43, s38, 4
    s_mul_i32 s43, s43, s42
    s_add_u32 s65, s43, s40
    s_movk_i32 s42, 12
    s_cmp_eq_u32 s61, 10
    s_cselect_b32 s42, 32, s42
    s_mul_i32 s43, s61, 9
    s_sub_u32 s43, s43, s42
    s_mov_b32 s46, 0
    s_add_u32 s46, s46, s65
    s_cmp_lt_u32 s46, s42
    s_cselect_b64 s[54:55], -1, 1
    s_cselect_b32 s46, s46, 0
    s_add_u32 s43, s43, s46
    s_mul_i32 s46, s43, s59
    s_lshr_b32 s46, s46, 16
    s_mul_i32 s47, s46, s61
    s_sub_u32 s43, s43, s47
    s_add_u32 s43, s43, s60
    s_mul_i32 s43, s43, 576
    s_lshl_b32 s46, s46, 6
    s_add_u32 s43, s43, s46
    v_add_lshl_u32 v62, v1, s43, 7
    s_movk_i32 s42, 12
    s_cmp_eq_u32 s61, 10
    s_cselect_b32 s42, 32, s42
    s_mul_i32 s43, s61, 9
    s_sub_u32 s43, s43, s42
    s_cmp_lt_u32 s39, 2
    s_cselect_b32 s46, 96, 64
    s_add_u32 s46, s46, s65
    s_cmp_lt_u32 s46, s42
    s_cselect_b64 s[50:51], -1, 1
    s_cselect_b32 s46, s46, 0
    s_add_u32 s43, s43, s46
    s_mul_i32 s46, s43, s59
    s_lshr_b32 s46, s46, 16
    s_mul_i32 s47, s46, s61
    s_sub_u32 s43, s43, s47
    s_add_u32 s43, s43, s60
    s_mul_i32 s43, s43, 576
    s_lshl_b32 s46, s46, 6
    s_add_u32 s43, s43, s46
    v_add_lshl_u32 v46, v1, s43, 7
    s_waitcnt vmcnt(2)
    global_load_dwordx4 v[26:29], v2, s[36:37] offset:-4096 sc1
    global_load_dwordx4 v[30:33], v2, s[36:37] offset:0 sc1
    global_load_dwordx4 v[34:37], v3, s[36:37] offset:-4096 sc1
    global_load_dwordx4 v[38:41], v3, s[36:37] offset:0 sc1
    s_and_b32 s56, s40, 15
    s_and_b32 s57, s38, 3
    s_lshl2_add_u32 s56, s56, s57
    s_cmp_lt_u32 s40, 16
    s_cselect_b32 s57, 16, 32
    s_cselect_b64 s[66:67], 0xffff, -1
    s_mul_i32 s56, s56, s57
    s_add_u32 s56, s56, 1024
    v_and_b32 v5, 31, v1
    v_add_u32 v5, s56, v5
    v_mul_u32_u24 v5, 1152, v5
    s_lshr_b32 s56, s62, 4
    s_lshl_b32 s56, s56, 7
    v_add_u32 v5, s56, v5
    s_mov_b32 exec_lo, s66
    s_mov_b32 exec_hi, 0
    global_load_dword v61, v5, s[4:5]
    s_mov_b64 exec, -1
    s_waitcnt vmcnt(7)
    v_lshlrev_b32 v72, 16, v10
    v_lshlrev_b32 v73, 16, v12
    v_and_b32 v74, s48, v10
    v_and_b32 v75, s48, v12
    v_lshlrev_b32 v76, 16, v11
    v_lshlrev_b32 v77, 16, v13
    v_and_b32 v78, s48, v11
    v_and_b32 v79, s48, v13
    s_waitcnt vmcnt(5)
    v_lshlrev_b32 v80, 16, v14
    v_lshlrev_b32 v81, 16, v16
    v_and_b32 v82, s48, v14
    v_and_b32 v83, s48, v16
    v_lshlrev_b32 v84, 16, v15
    v_lshlrev_b32 v85, 16, v17
    v_and_b32 v86, s48, v15
    v_and_b32 v87, s48, v17
    s_setprio 3
    s_mov_b32 s49, 3216550459
    s_mov_b32 s42, 0
    s_waitcnt vmcnt(1)
    v_cmp_ne_u32 s[56:57], s41, v29
    v_cmp_ne_u32 s[58:59], s41, v33
    v_cmp_ne_u32 s[60:61], s41, v37
    v_cmp_ne_u32 vcc, s41, v41
    s_or_b64 s[56:57], s[56:57], s[58:59]
    s_or_b64 s[60:61], s[60:61], vcc
    s_or_b64 vcc, s[56:57], s[60:61]
    s_cbranch_vccnz L_pollA
L_pollA_done:
    global_load_dwordx2 v[18:19], v68, s[4:5]
    global_load_dwordx2 v[20:21], v69, s[4:5]
    v_and_b32 v170, s48, v26
    v_and_b32 v171, s48, v27
    v_rcp_f32 v170, v170
    v_rcp_f32 v171, v171
    v_lshlrev_b32 v168, 16, v26
    v_lshlrev_b32 v169, 16, v27
    v_mul_f32 v170, s49, v170
    v_mul_f32 v171, s49, v171
    v_mul_f32 v168, v168, v170
    v_mul_f32 v169, v169, v171
    v_pk_fma_f32 v[104:105], v[72:73], v[170:171], v[168:169] neg_lo:[0,0,1] neg_hi:[0,0,1]
    v_cvt_pk_bf16_f32 v172, v104, v105
    v_pk_fma_f32 v[106:107], v[74:75], v[170:171], v[168:169] neg_lo:[0,0,1] neg_hi:[0,0,1]
    v_cvt_pk_bf16_f32 v173, v106, v107
    v_pk_fma_f32 v[108:109], v[76:77], v[170:171], v[168:169] neg_lo:[0,0,1] neg_hi:[0,0,1]
    v_cvt_pk_bf16_f32 v174, v108, v109
    v_pk_fma_f32 v[110:111], v[78:79], v[170:171], v[168:169] neg_lo:[0,0,1] neg_hi:[0,0,1]
    v_cvt_pk_bf16_f32 v175, v110, v111
    ds_write_b32 v8, v172 offset:0
    ds_write_b32 v8, v173 offset:4608
    ds_write_b32 v8, v174 offset:9216
    ds_write_b32 v8, v175 offset:13824
    v_and_b32 v170, s48, v30
    v_and_b32 v171, s48, v31
    v_rcp_f32 v170, v170
    v_rcp_f32 v171, v171
    v_lshlrev_b32 v168, 16, v30
    v_lshlrev_b32 v169, 16, v31
    v_mul_f32 v170, s49, v170
    v_mul_f32 v171, s49, v171
    v_mul_f32 v168, v168, v170
    v_mul_f32 v169, v169, v171
    v_pk_fma_f32 v[112:113], v[80:81], v[170:171], v[168:169] neg_lo:[0,0,1] neg_hi:[0,0,1]
    v_cvt_pk_bf16_f32 v172, v112, v113
    v_pk_fma_f32 v[114:115], v[82:83], v[170:171], v[168:169] neg_lo:[0,0,1] neg_hi:[0,0,1]
    v_cvt_pk_bf16_f32 v173, v114, v115
    v_pk_fma_f32 v[116:117], v[84:85], v[170:171], v[168:169] neg_lo:[0,0,1] neg_hi:[0,0,1]
    v_cvt_pk_bf16_f32 v174, v116, v117
    v_pk_fma_f32 v[118:119], v[86:87], v[170:171], v[168:169] neg_lo:[0,0,1] neg_hi:[0,0,1]
    v_cvt_pk_bf16_f32 v175, v118, v119
    ds_write_b32 v8, v172 offset:1024
    ds_write_b32 v8, v173 offset:5632
    ds_write_b32 v8, v174 offset:10240
    ds_write_b32 v8, v175 offset:14848
    global_load_dwordx2 v[22:23], v70, s[4:5]
    global_load_dwordx2 v[24:25], v71, s[4:5]
    s_setprio 0
    s_waitcnt lgkmcnt(0)
    s_barrier
    s_mov_b64 exec, s[54:55]
    global_load_dword v47, v62, s[30:31]
    s_mov_b64 exec, -1
    v_exp_f32 v136, v104
    v_exp_f32 v137, v105
    v_exp_f32 v138, v106
    v_exp_f32 v139, v107
    v_exp_f32 v140, v108
    v_exp_f32 v141, v109
    v_exp_f32 v142, v110
    v_exp_f32 v143, v111
    v_add_f32 v136, 1.0, v136
    v_add_f32 v137, 1.0, v137
    v_add_f32 v138, 1.0, v138
    v_add_f32 v139, 1.0, v139
    v_add_f32 v140, 1.0, v140
    v_add_f32 v141, 1.0, v141
    v_add_f32 v142, 1.0, v142
    v_add_f32 v143, 1.0, v143
    v_rcp_f32 v136, v136
    v_rcp_f32 v137, v137
    v_rcp_f32 v138, v138
    v_rcp_f32 v139, v139
    v_rcp_f32 v140, v140
    v_rcp_f32 v141, v141
    v_rcp_f32 v142, v142
    v_rcp_f32 v143, v143
    v_mul_f32 v136, v104, v136
    v_mul_f32 v137, v105, v137
    v_mul_f32 v138, v106, v138
    v_mul_f32 v139, v107, v139
    v_mul_f32 v140, v108, v140
    v_mul_f32 v141, v109, v141
    v_mul_f32 v142, v110, v142
    v_mul_f32 v143, v111, v143
    s_waitcnt vmcnt(3)
    v_lshlrev_b32 v88, 16, v18
    v_lshlrev_b32 v89, 16, v20
    v_and_b32 v90, s48, v18
    v_and_b32 v91, s48, v20
    v_lshlrev_b32 v92, 16, v19
    v_lshlrev_b32 v93, 16, v21
    v_and_b32 v94, s48, v19
    v_and_b32 v95, s48, v21
    v_and_b32 v170, s48, v34
    v_and_b32 v171, s48, v35
    v_rcp_f32 v170, v170
    v_rcp_f32 v171, v171
    v_lshlrev_b32 v168, 16, v34
    v_lshlrev_b32 v169, 16, v35
    v_mul_f32 v170, s49, v170
    v_mul_f32 v171, s49, v171
    v_mul_f32 v168, v168, v170
    v_mul_f32 v169, v169, v171
    v_fma_f32 v120, v88, v170, -v168
    v_fma_f32 v121, v89, v171, -v169
    v_cvt_pk_bf16_f32 v172, v120, v121
    v_fma_f32 v122, v90, v170, -v168
    v_fma_f32 v123, v91, v171, -v169
    v_cvt_pk_bf16_f32 v173, v122, v123
    v_fma_f32 v124, v92, v170, -v168
    v_fma_f32 v125, v93, v171, -v169
    v_cvt_pk_bf16_f32 v174, v124, v125
    v_fma_f32 v126, v94, v170, -v168
    v_fma_f32 v127, v95, v171, -v169
    v_cvt_pk_bf16_f32 v175, v126, v127
    ds_write_b32 v8, v172 offset:2048
    ds_write_b32 v8, v173 offset:6656
    ds_write_b32 v8, v174 offset:11264
    ds_write_b32 v8, v175 offset:15872
    s_waitcnt lgkmcnt(0)
    s_barrier
    ds_read_b64 v[176:177], v9 offset:0
    ds_read_b64 v[178:179], v9 offset:10240
    ds_read_b64 v[180:181], v9 offset:20480
    ds_read_b64 v[182:183], v9 offset:30720
    s_waitcnt lgkmcnt(3)
    v_fma_f32 v176, v176, v136, v72
    v_fma_f32 v177, v177, v137, v73
    s_waitcnt lgkmcnt(2)
    v_fma_f32 v178, v178, v138, v74
    v_fma_f32 v179, v179, v139, v75
    s_waitcnt lgkmcnt(1)
    v_fma_f32 v180, v180, v140, v76
    v_fma_f32 v181, v181, v141, v77
    s_waitcnt lgkmcnt(0)
    v_fma_f32 v182, v182, v142, v78
    v_fma_f32 v183, v183, v143, v79
    v_cvt_pk_bf16_f32 v184, v176, v178
    v_cvt_pk_bf16_f32 v185, v180, v182
    v_cvt_pk_bf16_f32 v186, v177, v179
    v_cvt_pk_bf16_f32 v187, v181, v183
    global_store_dwordx2 v64, v[184:185], s[32:33]
    global_store_dwordx2 v65, v[186:187], s[32:33]
    s_waitcnt vmcnt(3)
    v_lshlrev_b32 v96, 16, v22
    v_lshlrev_b32 v97, 16, v24
    v_and_b32 v98, s48, v22
    v_and_b32 v99, s48, v24
    v_lshlrev_b32 v100, 16, v23
    v_lshlrev_b32 v101, 16, v25
    v_and_b32 v102, s48, v23
    v_and_b32 v103, s48, v25
    v_and_b32 v170, s48, v38
    v_and_b32 v171, s48, v39
    v_rcp_f32 v170, v170
    v_rcp_f32 v171, v171
    v_lshlrev_b32 v168, 16, v38
    v_lshlrev_b32 v169, 16, v39
    v_mul_f32 v170, s49, v170
    v_mul_f32 v171, s49, v171
    v_mul_f32 v168, v168, v170
    v_mul_f32 v169, v169, v171
    v_fma_f32 v128, v96, v170, -v168
    v_fma_f32 v129, v97, v171, -v169
    v_cvt_pk_bf16_f32 v172, v128, v129
    v_fma_f32 v130, v98, v170, -v168
    v_fma_f32 v131, v99, v171, -v169
    v_cvt_pk_bf16_f32 v173, v130, v131
    v_fma_f32 v132, v100, v170, -v168
    v_fma_f32 v133, v101, v171, -v169
    v_cvt_pk_bf16_f32 v174, v132, v133
    v_fma_f32 v134, v102, v170, -v168
    v_fma_f32 v135, v103, v171, -v169
    v_cvt_pk_bf16_f32 v175, v134, v135
    ds_write_b32 v8, v172 offset:3072
    ds_write_b32 v8, v173 offset:7680
    ds_write_b32 v8, v174 offset:12288
    ds_write_b32 v8, v175 offset:16896
    v_exp_f32 v144, v112
    v_exp_f32 v145, v113
    v_exp_f32 v146, v114
    v_exp_f32 v147, v115
    v_exp_f32 v148, v116
    v_exp_f32 v149, v117
    v_exp_f32 v150, v118
    v_exp_f32 v151, v119
    v_add_f32 v144, 1.0, v144
    v_add_f32 v145, 1.0, v145
    v_add_f32 v146, 1.0, v146
    v_add_f32 v147, 1.0, v147
    v_add_f32 v148, 1.0, v148
    v_add_f32 v149, 1.0, v149
    v_add_f32 v150, 1.0, v150
    v_add_f32 v151, 1.0, v151
    v_rcp_f32 v144, v144
    v_rcp_f32 v145, v145
    v_rcp_f32 v146, v146
    v_rcp_f32 v147, v147
    v_rcp_f32 v148, v148
    v_rcp_f32 v149, v149
    v_rcp_f32 v150, v150
    v_rcp_f32 v151, v151
    v_mul_f32 v144, v112, v144
    v_mul_f32 v145, v113, v145
    v_mul_f32 v146, v114, v146
    v_mul_f32 v147, v115, v147
    v_mul_f32 v148, v116, v148
    v_mul_f32 v149, v117, v149
    v_mul_f32 v150, v118, v150
    v_mul_f32 v151, v119, v151
    s_waitcnt lgkmcnt(0)
    s_barrier
    ds_read_b64 v[176:177], v9 offset:2560
    ds_read_b64 v[178:179], v9 offset:12800
    ds_read_b64 v[180:181], v9 offset:23040
    ds_read_b64 v[182:183], v9 offset:33280
    s_waitcnt lgkmcnt(3)
    v_fma_f32 v176, v176, v144, v80
    v_fma_f32 v177, v177, v145, v81
    s_waitcnt lgkmcnt(2)
    v_fma_f32 v178, v178, v146, v82
    v_fma_f32 v179, v179, v147, v83
    s_waitcnt lgkmcnt(1)
    v_fma_f32 v180, v180, v148, v84
    v_fma_f32 v181, v181, v149, v85
    s_waitcnt lgkmcnt(0)
    v_fma_f32 v182, v182, v150, v86
    v_fma_f32 v183, v183, v151, v87
    v_cvt_pk_bf16_f32 v188, v176, v178
    v_cvt_pk_bf16_f32 v189, v180, v182
    v_cvt_pk_bf16_f32 v190, v177, v179
    v_cvt_pk_bf16_f32 v191, v181, v183
    global_store_dwordx2 v66, v[188:189], s[32:33]
    global_store_dwordx2 v67, v[190:191], s[32:33]
    v_exp_f32 v152, v120
    v_exp_f32 v153, v121
    v_exp_f32 v154, v122
    v_exp_f32 v155, v123
    v_exp_f32 v156, v124
    v_exp_f32 v157, v125
    v_exp_f32 v158, v126
    v_exp_f32 v159, v127
    v_add_f32 v152, 1.0, v152
    v_add_f32 v153, 1.0, v153
    v_add_f32 v154, 1.0, v154
    v_add_f32 v155, 1.0, v155
    v_add_f32 v156, 1.0, v156
    v_add_f32 v157, 1.0, v157
    v_add_f32 v158, 1.0, v158
    v_add_f32 v159, 1.0, v159
    v_rcp_f32 v152, v152
    v_rcp_f32 v153, v153
    v_rcp_f32 v154, v154
    v_rcp_f32 v155, v155
    v_rcp_f32 v156, v156
    v_rcp_f32 v157, v157
    v_rcp_f32 v158, v158
    v_rcp_f32 v159, v159
    v_mul_f32 v152, v120, v152
    v_mul_f32 v153, v121, v153
    v_mul_f32 v154, v122, v154
    v_mul_f32 v155, v123, v155
    v_mul_f32 v156, v124, v156
    v_mul_f32 v157, v125, v157
    v_mul_f32 v158, v126, v158
    v_mul_f32 v159, v127, v159
    v_lshlrev_b32 v42, 1, v0
    v_add_u32 v42, 146880, v42
    v_xor_b32 v43, 1, v42
    s_barrier
    ds_read_b64 v[176:177], v9 offset:5120
    ds_read_b64 v[178:179], v9 offset:15360
    ds_read_b64 v[180:181], v9 offset:25600
    ds_read_b64 v[182:183], v9 offset:35840
    s_waitcnt lgkmcnt(3)
    v_fma_f32 v176, v176, v152, v88
    v_fma_f32 v177, v177, v153, v89
    s_waitcnt lgkmcnt(2)
    v_fma_f32 v178, v178, v154, v90
    v_fma_f32 v179, v179, v155, v91
    s_waitcnt lgkmcnt(1)
    v_fma_f32 v180, v180, v156, v92
    v_fma_f32 v181, v181, v157, v93
    s_waitcnt lgkmcnt(0)
    v_fma_f32 v182, v182, v158, v94
    v_fma_f32 v183, v183, v159, v95
    v_cvt_pk_bf16_f32 v192, v176, v178
    v_cvt_pk_bf16_f32 v193, v180, v182
    v_cvt_pk_bf16_f32 v194, v177, v179
    v_cvt_pk_bf16_f32 v195, v181, v183
    global_store_dwordx2 v68, v[192:193], s[32:33]
    global_store_dwordx2 v69, v[194:195], s[32:33]
    v_exp_f32 v160, v128
    v_exp_f32 v161, v129
    v_exp_f32 v162, v130
    v_exp_f32 v163, v131
    v_exp_f32 v164, v132
    v_exp_f32 v165, v133
    v_exp_f32 v166, v134
    v_exp_f32 v167, v135
    v_add_f32 v160, 1.0, v160
    v_add_f32 v161, 1.0, v161
    v_add_f32 v162, 1.0, v162
    v_add_f32 v163, 1.0, v163
    v_add_f32 v164, 1.0, v164
    v_add_f32 v165, 1.0, v165
    v_add_f32 v166, 1.0, v166
    v_add_f32 v167, 1.0, v167
    v_rcp_f32 v160, v160
    v_rcp_f32 v161, v161
    v_rcp_f32 v162, v162
    v_rcp_f32 v163, v163
    v_rcp_f32 v164, v164
    v_rcp_f32 v165, v165
    v_rcp_f32 v166, v166
    v_rcp_f32 v167, v167
    v_mul_f32 v160, v128, v160
    v_mul_f32 v161, v129, v161
    v_mul_f32 v162, v130, v162
    v_mul_f32 v163, v131, v163
    v_mul_f32 v164, v132, v164
    v_mul_f32 v165, v133, v165
    v_mul_f32 v166, v134, v166
    v_mul_f32 v167, v135, v167
    s_barrier
    s_cmp_lt_u32 s38, 6
    s_cbranch_scc1 L_t6
    s_barrier
    ds_read_u8 v44, v42 offset:1536
    ds_read_u8 v45, v43 offset:1536
    ds_read_b64 v[176:177], v9 offset:7680
    ds_read_b64 v[178:179], v9 offset:17920
    ds_read_b64 v[180:181], v9 offset:28160
    ds_read_b64 v[182:183], v9 offset:38400
    s_waitcnt lgkmcnt(3)
    v_cmp_eq_u32 s[66:67], 0, v44
    v_cmp_eq_u32 s[68:69], 0, v45
    v_pk_fma_f32 v[176:177], v[176:177], v[160:161], v[96:97]
    s_waitcnt lgkmcnt(2)
    v_pk_fma_f32 v[178:179], v[178:179], v[162:163], v[98:99]
    s_waitcnt lgkmcnt(1)
    v_pk_fma_f32 v[180:181], v[180:181], v[164:165], v[100:101]
    s_waitcnt lgkmcnt(0)
    v_pk_fma_f32 v[182:183], v[182:183], v[166:167], v[102:103]
    v_cvt_pk_bf16_f32 v196, v176, v178
    v_cvt_pk_bf16_f32 v197, v180, v182
    v_cvt_pk_bf16_f32 v198, v177, v179
    v_cvt_pk_bf16_f32 v199, v181, v183
    s_mov_b64 exec, s[66:67]
    global_store_dwordx2 v70, v[196:197], s[32:33]
    s_mov_b64 exec, s[68:69]
    global_store_dwordx2 v71, v[198:199], s[32:33]
    s_waitcnt vmcnt(2)
    s_barrier
    s_endpgm
L_t6:
    ds_read_u8 v44, v42 offset:1536
    ds_read_u8 v45, v43 offset:1536
    ds_read_b64 v[176:177], v9 offset:7680
    ds_read_b64 v[178:179], v9 offset:17920
    ds_read_b64 v[180:181], v9 offset:28160
    ds_read_b64 v[182:183], v9 offset:38400
    s_waitcnt lgkmcnt(3)
    v_cmp_eq_u32 s[66:67], 0, v44
    v_cmp_eq_u32 s[68:69], 0, v45
    v_fma_f32 v176, v176, v160, v96
    v_fma_f32 v177, v177, v161, v97
    s_waitcnt lgkmcnt(2)
    v_fma_f32 v178, v178, v162, v98
    v_fma_f32 v179, v179, v163, v99
    s_waitcnt lgkmcnt(1)
    v_fma_f32 v180, v180, v164, v100
    v_fma_f32 v181, v181, v165, v101
    s_waitcnt lgkmcnt(0)
    v_fma_f32 v182, v182, v166, v102
    v_fma_f32 v183, v183, v167, v103
    v_cvt_pk_bf16_f32 v196, v176, v178
    v_cvt_pk_bf16_f32 v197, v180, v182
    v_cvt_pk_bf16_f32 v198, v177, v179
    v_cvt_pk_bf16_f32 v199, v181, v183
    s_mov_b64 exec, s[66:67]
    global_store_dwordx2 v70, v[196:197], s[32:33]
    s_mov_b64 exec, s[68:69]
    global_store_dwordx2 v71, v[198:199], s[32:33]
    s_barrier
    s_waitcnt vmcnt(2)
    s_barrier
    s_endpgm
L_pollA:
    s_mov_b64 exec, vcc
    global_load_dwordx4 v[26:29], v2, s[36:37] offset:-4096 sc1
    global_load_dwordx4 v[30:33], v2, s[36:37] offset:0 sc1
    global_load_dwordx4 v[34:37], v3, s[36:37] offset:-4096 sc1
    global_load_dwordx4 v[38:41], v3, s[36:37] offset:0 sc1
    s_mov_b64 exec, -1
    s_add_u32 s42, s42, 1
    s_waitcnt vmcnt(0)
    v_cmp_ne_u32 s[56:57], s41, v29
    v_cmp_ne_u32 s[58:59], s41, v33
    v_cmp_ne_u32 s[60:61], s41, v37
    v_cmp_ne_u32 vcc, s41, v41
    s_or_b64 s[56:57], s[56:57], s[58:59]
    s_or_b64 s[60:61], s[60:61], vcc
    s_or_b64 vcc, s[56:57], s[60:61]
    s_cbranch_vccz L_pollA_done
    s_cmp_lt_u32 s42, 65536
    s_cbranch_scc1 L_pollA
    s_branch L_pollA_done
L_low:
    s_mov_b32 s42, s62
    s_mul_i32 s48, s38, 3328
    s_add_u32 s48, s48, 127872
    s_mul_i32 s49, s38, 4608
    s_add_u32 s49, s49, 109440
    v_mov_b32 v4, 0
    v_mov_b32 v5, 0
    v_mov_b32 v6, 0
    v_mov_b32 v7, 0
    v_lshl_add_u32 v3, v1, 4, s48
    v_lshl_add_u32 v9, v1, 3, s49
    ds_write_b128 v3, v[4:7]
    ds_write_b128 v3, v[4:7] offset:1024
    ds_write_b128 v3, v[4:7] offset:2048
    ds_write_b128 v3, v[4:7] offset:2304
    ds_write_b64 v9, v[4:5]
    v_lshlrev_b32 v9, 3, v0
    v_add_u32 v9, 147392, v9
    ds_write_b64 v9, v[4:5]
    v_and_b32 v252, 15, v1
    v_lshrrev_b32 v253, 4, v1
    s_and_b32 s50, s38, 3
    s_lshl_b32 s50, s50, 9
    s_lshr_b32 s51, s38, 2
    s_lshl_b32 s51, s51, 8
    s_add_u32 s50, s50, s51
    s_mov_b32 m0, s50
    v_mov_b32 v209, 0x3f80
    ds_write_addtid_b32 v209
    ds_write_addtid_b32 v209 offset:256
    v_and_b32 v200, 31, v1
    v_lshrrev_b32 v201, 5, v1
    v_mul_u32_u24 v208, 2064, v200
    v_lshl_add_u32 v208, v201, 4, v208
    v_add_u32 v208, s50, v208
    v_add_u32 v209, 66048, v208
    v_mov_b32 v207, s63
    v_lshl_add_u32 v207, s38, 1, v207
    global_load_ushort v207, v207, s[20:21]
    s_waitcnt lgkmcnt(0)
    s_bitcmp0_b32 s38, 1
    s_cselect_b32 s44, s44, s45
    s_lshl_b32 s45, s44, 16
    s_and_b32 s44, s44, 4294901760
    s_bitcmp0_b32 s38, 0
    s_cselect_b32 s44, s45, s44
    v_mov_b32 v148, 1069066811
    v_mul_f32 v147, s44, v148
    v_fma_f32 v148, s44, v148, -v147
    v_mov_b32 v149, 0x32a5705f
    v_fma_f32 v148, s44, v149, v148
    v_exp_f32 v147, v147
    v_mul_f32 v148, 0x3f317218, v148
    v_fma_f32 v147, v147, v148, v147
    v_cvt_pk_bf16_f32 v147, v147, v147
    v_and_b32 v148, 4294901760, v147
    v_mul_f32 v149, 1056308720, v148
    s_and_b32 s56, s40, 15
    s_and_b32 s57, s38, 3
    s_lshl2_add_u32 s56, s56, s57
    s_cmp_lt_u32 s40, 16
    s_cselect_b32 s57, 16, 32
    s_cselect_b64 s[66:67], 0xffff, -1
    s_mul_i32 s56, s56, s57
    s_add_u32 s56, s56, 0
    v_and_b32 v5, 31, v1
    v_add_u32 v5, s56, v5
    v_mul_u32_u24 v5, 1152, v5
    s_lshr_b32 s56, s62, 4
    s_lshl_b32 s56, s56, 7
    v_add_u32 v5, s56, v5
    s_mov_b32 exec_lo, s66
    s_mov_b32 exec_hi, 0
    global_load_dword v254, v5, s[4:5]
    s_mov_b64 exec, -1
    s_mov_b32 s60, 0x10001a0a
    s_mov_b32 s61, 0x3e342a20
    s_lshl_b32 s59, s39, 3
    s_lshr_b64 s[60:61], s[60:61], s59
    s_and_b32 s60, s60, 0xff
    s_lshl_b32 s59, s39, 2
    s_lshr_b32 s61, 0xaaaaaa66, s59
    s_and_b32 s61, s61, 15
    s_movk_i32 s59, 10923
    s_cmp_eq_u32 s61, 10
    s_cselect_b32 s59, 6554, s59
    s_cmp_lt_u32 s39, 2
    s_cselect_b32 s65, 24, 16
    s_mul_i32 s65, s65, s38
    s_add_u32 s65, s65, s40
    s_movk_i32 s51, 18
    s_cmp_eq_u32 s61, 10
    s_cselect_b32 s51, 10, s51
    s_sub_u32 s54, 3, s60
    s_and_b32 s54, s54, 7
    s_cmp_ge_u32 s65, s51
    s_cselect_b32 s56, 8, 0
    s_cselect_b32 s57, s51, 0
    s_add_u32 s54, s54, s56
    s_sub_u32 s57, s65, s57
    s_cmp_lt_u32 s57, s51
    s_cselect_b32 s54, s54, 99
    s_cmp_lt_u32 s54, s61
    s_cselect_b64 s[52:53], -1, 1
    s_cselect_b32 s54, s54, 0
    s_cselect_b32 s57, s57, 0
    s_add_u32 s54, s54, s60
    s_lshl_b32 s54, s54, 7
    s_andn2_b32 s56, s57, 1
    s_add_u32 s56, s56, 0
    s_mul_i32 s56, s56, 9216
    s_add_u32 s54, s54, s56
    v_and_b32 v4, 31, v1
    v_mul_u32_u24 v4, 18, v4
    v_lshrrev_b32 v5, 5, v1
    v_add_u32 v4, v4, v5
    v_mul_u32_u24 v4, 9216, v4
    v_add_u32 v4, s54, v4
    s_bitcmp0_b32 s57, 0
    s_cselect_b64 s[56:57], s[26:27], s[28:29]
    s_mov_b64 exec, s[52:53]
    global_load_dword v254, v4, s[56:57]
    s_mov_b64 exec, -1
    s_waitcnt vmcnt(3)
    v_lshlrev_b32 v150, 16, v140
    v_lshlrev_b32 v151, 16, v141
    v_lshlrev_b32 v152, 16, v142
    v_lshlrev_b32 v153, 16, v143
    v_lshlrev_b32 v154, 16, v144
    v_lshlrev_b32 v155, 16, v145
    v_pk_mul_f32 v[150:151], v[150:151], v[148:149] op_sel_hi:[1,0]
    v_mul_f32 v150, 1069066811, v150
    v_mul_f32 v151, 1042479491, v151
    v_mul_f32 v186, 0x41000000, v150
    v_mul_f32 v187, 0x41000000, v151
    v_exp_f32 v186, v186
    v_fract_f32 v187, v187
    v_cos_f32 v158, v187
    v_sin_f32 v159, v187
    v_exp_f32 v190, v150
    v_fract_f32 v191, v151
    v_cos_f32 v156, v191
    v_sin_f32 v157, v191
    v_mul_f32 v194, 0x43800000, v150
    v_mul_f32 v195, 0x43800000, v151
    v_exp_f32 v194, v194
    v_fract_f32 v195, v195
    v_cos_f32 v160, v195
    v_sin_f32 v161, v195
.p2align 3
    v_pk_mul_f32 v[162:163], v[154:155], v[152:153] op_sel:[0,0] op_sel_hi:[0,1]
    v_pk_fma_f32 v[76:77], v[154:155], v[152:153], v[162:163] op_sel:[1,1,0] op_sel_hi:[1,0,1] neg_lo:[0,1,0]
    v_pk_mul_f32 v[158:159], v[158:159], v[186:187] op_sel_hi:[1,0]
    v_pk_mul_f32 v[156:157], v[156:157], v[190:191] op_sel_hi:[1,0]
    v_pk_mul_f32 v[160:161], v[160:161], v[194:195] op_sel_hi:[1,0]
    v_pk_mul_f32 v[76:77], v[76:77], v[148:149] op_sel:[0,1] op_sel_hi:[1,1] neg_hi:[0,1]
    v_pk_mul_f32 v[162:163], v[158:159], v[158:159] op_sel:[0,0] op_sel_hi:[0,1]
    v_pk_fma_f32 v[94:95], v[158:159], v[158:159], v[162:163] op_sel:[1,1,0] op_sel_hi:[1,0,1] neg_lo:[0,1,0]
    v_pk_mul_f32 v[162:163], v[94:95], v[158:159] op_sel:[0,0] op_sel_hi:[0,1]
    v_pk_fma_f32 v[96:97], v[94:95], v[158:159], v[162:163] op_sel:[1,1,0] op_sel_hi:[1,0,1] neg_lo:[0,1,0]
    v_pk_mul_f32 v[162:163], v[96:97], v[158:159] op_sel:[0,0] op_sel_hi:[0,1]
    v_pk_fma_f32 v[98:99], v[96:97], v[158:159], v[162:163] op_sel:[1,1,0] op_sel_hi:[1,0,1] neg_lo:[0,1,0]
    v_cvt_pk_bf16_f32 v164, v158, v159
    v_cvt_pk_bf16_f32 v165, v94, v95
    v_cvt_pk_bf16_f32 v166, v96, v97
    v_cvt_pk_bf16_f32 v167, v98, v99
    ds_write_addtid_b32 v164 offset:2064
    ds_write_addtid_b32 v165 offset:4128
    ds_write_addtid_b32 v166 offset:6192
    ds_write_addtid_b32 v167 offset:8256
    v_pk_mul_f32 v[162:163], v[98:99], v[158:159] op_sel:[0,0] op_sel_hi:[0,1]
    v_pk_fma_f32 v[100:101], v[98:99], v[158:159], v[162:163] op_sel:[1,1,0] op_sel_hi:[1,0,1] neg_lo:[0,1,0]
    v_pk_mul_f32 v[162:163], v[100:101], v[158:159] op_sel:[0,0] op_sel_hi:[0,1]
    v_pk_fma_f32 v[102:103], v[100:101], v[158:159], v[162:163] op_sel:[1,1,0] op_sel_hi:[1,0,1] neg_lo:[0,1,0]
    v_pk_mul_f32 v[162:163], v[102:103], v[158:159] op_sel:[0,0] op_sel_hi:[0,1]
    v_pk_fma_f32 v[104:105], v[102:103], v[158:159], v[162:163] op_sel:[1,1,0] op_sel_hi:[1,0,1] neg_lo:[0,1,0]
    v_pk_mul_f32 v[162:163], v[104:105], v[158:159] op_sel:[0,0] op_sel_hi:[0,1]
    v_pk_fma_f32 v[106:107], v[104:105], v[158:159], v[162:163] op_sel:[1,1,0] op_sel_hi:[1,0,1] neg_lo:[0,1,0]
    v_cvt_pk_bf16_f32 v164, v100, v101
    v_cvt_pk_bf16_f32 v165, v102, v103
    v_cvt_pk_bf16_f32 v166, v104, v105
    v_cvt_pk_bf16_f32 v167, v106, v107
    ds_write_addtid_b32 v164 offset:10320
    ds_write_addtid_b32 v165 offset:12384
    ds_write_addtid_b32 v166 offset:14448
    ds_write_addtid_b32 v167 offset:16512
    v_pk_mul_f32 v[162:163], v[106:107], v[158:159] op_sel:[0,0] op_sel_hi:[0,1]
    v_pk_fma_f32 v[108:109], v[106:107], v[158:159], v[162:163] op_sel:[1,1,0] op_sel_hi:[1,0,1] neg_lo:[0,1,0]
    v_pk_mul_f32 v[162:163], v[108:109], v[158:159] op_sel:[0,0] op_sel_hi:[0,1]
    v_pk_fma_f32 v[110:111], v[108:109], v[158:159], v[162:163] op_sel:[1,1,0] op_sel_hi:[1,0,1] neg_lo:[0,1,0]
    v_pk_mul_f32 v[162:163], v[110:111], v[158:159] op_sel:[0,0] op_sel_hi:[0,1]
    v_pk_fma_f32 v[112:113], v[110:111], v[158:159], v[162:163] op_sel:[1,1,0] op_sel_hi:[1,0,1] neg_lo:[0,1,0]
    v_pk_mul_f32 v[162:163], v[112:113], v[158:159] op_sel:[0,0] op_sel_hi:[0,1]
    v_pk_fma_f32 v[94:95], v[112:113], v[158:159], v[162:163] op_sel:[1,1,0] op_sel_hi:[1,0,1] neg_lo:[0,1,0]
    v_cvt_pk_bf16_f32 v164, v108, v109
    v_cvt_pk_bf16_f32 v165, v110, v111
    v_cvt_pk_bf16_f32 v166, v112, v113
    v_cvt_pk_bf16_f32 v167, v94, v95
    ds_write_addtid_b32 v164 offset:18576
    ds_write_addtid_b32 v165 offset:20640
    ds_write_addtid_b32 v166 offset:22704
    ds_write_addtid_b32 v167 offset:24768
    v_pk_mul_f32 v[162:163], v[94:95], v[158:159] op_sel:[0,0] op_sel_hi:[0,1]
    v_pk_fma_f32 v[96:97], v[94:95], v[158:159], v[162:163] op_sel:[1,1,0] op_sel_hi:[1,0,1] neg_lo:[0,1,0]
    v_pk_mul_f32 v[162:163], v[96:97], v[158:159] op_sel:[0,0] op_sel_hi:[0,1]
    v_pk_fma_f32 v[98:99], v[96:97], v[158:159], v[162:163] op_sel:[1,1,0] op_sel_hi:[1,0,1] neg_lo:[0,1,0]
    v_pk_mul_f32 v[162:163], v[98:99], v[158:159] op_sel:[0,0] op_sel_hi:[0,1]
    v_pk_fma_f32 v[100:101], v[98:99], v[158:159], v[162:163] op_sel:[1,1,0] op_sel_hi:[1,0,1] neg_lo:[0,1,0]
    v_pk_mul_f32 v[162:163], v[100:101], v[158:159] op_sel:[0,0] op_sel_hi:[0,1]
    v_pk_fma_f32 v[102:103], v[100:101], v[158:159], v[162:163] op_sel:[1,1,0] op_sel_hi:[1,0,1] neg_lo:[0,1,0]
    v_cvt_pk_bf16_f32 v164, v96, v97
    v_cvt_pk_bf16_f32 v165, v98, v99
    v_cvt_pk_bf16_f32 v166, v100, v101
    v_cvt_pk_bf16_f32 v167, v102, v103
    ds_write_addtid_b32 v164 offset:26832
    ds_write_addtid_b32 v165 offset:28896
    ds_write_addtid_b32 v166 offset:30960
    ds_write_addtid_b32 v167 offset:33024
    v_pk_mul_f32 v[162:163], v[102:103], v[158:159] op_sel:[0,0] op_sel_hi:[0,1]
    v_pk_fma_f32 v[104:105], v[102:103], v[158:159], v[162:163] op_sel:[1,1,0] op_sel_hi:[1,0,1] neg_lo:[0,1,0]
    v_pk_mul_f32 v[162:163], v[104:105], v[158:159] op_sel:[0,0] op_sel_hi:[0,1]
    v_pk_fma_f32 v[106:107], v[104:105], v[158:159], v[162:163] op_sel:[1,1,0] op_sel_hi:[1,0,1] neg_lo:[0,1,0]
    v_pk_mul_f32 v[162:163], v[106:107], v[158:159] op_sel:[0,0] op_sel_hi:[0,1]
    v_pk_fma_f32 v[108:109], v[106:107], v[158:159], v[162:163] op_sel:[1,1,0] op_sel_hi:[1,0,1] neg_lo:[0,1,0]
    v_pk_mul_f32 v[162:163], v[108:109], v[158:159] op_sel:[0,0] op_sel_hi:[0,1]
    v_pk_fma_f32 v[110:111], v[108:109], v[158:159], v[162:163] op_sel:[1,1,0] op_sel_hi:[1,0,1] neg_lo:[0,1,0]
    v_cvt_pk_bf16_f32 v164, v104, v105
    v_cvt_pk_bf16_f32 v165, v106, v107
    v_cvt_pk_bf16_f32 v166, v108, v109
    v_cvt_pk_bf16_f32 v167, v110, v111
    ds_write_addtid_b32 v164 offset:35088
    ds_write_addtid_b32 v165 offset:37152
    ds_write_addtid_b32 v166 offset:39216
    ds_write_addtid_b32 v167 offset:41280
    v_pk_mul_f32 v[162:163], v[110:111], v[158:159] op_sel:[0,0] op_sel_hi:[0,1]
    v_pk_fma_f32 v[112:113], v[110:111], v[158:159], v[162:163] op_sel:[1,1,0] op_sel_hi:[1,0,1] neg_lo:[0,1,0]
    v_pk_mul_f32 v[162:163], v[112:113], v[158:159] op_sel:[0,0] op_sel_hi:[0,1]
    v_pk_fma_f32 v[94:95], v[112:113], v[158:159], v[162:163] op_sel:[1,1,0] op_sel_hi:[1,0,1] neg_lo:[0,1,0]
    v_pk_mul_f32 v[162:163], v[94:95], v[158:159] op_sel:[0,0] op_sel_hi:[0,1]
    v_pk_fma_f32 v[96:97], v[94:95], v[158:159], v[162:163] op_sel:[1,1,0] op_sel_hi:[1,0,1] neg_lo:[0,1,0]
    v_pk_mul_f32 v[162:163], v[96:97], v[158:159] op_sel:[0,0] op_sel_hi:[0,1]
    v_pk_fma_f32 v[98:99], v[96:97], v[158:159], v[162:163] op_sel:[1,1,0] op_sel_hi:[1,0,1] neg_lo:[0,1,0]
    v_cvt_pk_bf16_f32 v164, v112, v113
    v_cvt_pk_bf16_f32 v165, v94, v95
    v_cvt_pk_bf16_f32 v166, v96, v97
    v_cvt_pk_bf16_f32 v167, v98, v99
    ds_write_addtid_b32 v164 offset:43344
    ds_write_addtid_b32 v165 offset:45408
    ds_write_addtid_b32 v166 offset:47472
    ds_write_addtid_b32 v167 offset:49536
    v_pk_mul_f32 v[162:163], v[98:99], v[158:159] op_sel:[0,0] op_sel_hi:[0,1]
    v_pk_fma_f32 v[100:101], v[98:99], v[158:159], v[162:163] op_sel:[1,1,0] op_sel_hi:[1,0,1] neg_lo:[0,1,0]
    v_pk_mul_f32 v[162:163], v[100:101], v[158:159] op_sel:[0,0] op_sel_hi:[0,1]
    v_pk_fma_f32 v[102:103], v[100:101], v[158:159], v[162:163] op_sel:[1,1,0] op_sel_hi:[1,0,1] neg_lo:[0,1,0]
    v_pk_mul_f32 v[162:163], v[102:103], v[158:159] op_sel:[0,0] op_sel_hi:[0,1]
    v_pk_fma_f32 v[104:105], v[102:103], v[158:159], v[162:163] op_sel:[1,1,0] op_sel_hi:[1,0,1] neg_lo:[0,1,0]
    v_pk_mul_f32 v[162:163], v[104:105], v[158:159] op_sel:[0,0] op_sel_hi:[0,1]
    v_pk_fma_f32 v[106:107], v[104:105], v[158:159], v[162:163] op_sel:[1,1,0] op_sel_hi:[1,0,1] neg_lo:[0,1,0]
    v_cvt_pk_bf16_f32 v164, v100, v101
    v_cvt_pk_bf16_f32 v165, v102, v103
    v_cvt_pk_bf16_f32 v166, v104, v105
    v_cvt_pk_bf16_f32 v167, v106, v107
    ds_write_addtid_b32 v164 offset:51600
    ds_write_addtid_b32 v165 offset:53664
    ds_write_addtid_b32 v166 offset:55728
    ds_write_addtid_b32 v167 offset:57792
    v_pk_mul_f32 v[162:163], v[106:107], v[158:159] op_sel:[0,0] op_sel_hi:[0,1]
    v_pk_fma_f32 v[108:109], v[106:107], v[158:159], v[162:163] op_sel:[1,1,0] op_sel_hi:[1,0,1] neg_lo:[0,1,0]
    v_pk_mul_f32 v[162:163], v[108:109], v[158:159] op_sel:[0,0] op_sel_hi:[0,1]
    v_pk_fma_f32 v[110:111], v[108:109], v[158:159], v[162:163] op_sel:[1,1,0] op_sel_hi:[1,0,1] neg_lo:[0,1,0]
    v_pk_mul_f32 v[162:163], v[110:111], v[158:159] op_sel:[0,0] op_sel_hi:[0,1]
    v_pk_fma_f32 v[112:113], v[110:111], v[158:159], v[162:163] op_sel:[1,1,0] op_sel_hi:[1,0,1] neg_lo:[0,1,0]
    v_cvt_pk_bf16_f32 v164, v108, v109
    v_cvt_pk_bf16_f32 v165, v110, v111
    v_cvt_pk_bf16_f32 v166, v112, v113
    ds_write_addtid_b32 v164 offset:59856
    ds_write_addtid_b32 v165 offset:61920
    ds_write_addtid_b32 v166 offset:63984
    s_add_u32 s52, s50, 45056
    s_mov_b32 m0, s52
.p2align 3
    v_pk_mul_f32 v[162:163], v[76:77], v[156:157] op_sel:[0,0] op_sel_hi:[0,1] neg_hi:[0,1]
    v_pk_fma_f32 v[78:79], v[76:77], v[156:157], v[162:163] op_sel:[1,1,0] op_sel_hi:[1,0,1]
    v_pk_mul_f32 v[162:163], v[78:79], v[156:157] op_sel:[0,0] op_sel_hi:[0,1] neg_hi:[0,1]
    v_pk_fma_f32 v[80:81], v[78:79], v[156:157], v[162:163] op_sel:[1,1,0] op_sel_hi:[1,0,1]
    v_pk_mul_f32 v[162:163], v[80:81], v[156:157] op_sel:[0,0] op_sel_hi:[0,1] neg_hi:[0,1]
    v_pk_fma_f32 v[82:83], v[80:81], v[156:157], v[162:163] op_sel:[1,1,0] op_sel_hi:[1,0,1]
    v_cvt_pk_bf16_f32 v164, v76, v77
    v_cvt_pk_bf16_f32 v165, v78, v79
    v_cvt_pk_bf16_f32 v166, v80, v81
    v_cvt_pk_bf16_f32 v167, v82, v83
    ds_write_addtid_b32 v164 offset:62272
    ds_write_addtid_b32 v165 offset:20992
    ds_write_addtid_b32 v166 offset:23056
    ds_write_addtid_b32 v167 offset:25120
    v_pk_mul_f32 v[162:163], v[82:83], v[156:157] op_sel:[0,0] op_sel_hi:[0,1] neg_hi:[0,1]
    v_pk_fma_f32 v[84:85], v[82:83], v[156:157], v[162:163] op_sel:[1,1,0] op_sel_hi:[1,0,1]
    v_pk_mul_f32 v[162:163], v[84:85], v[156:157] op_sel:[0,0] op_sel_hi:[0,1] neg_hi:[0,1]
    v_pk_fma_f32 v[86:87], v[84:85], v[156:157], v[162:163] op_sel:[1,1,0] op_sel_hi:[1,0,1]
    v_pk_mul_f32 v[162:163], v[86:87], v[156:157] op_sel:[0,0] op_sel_hi:[0,1] neg_hi:[0,1]
    v_pk_fma_f32 v[88:89], v[86:87], v[156:157], v[162:163] op_sel:[1,1,0] op_sel_hi:[1,0,1]
    v_pk_mul_f32 v[162:163], v[88:89], v[156:157] op_sel:[0,0] op_sel_hi:[0,1] neg_hi:[0,1]
    v_pk_fma_f32 v[90:91], v[88:89], v[156:157], v[162:163] op_sel:[1,1,0] op_sel_hi:[1,0,1]
    v_cvt_pk_bf16_f32 v164, v84, v85
    v_cvt_pk_bf16_f32 v165, v86, v87
    v_cvt_pk_bf16_f32 v166, v88, v89
    v_cvt_pk_bf16_f32 v167, v90, v91
    ds_write_addtid_b32 v164 offset:27184
    ds_write_addtid_b32 v165 offset:29248
    ds_write_addtid_b32 v166 offset:31312
    ds_write_addtid_b32 v167 offset:33376
    v_pk_mul_f32 v[162:163], v[90:91], v[156:157] op_sel:[0,0] op_sel_hi:[0,1] neg_hi:[0,1]
    v_pk_fma_f32 v[92:93], v[90:91], v[156:157], v[162:163] op_sel:[1,1,0] op_sel_hi:[1,0,1]
    v_pk_mul_f32 v[162:163], v[80:81], v[160:161] op_sel:[0,0] op_sel_hi:[0,1] neg_hi:[0,1]
    v_pk_fma_f32 v[94:95], v[80:81], v[160:161], v[162:163] op_sel:[1,1,0] op_sel_hi:[1,0,1]
    v_pk_mul_f32 v[162:163], v[84:85], v[160:161] op_sel:[0,0] op_sel_hi:[0,1] neg_hi:[0,1]
    v_pk_fma_f32 v[96:97], v[84:85], v[160:161], v[162:163] op_sel:[1,1,0] op_sel_hi:[1,0,1]
    v_pk_mul_f32 v[162:163], v[88:89], v[160:161] op_sel:[0,0] op_sel_hi:[0,1] neg_hi:[0,1]
    v_pk_fma_f32 v[98:99], v[88:89], v[160:161], v[162:163] op_sel:[1,1,0] op_sel_hi:[1,0,1]
    v_cvt_pk_bf16_f32 v164, v92, v93
    v_cvt_pk_bf16_f32 v165, v94, v95
    v_cvt_pk_bf16_f32 v166, v96, v97
    v_cvt_pk_bf16_f32 v167, v98, v99
    ds_write_addtid_b32 v164 offset:35440
    ds_write_addtid_b32 v165 offset:37504
    ds_write_addtid_b32 v166 offset:39568
    ds_write_addtid_b32 v167 offset:41632
    v_pk_mul_f32 v[162:163], v[92:93], v[160:161] op_sel:[0,0] op_sel_hi:[0,1] neg_hi:[0,1]
    v_pk_fma_f32 v[100:101], v[92:93], v[160:161], v[162:163] op_sel:[1,1,0] op_sel_hi:[1,0,1]
    v_pk_mul_f32 v[162:163], v[96:97], v[160:161] op_sel:[0,0] op_sel_hi:[0,1] neg_hi:[0,1]
    v_pk_fma_f32 v[102:103], v[96:97], v[160:161], v[162:163] op_sel:[1,1,0] op_sel_hi:[1,0,1]
    v_pk_mul_f32 v[162:163], v[100:101], v[160:161] op_sel:[0,0] op_sel_hi:[0,1] neg_hi:[0,1]
    v_pk_fma_f32 v[104:105], v[100:101], v[160:161], v[162:163] op_sel:[1,1,0] op_sel_hi:[1,0,1]
    v_pk_mul_f32 v[162:163], v[102:103], v[160:161] op_sel:[0,0] op_sel_hi:[0,1] neg_hi:[0,1]
    v_pk_fma_f32 v[106:107], v[102:103], v[160:161], v[162:163] op_sel:[1,1,0] op_sel_hi:[1,0,1]
    v_cvt_pk_bf16_f32 v164, v100, v101
    v_cvt_pk_bf16_f32 v165, v102, v103
    v_cvt_pk_bf16_f32 v166, v104, v105
    v_cvt_pk_bf16_f32 v167, v106, v107
    ds_write_addtid_b32 v164 offset:43696
    ds_write_addtid_b32 v165 offset:45760
    ds_write_addtid_b32 v166 offset:47824
    ds_write_addtid_b32 v167 offset:49888
    v_pk_mul_f32 v[162:163], v[104:105], v[160:161] op_sel:[0,0] op_sel_hi:[0,1] neg_hi:[0,1]
    v_pk_fma_f32 v[108:109], v[104:105], v[160:161], v[162:163] op_sel:[1,1,0] op_sel_hi:[1,0,1]
    v_pk_mul_f32 v[162:163], v[108:109], v[160:161] op_sel:[0,0] op_sel_hi:[0,1] neg_hi:[0,1]
    v_pk_fma_f32 v[110:111], v[108:109], v[160:161], v[162:163] op_sel:[1,1,0] op_sel_hi:[1,0,1]
    v_pk_mul_f32 v[162:163], v[110:111], v[160:161] op_sel:[0,0] op_sel_hi:[0,1] neg_hi:[0,1]
    v_pk_fma_f32 v[112:113], v[110:111], v[160:161], v[162:163] op_sel:[1,1,0] op_sel_hi:[1,0,1]
    v_pk_mul_f32 v[162:163], v[112:113], v[160:161] op_sel:[0,0] op_sel_hi:[0,1] neg_hi:[0,1]
    v_pk_fma_f32 v[94:95], v[112:113], v[160:161], v[162:163] op_sel:[1,1,0] op_sel_hi:[1,0,1]
    v_cvt_pk_bf16_f32 v164, v108, v109
    v_cvt_pk_bf16_f32 v165, v110, v111
    v_cvt_pk_bf16_f32 v166, v112, v113
    v_cvt_pk_bf16_f32 v167, v94, v95
    ds_write_addtid_b32 v164 offset:51952
    ds_write_addtid_b32 v165 offset:54016
    ds_write_addtid_b32 v166 offset:56080
    ds_write_addtid_b32 v167 offset:58144
    v_pk_mul_f32 v[162:163], v[94:95], v[160:161] op_sel:[0,0] op_sel_hi:[0,1] neg_hi:[0,1]
    v_pk_fma_f32 v[96:97], v[94:95], v[160:161], v[162:163] op_sel:[1,1,0] op_sel_hi:[1,0,1]
    v_cvt_pk_bf16_f32 v164, v96, v97
    ds_write_addtid_b32 v164 offset:60208
    ds_read_b128 v[4:7], v209 offset:0
    ds_read_b128 v[8:11], v208 offset:0
    ds_read_b128 v[12:15], v209 offset:32
    ds_read_b128 v[16:19], v208 offset:32
    v_and_b32 v150, 4294901760, v140
    v_and_b32 v151, 4294901760, v141
    v_and_b32 v152, 4294901760, v142
    v_and_b32 v153, 4294901760, v143
    v_and_b32 v154, 4294901760, v144
    v_and_b32 v155, 4294901760, v145
    v_pk_mul_f32 v[150:151], v[150:151], v[148:149] op_sel_hi:[1,0]
    v_mul_f32 v150, 1069066811, v150
    v_mul_f32 v151, 1042479491, v151
    v_mul_f32 v186, 0x41000000, v150
    v_mul_f32 v187, 0x41000000, v151
    v_exp_f32 v186, v186
    v_fract_f32 v187, v187
    v_cos_f32 v158, v187
    v_sin_f32 v159, v187
    v_exp_f32 v190, v150
    v_fract_f32 v191, v151
    v_cos_f32 v156, v191
    v_sin_f32 v157, v191
    v_mul_f32 v194, 0x43800000, v150
    v_mul_f32 v195, 0x43800000, v151
    v_exp_f32 v194, v194
    v_fract_f32 v195, v195
    v_cos_f32 v160, v195
    v_sin_f32 v161, v195
    s_add_u32 s52, s50, 256
    s_mov_b32 m0, s52
.p2align 3
    v_pk_mul_f32 v[162:163], v[154:155], v[152:153] op_sel:[0,0] op_sel_hi:[0,1]
    v_pk_fma_f32 v[76:77], v[154:155], v[152:153], v[162:163] op_sel:[1,1,0] op_sel_hi:[1,0,1] neg_lo:[0,1,0]
    v_pk_mul_f32 v[158:159], v[158:159], v[186:187] op_sel_hi:[1,0]
    v_pk_mul_f32 v[156:157], v[156:157], v[190:191] op_sel_hi:[1,0]
    v_pk_mul_f32 v[160:161], v[160:161], v[194:195] op_sel_hi:[1,0]
    v_pk_mul_f32 v[76:77], v[76:77], v[148:149] op_sel:[0,1] op_sel_hi:[1,1] neg_hi:[0,1]
    v_pk_mul_f32 v[162:163], v[158:159], v[158:159] op_sel:[0,0] op_sel_hi:[0,1]
    v_pk_fma_f32 v[94:95], v[158:159], v[158:159], v[162:163] op_sel:[1,1,0] op_sel_hi:[1,0,1] neg_lo:[0,1,0]
    v_pk_mul_f32 v[162:163], v[94:95], v[158:159] op_sel:[0,0] op_sel_hi:[0,1]
    v_pk_fma_f32 v[96:97], v[94:95], v[158:159], v[162:163] op_sel:[1,1,0] op_sel_hi:[1,0,1] neg_lo:[0,1,0]
    v_pk_mul_f32 v[162:163], v[96:97], v[158:159] op_sel:[0,0] op_sel_hi:[0,1]
    v_pk_fma_f32 v[98:99], v[96:97], v[158:159], v[162:163] op_sel:[1,1,0] op_sel_hi:[1,0,1] neg_lo:[0,1,0]
    v_cvt_pk_bf16_f32 v164, v158, v159
    v_cvt_pk_bf16_f32 v165, v94, v95
    v_cvt_pk_bf16_f32 v166, v96, v97
    v_cvt_pk_bf16_f32 v167, v98, v99
    ds_write_addtid_b32 v164 offset:2064
    ds_write_addtid_b32 v165 offset:4128
    ds_write_addtid_b32 v166 offset:6192
    ds_write_addtid_b32 v167 offset:8256
    ds_read_b128 v[20:23], v209 offset:64
    ds_read_b128 v[24:27], v208 offset:64
    ds_read_b128 v[28:31], v209 offset:96
    v_pk_mul_f32 v[162:163], v[98:99], v[158:159] op_sel:[0,0] op_sel_hi:[0,1]
    v_pk_fma_f32 v[100:101], v[98:99], v[158:159], v[162:163] op_sel:[1,1,0] op_sel_hi:[1,0,1] neg_lo:[0,1,0]
    v_pk_mul_f32 v[162:163], v[100:101], v[158:159] op_sel:[0,0] op_sel_hi:[0,1]
    v_pk_fma_f32 v[102:103], v[100:101], v[158:159], v[162:163] op_sel:[1,1,0] op_sel_hi:[1,0,1] neg_lo:[0,1,0]
    v_pk_mul_f32 v[162:163], v[102:103], v[158:159] op_sel:[0,0] op_sel_hi:[0,1]
    v_pk_fma_f32 v[104:105], v[102:103], v[158:159], v[162:163] op_sel:[1,1,0] op_sel_hi:[1,0,1] neg_lo:[0,1,0]
    v_pk_mul_f32 v[162:163], v[104:105], v[158:159] op_sel:[0,0] op_sel_hi:[0,1]
    v_pk_fma_f32 v[106:107], v[104:105], v[158:159], v[162:163] op_sel:[1,1,0] op_sel_hi:[1,0,1] neg_lo:[0,1,0]
    v_cvt_pk_bf16_f32 v164, v100, v101
    v_cvt_pk_bf16_f32 v165, v102, v103
    v_cvt_pk_bf16_f32 v166, v104, v105
    v_cvt_pk_bf16_f32 v167, v106, v107
    ds_write_addtid_b32 v164 offset:10320
    ds_write_addtid_b32 v165 offset:12384
    ds_write_addtid_b32 v166 offset:14448
    ds_write_addtid_b32 v167 offset:16512
    ds_read_b128 v[32:35], v208 offset:96
    ds_read_b128 v[36:39], v209 offset:128
    ds_read_b128 v[40:43], v208 offset:128
    v_pk_mul_f32 v[162:163], v[106:107], v[158:159] op_sel:[0,0] op_sel_hi:[0,1]
    v_pk_fma_f32 v[108:109], v[106:107], v[158:159], v[162:163] op_sel:[1,1,0] op_sel_hi:[1,0,1] neg_lo:[0,1,0]
    v_pk_mul_f32 v[162:163], v[108:109], v[158:159] op_sel:[0,0] op_sel_hi:[0,1]
    v_pk_fma_f32 v[110:111], v[108:109], v[158:159], v[162:163] op_sel:[1,1,0] op_sel_hi:[1,0,1] neg_lo:[0,1,0]
    v_pk_mul_f32 v[162:163], v[110:111], v[158:159] op_sel:[0,0] op_sel_hi:[0,1]
    v_pk_fma_f32 v[112:113], v[110:111], v[158:159], v[162:163] op_sel:[1,1,0] op_sel_hi:[1,0,1] neg_lo:[0,1,0]
    v_pk_mul_f32 v[162:163], v[112:113], v[158:159] op_sel:[0,0] op_sel_hi:[0,1]
    v_pk_fma_f32 v[94:95], v[112:113], v[158:159], v[162:163] op_sel:[1,1,0] op_sel_hi:[1,0,1] neg_lo:[0,1,0]
    v_cvt_pk_bf16_f32 v164, v108, v109
    v_cvt_pk_bf16_f32 v165, v110, v111
    v_cvt_pk_bf16_f32 v166, v112, v113
    v_cvt_pk_bf16_f32 v167, v94, v95
    ds_write_addtid_b32 v164 offset:18576
    ds_write_addtid_b32 v165 offset:20640
    ds_write_addtid_b32 v166 offset:22704
    ds_write_addtid_b32 v167 offset:24768
    ds_read_b128 v[44:47], v209 offset:160
    ds_read_b128 v[48:51], v208 offset:160
    ds_read_b128 v[52:55], v209 offset:192
    v_pk_mul_f32 v[162:163], v[94:95], v[158:159] op_sel:[0,0] op_sel_hi:[0,1]
    v_pk_fma_f32 v[96:97], v[94:95], v[158:159], v[162:163] op_sel:[1,1,0] op_sel_hi:[1,0,1] neg_lo:[0,1,0]
    v_pk_mul_f32 v[162:163], v[96:97], v[158:159] op_sel:[0,0] op_sel_hi:[0,1]
    v_pk_fma_f32 v[98:99], v[96:97], v[158:159], v[162:163] op_sel:[1,1,0] op_sel_hi:[1,0,1] neg_lo:[0,1,0]
    v_pk_mul_f32 v[162:163], v[98:99], v[158:159] op_sel:[0,0] op_sel_hi:[0,1]
    v_pk_fma_f32 v[100:101], v[98:99], v[158:159], v[162:163] op_sel:[1,1,0] op_sel_hi:[1,0,1] neg_lo:[0,1,0]
    v_pk_mul_f32 v[162:163], v[100:101], v[158:159] op_sel:[0,0] op_sel_hi:[0,1]
    v_pk_fma_f32 v[102:103], v[100:101], v[158:159], v[162:163] op_sel:[1,1,0] op_sel_hi:[1,0,1] neg_lo:[0,1,0]
    v_cvt_pk_bf16_f32 v164, v96, v97
    v_cvt_pk_bf16_f32 v165, v98, v99
    v_cvt_pk_bf16_f32 v166, v100, v101
    v_cvt_pk_bf16_f32 v167, v102, v103
    ds_write_addtid_b32 v164 offset:26832
    ds_write_addtid_b32 v165 offset:28896
    ds_write_addtid_b32 v166 offset:30960
    ds_write_addtid_b32 v167 offset:33024
    ds_read_b128 v[56:59], v208 offset:192
    ds_read_b128 v[60:63], v209 offset:224
    ds_read_b128 v[64:67], v208 offset:224
    v_pk_mul_f32 v[162:163], v[102:103], v[158:159] op_sel:[0,0] op_sel_hi:[0,1]
    v_pk_fma_f32 v[104:105], v[102:103], v[158:159], v[162:163] op_sel:[1,1,0] op_sel_hi:[1,0,1] neg_lo:[0,1,0]
    v_pk_mul_f32 v[162:163], v[104:105], v[158:159] op_sel:[0,0] op_sel_hi:[0,1]
    v_pk_fma_f32 v[106:107], v[104:105], v[158:159], v[162:163] op_sel:[1,1,0] op_sel_hi:[1,0,1] neg_lo:[0,1,0]
    v_pk_mul_f32 v[162:163], v[106:107], v[158:159] op_sel:[0,0] op_sel_hi:[0,1]
    v_pk_fma_f32 v[108:109], v[106:107], v[158:159], v[162:163] op_sel:[1,1,0] op_sel_hi:[1,0,1] neg_lo:[0,1,0]
    v_pk_mul_f32 v[162:163], v[108:109], v[158:159] op_sel:[0,0] op_sel_hi:[0,1]
    v_pk_fma_f32 v[110:111], v[108:109], v[158:159], v[162:163] op_sel:[1,1,0] op_sel_hi:[1,0,1] neg_lo:[0,1,0]
    s_waitcnt lgkmcnt(15)
.p2align 3
    v_mfma_f32_32x32x16_bf16 v[224:239], v[4:7], v[8:11], 0
    v_cvt_pk_bf16_f32 v164, v104, v105
    v_cvt_pk_bf16_f32 v165, v106, v107
    v_cvt_pk_bf16_f32 v166, v108, v109
    v_cvt_pk_bf16_f32 v167, v110, v111
    ds_write_addtid_b32 v164 offset:35088
    ds_write_addtid_b32 v165 offset:37152
    ds_write_addtid_b32 v166 offset:39216
    ds_write_addtid_b32 v167 offset:41280
    v_pk_mul_f32 v[162:163], v[110:111], v[158:159] op_sel:[0,0] op_sel_hi:[0,1]
    v_pk_fma_f32 v[112:113], v[110:111], v[158:159], v[162:163] op_sel:[1,1,0] op_sel_hi:[1,0,1] neg_lo:[0,1,0]
    v_pk_mul_f32 v[162:163], v[112:113], v[158:159] op_sel:[0,0] op_sel_hi:[0,1]
    v_pk_fma_f32 v[94:95], v[112:113], v[158:159], v[162:163] op_sel:[1,1,0] op_sel_hi:[1,0,1] neg_lo:[0,1,0]
    v_pk_mul_f32 v[162:163], v[94:95], v[158:159] op_sel:[0,0] op_sel_hi:[0,1]
    v_pk_fma_f32 v[96:97], v[94:95], v[158:159], v[162:163] op_sel:[1,1,0] op_sel_hi:[1,0,1] neg_lo:[0,1,0]
    v_pk_mul_f32 v[162:163], v[96:97], v[158:159] op_sel:[0,0] op_sel_hi:[0,1]
    v_pk_fma_f32 v[98:99], v[96:97], v[158:159], v[162:163] op_sel:[1,1,0] op_sel_hi:[1,0,1] neg_lo:[0,1,0]
.p2align 3
    v_mfma_f32_32x32x16_bf16 v[224:239], v[12:15], v[16:19], v[224:239]
    v_cvt_pk_bf16_f32 v164, v112, v113
    v_cvt_pk_bf16_f32 v165, v94, v95
    v_cvt_pk_bf16_f32 v166, v96, v97
    v_cvt_pk_bf16_f32 v167, v98, v99
    ds_write_addtid_b32 v164 offset:43344
    ds_write_addtid_b32 v165 offset:45408
    ds_write_addtid_b32 v166 offset:47472
    ds_write_addtid_b32 v167 offset:49536
    v_pk_mul_f32 v[162:163], v[98:99], v[158:159] op_sel:[0,0] op_sel_hi:[0,1]
    v_pk_fma_f32 v[100:101], v[98:99], v[158:159], v[162:163] op_sel:[1,1,0] op_sel_hi:[1,0,1] neg_lo:[0,1,0]
    v_pk_mul_f32 v[162:163], v[100:101], v[158:159] op_sel:[0,0] op_sel_hi:[0,1]
    v_pk_fma_f32 v[102:103], v[100:101], v[158:159], v[162:163] op_sel:[1,1,0] op_sel_hi:[1,0,1] neg_lo:[0,1,0]
    v_pk_mul_f32 v[162:163], v[102:103], v[158:159] op_sel:[0,0] op_sel_hi:[0,1]
    v_pk_fma_f32 v[104:105], v[102:103], v[158:159], v[162:163] op_sel:[1,1,0] op_sel_hi:[1,0,1] neg_lo:[0,1,0]
    v_pk_mul_f32 v[162:163], v[104:105], v[158:159] op_sel:[0,0] op_sel_hi:[0,1]
    v_pk_fma_f32 v[106:107], v[104:105], v[158:159], v[162:163] op_sel:[1,1,0] op_sel_hi:[1,0,1] neg_lo:[0,1,0]
.p2align 3
    v_mfma_f32_32x32x16_bf16 v[224:239], v[20:23], v[24:27], v[224:239]
    v_cvt_pk_bf16_f32 v164, v100, v101
    v_cvt_pk_bf16_f32 v165, v102, v103
    v_cvt_pk_bf16_f32 v166, v104, v105
    v_cvt_pk_bf16_f32 v167, v106, v107
    ds_write_addtid_b32 v164 offset:51600
    ds_write_addtid_b32 v165 offset:53664
    ds_write_addtid_b32 v166 offset:55728
    ds_write_addtid_b32 v167 offset:57792
    v_pk_mul_f32 v[162:163], v[106:107], v[158:159] op_sel:[0,0] op_sel_hi:[0,1]
    v_pk_fma_f32 v[108:109], v[106:107], v[158:159], v[162:163] op_sel:[1,1,0] op_sel_hi:[1,0,1] neg_lo:[0,1,0]
    v_pk_mul_f32 v[162:163], v[108:109], v[158:159] op_sel:[0,0] op_sel_hi:[0,1]
    v_pk_fma_f32 v[110:111], v[108:109], v[158:159], v[162:163] op_sel:[1,1,0] op_sel_hi:[1,0,1] neg_lo:[0,1,0]
    v_pk_mul_f32 v[162:163], v[110:111], v[158:159] op_sel:[0,0] op_sel_hi:[0,1]
    v_pk_fma_f32 v[112:113], v[110:111], v[158:159], v[162:163] op_sel:[1,1,0] op_sel_hi:[1,0,1] neg_lo:[0,1,0]
.p2align 3
    v_mfma_f32_32x32x16_bf16 v[224:239], v[28:31], v[32:35], v[224:239]
    v_cvt_pk_bf16_f32 v164, v108, v109
    v_cvt_pk_bf16_f32 v165, v110, v111
    v_cvt_pk_bf16_f32 v166, v112, v113
    ds_write_addtid_b32 v164 offset:59856
    ds_write_addtid_b32 v165 offset:61920
    ds_write_addtid_b32 v166 offset:63984
    s_add_u32 s52, s50, 45312
    s_mov_b32 m0, s52
.p2align 3
    v_pk_mul_f32 v[162:163], v[76:77], v[156:157] op_sel:[0,0] op_sel_hi:[0,1] neg_hi:[0,1]
    v_pk_fma_f32 v[78:79], v[76:77], v[156:157], v[162:163] op_sel:[1,1,0] op_sel_hi:[1,0,1]
    v_pk_mul_f32 v[162:163], v[78:79], v[156:157] op_sel:[0,0] op_sel_hi:[0,1] neg_hi:[0,1]
    v_pk_fma_f32 v[80:81], v[78:79], v[156:157], v[162:163] op_sel:[1,1,0] op_sel_hi:[1,0,1]
    v_pk_mul_f32 v[162:163], v[80:81], v[156:157] op_sel:[0,0] op_sel_hi:[0,1] neg_hi:[0,1]
    v_pk_fma_f32 v[82:83], v[80:81], v[156:157], v[162:163] op_sel:[1,1,0] op_sel_hi:[1,0,1]
    s_waitcnt lgkmcnt(15)
.p2align 3
    v_mfma_f32_32x32x16_bf16 v[224:239], v[36:39], v[40:43], v[224:239]
    v_cvt_pk_bf16_f32 v164, v76, v77
    v_cvt_pk_bf16_f32 v165, v78, v79
    v_cvt_pk_bf16_f32 v166, v80, v81
    v_cvt_pk_bf16_f32 v167, v82, v83
    ds_write_addtid_b32 v164 offset:62272
    ds_write_addtid_b32 v165 offset:20992
    ds_write_addtid_b32 v166 offset:23056
    ds_write_addtid_b32 v167 offset:25120
    ds_read_b128 v[68:71], v208 offset:256
    ds_read_b128 v[72:75], v208 offset:288
    ds_read_b128 v[116:119], v208 offset:320
    v_pk_mul_f32 v[162:163], v[82:83], v[156:157] op_sel:[0,0] op_sel_hi:[0,1] neg_hi:[0,1]
    v_pk_fma_f32 v[84:85], v[82:83], v[156:157], v[162:163] op_sel:[1,1,0] op_sel_hi:[1,0,1]
    v_pk_mul_f32 v[162:163], v[84:85], v[156:157] op_sel:[0,0] op_sel_hi:[0,1] neg_hi:[0,1]
    v_pk_fma_f32 v[86:87], v[84:85], v[156:157], v[162:163] op_sel:[1,1,0] op_sel_hi:[1,0,1]
    v_pk_mul_f32 v[162:163], v[86:87], v[156:157] op_sel:[0,0] op_sel_hi:[0,1] neg_hi:[0,1]
    v_pk_fma_f32 v[88:89], v[86:87], v[156:157], v[162:163] op_sel:[1,1,0] op_sel_hi:[1,0,1]
    v_pk_mul_f32 v[162:163], v[88:89], v[156:157] op_sel:[0,0] op_sel_hi:[0,1] neg_hi:[0,1]
    v_pk_fma_f32 v[90:91], v[88:89], v[156:157], v[162:163] op_sel:[1,1,0] op_sel_hi:[1,0,1]
.p2align 3
    v_mfma_f32_32x32x16_bf16 v[224:239], v[44:47], v[48:51], v[224:239]
    v_cvt_pk_bf16_f32 v164, v84, v85
    v_cvt_pk_bf16_f32 v165, v86, v87
    v_cvt_pk_bf16_f32 v166, v88, v89
    v_cvt_pk_bf16_f32 v167, v90, v91
    ds_write_addtid_b32 v164 offset:27184
    ds_write_addtid_b32 v165 offset:29248
    ds_write_addtid_b32 v166 offset:31312
    ds_write_addtid_b32 v167 offset:33376
    ds_read_b128 v[120:123], v208 offset:352
    ds_read_b128 v[124:127], v208 offset:384
    ds_read_b128 v[128:131], v208 offset:416
    v_pk_mul_f32 v[162:163], v[90:91], v[156:157] op_sel:[0,0] op_sel_hi:[0,1] neg_hi:[0,1]
    v_pk_fma_f32 v[92:93], v[90:91], v[156:157], v[162:163] op_sel:[1,1,0] op_sel_hi:[1,0,1]
    v_pk_mul_f32 v[162:163], v[80:81], v[160:161] op_sel:[0,0] op_sel_hi:[0,1] neg_hi:[0,1]
    v_pk_fma_f32 v[94:95], v[80:81], v[160:161], v[162:163] op_sel:[1,1,0] op_sel_hi:[1,0,1]
    v_pk_mul_f32 v[162:163], v[84:85], v[160:161] op_sel:[0,0] op_sel_hi:[0,1] neg_hi:[0,1]
    v_pk_fma_f32 v[96:97], v[84:85], v[160:161], v[162:163] op_sel:[1,1,0] op_sel_hi:[1,0,1]
    v_pk_mul_f32 v[162:163], v[88:89], v[160:161] op_sel:[0,0] op_sel_hi:[0,1] neg_hi:[0,1]
    v_pk_fma_f32 v[98:99], v[88:89], v[160:161], v[162:163] op_sel:[1,1,0] op_sel_hi:[1,0,1]
.p2align 3
    v_mfma_f32_32x32x16_bf16 v[224:239], v[52:55], v[56:59], v[224:239]
    v_cvt_pk_bf16_f32 v164, v92, v93
    v_cvt_pk_bf16_f32 v165, v94, v95
    v_cvt_pk_bf16_f32 v166, v96, v97
    v_cvt_pk_bf16_f32 v167, v98, v99
    ds_write_addtid_b32 v164 offset:35440
    ds_write_addtid_b32 v165 offset:37504
    ds_write_addtid_b32 v166 offset:39568
    ds_write_addtid_b32 v167 offset:41632
    ds_read_b128 v[132:135], v208 offset:448
    ds_read_b128 v[136:139], v208 offset:480
    v_pk_mul_f32 v[162:163], v[92:93], v[160:161] op_sel:[0,0] op_sel_hi:[0,1] neg_hi:[0,1]
    v_pk_fma_f32 v[100:101], v[92:93], v[160:161], v[162:163] op_sel:[1,1,0] op_sel_hi:[1,0,1]
    v_pk_mul_f32 v[162:163], v[96:97], v[160:161] op_sel:[0,0] op_sel_hi:[0,1] neg_hi:[0,1]
    v_pk_fma_f32 v[102:103], v[96:97], v[160:161], v[162:163] op_sel:[1,1,0] op_sel_hi:[1,0,1]
    v_pk_mul_f32 v[162:163], v[100:101], v[160:161] op_sel:[0,0] op_sel_hi:[0,1] neg_hi:[0,1]
    v_pk_fma_f32 v[104:105], v[100:101], v[160:161], v[162:163] op_sel:[1,1,0] op_sel_hi:[1,0,1]
    v_pk_mul_f32 v[162:163], v[102:103], v[160:161] op_sel:[0,0] op_sel_hi:[0,1] neg_hi:[0,1]
    v_pk_fma_f32 v[106:107], v[102:103], v[160:161], v[162:163] op_sel:[1,1,0] op_sel_hi:[1,0,1]
.p2align 3
    v_mfma_f32_32x32x16_bf16 v[224:239], v[60:63], v[64:67], v[224:239]
    v_cvt_pk_bf16_f32 v164, v100, v101
    v_cvt_pk_bf16_f32 v165, v102, v103
    v_cvt_pk_bf16_f32 v166, v104, v105
    v_cvt_pk_bf16_f32 v167, v106, v107
    ds_write_addtid_b32 v164 offset:43696
    ds_write_addtid_b32 v165 offset:45760
    ds_write_addtid_b32 v166 offset:47824
    ds_write_addtid_b32 v167 offset:49888
    v_pk_mul_f32 v[162:163], v[104:105], v[160:161] op_sel:[0,0] op_sel_hi:[0,1] neg_hi:[0,1]
    v_pk_fma_f32 v[108:109], v[104:105], v[160:161], v[162:163] op_sel:[1,1,0] op_sel_hi:[1,0,1]
    v_pk_mul_f32 v[162:163], v[108:109], v[160:161] op_sel:[0,0] op_sel_hi:[0,1] neg_hi:[0,1]
    v_pk_fma_f32 v[110:111], v[108:109], v[160:161], v[162:163] op_sel:[1,1,0] op_sel_hi:[1,0,1]
    v_pk_mul_f32 v[162:163], v[110:111], v[160:161] op_sel:[0,0] op_sel_hi:[0,1] neg_hi:[0,1]
    v_pk_fma_f32 v[112:113], v[110:111], v[160:161], v[162:163] op_sel:[1,1,0] op_sel_hi:[1,0,1]
    v_pk_mul_f32 v[162:163], v[112:113], v[160:161] op_sel:[0,0] op_sel_hi:[0,1] neg_hi:[0,1]
    v_pk_fma_f32 v[94:95], v[112:113], v[160:161], v[162:163] op_sel:[1,1,0] op_sel_hi:[1,0,1]
    v_cvt_pk_bf16_f32 v164, v108, v109
    v_cvt_pk_bf16_f32 v165, v110, v111
    v_cvt_pk_bf16_f32 v166, v112, v113
    v_cvt_pk_bf16_f32 v167, v94, v95
    ds_write_addtid_b32 v164 offset:51952
    ds_write_addtid_b32 v165 offset:54016
    ds_write_addtid_b32 v166 offset:56080
    ds_write_addtid_b32 v167 offset:58144
    v_pk_mul_f32 v[162:163], v[94:95], v[160:161] op_sel:[0,0] op_sel_hi:[0,1] neg_hi:[0,1]
    v_pk_fma_f32 v[96:97], v[94:95], v[160:161], v[162:163] op_sel:[1,1,0] op_sel_hi:[1,0,1]
    v_cvt_pk_bf16_f32 v164, v96, v97
    ds_write_addtid_b32 v164 offset:60208
    ds_read_b128 v[168:171], v209 offset:256
    ds_read_b128 v[172:175], v209 offset:288
    ds_read_b128 v[176:179], v209 offset:320
    ds_read_b128 v[180:183], v209 offset:352
    ds_read_b128 v[184:187], v209 offset:384
    ds_read_b128 v[188:191], v209 offset:416
    ds_read_b128 v[192:195], v209 offset:448
    ds_read_b128 v[196:199], v209 offset:480
    v_lshlrev_b32 v210, 4, v200
    v_lshl_add_u32 v203, v201, 3, v210
    v_sub_u32 v203, s48, v203
    v_add_u32 v203, 512, v203
    v_lshrrev_b32 v210, 1, v200
    v_and_b32 v211, 1, v200
    v_lshlrev_b32 v210, 2, v210
    v_sub_u32 v210, s48, v210
    v_lshl_add_u32 v204, v211, 8, v210
    v_lshl_add_u32 v205, v211, 1, v210
    v_mov_b32 v206, 60
    s_movk_i32 s52, 1088
    s_waitcnt lgkmcnt(7)
.p2align 3
    v_mfma_f32_32x32x16_bf16 v[224:239], v[168:171], v[68:71], v[224:239]
    v_writelane_b32 v206, s52, 32
    s_movk_i32 s52, 574
    v_writelane_b32 v206, s52, 63
    v_add_u32 v206, s48, v206
    v_and_b32 v248, 1, v252
    s_waitcnt lgkmcnt(6)
.p2align 3
    v_mfma_f32_32x32x16_bf16 v[224:239], v[172:175], v[72:75], v[224:239]
    v_mul_u32_u24 v248, 1218, v248
    v_lshlrev_b32 v210, 1, v252
    v_sub_u32 v248, v248, v210
    v_lshl_add_u32 v248, v253, 4, v248
    v_add3_u32 v248, v248, s48, 32
    s_waitcnt lgkmcnt(5)
.p2align 3
    v_mfma_f32_32x32x16_bf16 v[224:239], v[176:179], v[116:119], v[224:239]
    v_add_u32 v249, 512, v248
    v_lshlrev_b32 v250, 2, v252
    v_sub_u32 v250, s48, v250
    v_lshl_add_u32 v250, v253, 4, v250
    v_add_u32 v250, 2492, v250
    s_waitcnt lgkmcnt(4)
.p2align 3
    v_mfma_f32_32x32x16_bf16 v[224:239], v[180:183], v[120:123], v[224:239]
    v_lshlrev_b32 v2, 5, v252
    v_lshl_add_u32 v2, v253, 4, v2
    v_add_u32 v2, s49, v2
    v_mul_u32_u24 v3, 320, v253
    v_lshl_add_u32 v3, v252, 4, v3
    s_waitcnt lgkmcnt(3)
.p2align 3
    v_mfma_f32_32x32x16_bf16 v[224:239], v[184:187], v[124:127], v[224:239]
    s_mul_i32 s52, s38, 10240
    v_add_u32 v3, s52, v3
    v_lshlrev_b32 v252, 4, v1
    v_add_u32 v252, 141184, v252
    v_and_b32 v251, 7, v1
    s_waitcnt lgkmcnt(2)
.p2align 3
    v_mfma_f32_32x32x16_bf16 v[224:239], v[188:191], v[128:131], v[224:239]
    v_lshlrev_b32 v251, 4, v251
    s_lshr_b32 s52, s42, 1
    s_and_b32 s53, s42, 1
    s_and_b32 s54, s52, 1
    s_andn2_b32 s55, s52, 1
    s_waitcnt lgkmcnt(1)
.p2align 3
    v_mfma_f32_32x32x16_bf16 v[224:239], v[192:195], v[132:135], v[224:239]
    s_or_b32 s55, s55, s53
    s_cmp_lt_u32 s42, 128
    s_cselect_b32 s52, s55, s52
    s_cselect_b32 s53, s54, s53
    s_mul_i32 s52, s52, 9216
    s_waitcnt lgkmcnt(0)
.p2align 3
    v_mfma_f32_32x32x16_bf16 v[224:239], v[196:199], v[136:139], v[224:239]
    s_lshl_b32 s53, s53, 6
    s_add_u32 s52, s52, s53
    s_add_u32 s52, s52, 1052672
    v_and_b32 v0, 3, v1
    v_lshl_add_u32 v0, v0, 4, s52
    v_lshrrev_b32 v210, 2, v1
    v_lshl_add_u32 v0, v210, 7, v0
    v_add_u32 v251, 77824, v251
    s_waitcnt vmcnt(2)
    v_mul_u32_u24 v207, v207, v201
    v_lshlrev_b32 v207, 16, v207
    v_mul_f32 v207, 1056308720, v207
    v_cvt_pk_bf16_f32 v164, v227, v226
    v_cvt_pk_bf16_f32 v165, v225, v224
    v_cvt_pk_bf16_f32 v166, v226, v225
    v_add_f32 v232, v232, v207
    v_cvt_pk_bf16_f32 v168, v231, v231
    v_cvt_pk_bf16_f32 v169, v231, v230
    v_cvt_pk_bf16_f32 v170, v229, v229
    v_cvt_pk_bf16_f32 v171, v229, v228
    v_mov_b32 v172, v168
    v_cvt_pk_bf16_f32 v173, v230, v229
    v_mov_b32 v174, v170
    v_cvt_pk_bf16_f32 v176, v232, v233
    v_readlane_b32 s52, v168, 63
    v_readlane_b32 s56, v164, 63
    v_mov_b32 v167, v168
    v_readlane_b32 s57, v176, 32
    v_cvt_pk_bf16_f32 v177, v234, v235
    v_cvt_pk_bf16_f32 v178, v228, v229
    v_cvt_pk_bf16_f32 v179, v230, v231
    v_writelane_b32 v167, s56, 63
    v_writelane_b32 v167, s57, 32
    ds_write_b64 v203, v[164:165] offset:568
    ds_write_b16 v203, v164 offset:1786
    ds_write_b32 v203, v166 offset:1788
    ds_write_b16_d16_hi v203, v165 offset:1792
    s_mov_b32 exec_hi, 0
    ds_write_b128 v203, v[168:171] offset:1264
    ds_write_b16 v203, v168 offset:46
    ds_write_b96 v203, v[172:174] offset:48
    ds_write_b16_d16_hi v203, v171 offset:60
    s_mov_b32 exec_lo, 0x80000000
    s_mov_b32 exec_hi, 0x80000001
    ds_write_b16 v206, v167
    ds_write_b16 v206, v167 offset:1218
    s_mov_b64 exec, -1
    ds_read2_b32 v[32:33], v249 offset0:16 offset1:17
    ds_read2_b32 v[34:35], v249 offset0:18 offset1:19
    ds_read2_b32 v[64:65], v248 offset0:16 offset1:17
    ds_read2_b32 v[66:67], v248 offset0:18 offset1:19
    ds_read2_b32 v[28:29], v249 offset0:32 offset1:33
    ds_read2_b32 v[30:31], v249 offset0:34 offset1:35
    ds_read2_b32 v[60:61], v248 offset0:32 offset1:33
    ds_read2_b32 v[62:63], v248 offset0:34 offset1:35
    ds_read2_b32 v[24:25], v249 offset0:48 offset1:49
    ds_read2_b32 v[26:27], v249 offset0:50 offset1:51
    ds_read2_b32 v[56:57], v248 offset0:48 offset1:49
    ds_read2_b32 v[58:59], v248 offset0:50 offset1:51
    ds_read2_b32 v[20:21], v249 offset0:64 offset1:65
    ds_read2_b32 v[22:23], v249 offset0:66 offset1:67
    ds_read2_b32 v[52:53], v248 offset0:64 offset1:65
    ds_read2_b32 v[54:55], v248 offset0:66 offset1:67
    ds_read2_b32 v[16:17], v249 offset0:80 offset1:81
    ds_read2_b32 v[18:19], v249 offset0:82 offset1:83
    ds_read2_b32 v[48:49], v248 offset0:80 offset1:81
    ds_read2_b32 v[50:51], v248 offset0:82 offset1:83
    ds_read2_b32 v[12:13], v249 offset0:96 offset1:97
    ds_read2_b32 v[14:15], v249 offset0:98 offset1:99
    ds_read2_b32 v[44:45], v248 offset0:96 offset1:97
    ds_read2_b32 v[46:47], v248 offset0:98 offset1:99
    ds_read2_b32 v[8:9], v249 offset0:112 offset1:113
    ds_read2_b32 v[10:11], v249 offset0:114 offset1:115
    ds_read2_b32 v[40:41], v248 offset0:112 offset1:113
    ds_read2_b32 v[42:43], v248 offset0:114 offset1:115
    ds_read2_b32 v[4:5], v249 offset0:128 offset1:129
    ds_read2_b32 v[6:7], v249 offset0:130 offset1:131
    ds_read2_b32 v[36:37], v248 offset0:128 offset1:129
    ds_read2_b32 v[38:39], v248 offset0:130 offset1:131
    s_mov_b32 exec_hi, 0
    ds_write_b16 v205, v176 offset:3196
    ds_write_b16_d16_hi v205, v176 offset:3132
    ds_write_b16 v205, v177 offset:3068
    ds_write_b16_d16_hi v205, v177 offset:3004
    s_mov_b32 exec_lo, 0
    s_mov_b32 exec_hi, -1
    ds_write_b32 v204, v178 offset:2620
    ds_write_b32 v204, v179 offset:2556
    s_mov_b64 exec, -1
    s_barrier
    ds_read_b128 v[184:187], v2 offset:32
    ds_read_b128 v[188:191], v2 offset:96
    ds_read_b128 v[192:195], v2 offset:160
    ds_read_b128 v[196:199], v2 offset:224
    ds_read_b128 v[200:203], v2 offset:288
    ds_read_b128 v[204:207], v2 offset:352
    ds_read_b128 v[208:211], v2 offset:416
    s_waitcnt lgkmcnt(5)
    v_mfma_f32_16x16x32_bf16 v[240:243], v[32:35], v[184:187], 0
    ds_read2_b32 v[68:69], v248 offset0:0 offset1:1
    v_mfma_f32_16x16x32_bf16 v[244:247], v[64:67], v[184:187], 0
    ds_read_b128 v[184:187], v2 offset:480
    v_mfma_f32_16x16x32_bf16 v[240:243], v[28:31], v[188:191], v[240:243]
    ds_read2_b32 v[70:71], v248 offset0:2 offset1:3
    v_mfma_f32_16x16x32_bf16 v[244:247], v[60:63], v[188:191], v[244:247]
    ds_read_b128 v[188:191], v2 offset:464
    s_waitcnt lgkmcnt(5)
    v_mfma_f32_16x16x32_bf16 v[240:243], v[24:27], v[192:195], v[240:243]
    ds_read_b128 v[116:119], v252 offset:0
    v_mfma_f32_16x16x32_bf16 v[244:247], v[56:59], v[192:195], v[244:247]
    ds_read_b128 v[192:195], v2 offset:544
    v_mfma_f32_16x16x32_bf16 v[240:243], v[20:23], v[196:199], v[240:243]
    ds_read_b128 v[120:123], v252 offset:1024
    v_mfma_f32_16x16x32_bf16 v[244:247], v[52:55], v[196:199], v[244:247]
    ds_read_b128 v[196:199], v2 offset:608
    v_mfma_f32_16x16x32_bf16 v[240:243], v[16:19], v[200:203], v[240:243]
    ds_read_b128 v[124:127], v252 offset:2048
    v_mfma_f32_16x16x32_bf16 v[244:247], v[48:51], v[200:203], v[244:247]
    ds_read_b128 v[200:203], v2 offset:672
    v_mfma_f32_16x16x32_bf16 v[240:243], v[12:15], v[204:207], v[240:243]
    ds_read_b128 v[128:131], v252 offset:3072
    v_mfma_f32_16x16x32_bf16 v[244:247], v[44:47], v[204:207], v[244:247]
    ds_read_b128 v[204:207], v2 offset:736
    s_waitcnt lgkmcnt(6)
    v_mfma_f32_16x16x32_bf16 v[240:243], v[8:11], v[208:211], v[240:243]
    ds_read_b128 v[132:135], v252 offset:4096
    v_mfma_f32_16x16x32_bf16 v[244:247], v[40:43], v[208:211], v[244:247]
    ds_read_b128 v[208:211], v2 offset:800
    v_mfma_f32_16x16x32_bf16 v[240:243], v[4:7], v[184:187], v[240:243]
    ds_read_b128 v[72:75], v252 offset:5120
    v_mfma_f32_16x16x32_bf16 v[244:247], v[36:39], v[184:187], v[244:247]
    v_mfma_f32_16x16x32_bf16 v[212:215], v[68:71], v[184:187], 0
    ds_read2_b32 v[76:77], v250 offset0:32 offset1:33
    v_mfma_f32_16x16x32_bf16 v[216:219], v[184:187], v[116:119], 0
    s_waitcnt lgkmcnt(9)
    v_mfma_f32_16x16x32_bf16 v[220:223], v[184:187], v[120:123], 0
    ds_read2_b32 v[78:79], v250 offset0:34 offset1:35
    s_waitcnt lgkmcnt(8)
    v_mfma_f32_16x16x32_bf16 v[224:227], v[184:187], v[124:127], 0
    ds_write_b128 v3, v[240:243] offset:0
    s_waitcnt lgkmcnt(7)
    v_mfma_f32_16x16x32_bf16 v[232:235], v[184:187], v[128:131], 0
    ds_read_b128 v[184:187], v2 offset:864
    v_mfma_f32_16x16x32_bf16 v[228:231], v[188:191], v[120:123], 0
    v_cvt_pk_bf16_f32 v136, v216, v220
    v_cvt_pk_bf16_f32 v137, v217, v221
    s_waitcnt lgkmcnt(6)
    v_mfma_f32_16x16x32_bf16 v[236:239], v[188:191], v[132:135], 0
    ds_read_b128 v[188:191], v2 offset:928
    v_cvt_pk_bf16_f32 v138, v218, v222
    v_mfma_f32_16x16x32_bf16 v[244:247], v[32:35], v[192:195], v[244:247]
    v_cvt_pk_bf16_f32 v139, v219, v223
    v_cvt_pk_bf16_f32 v140, v224, v228
    v_mfma_f32_16x16x32_bf16 v[212:215], v[64:67], v[192:195], v[212:215]
    ds_read_b128 v[192:195], v2 offset:992
    v_cvt_pk_bf16_f32 v141, v225, v229
    v_mfma_f32_16x16x32_bf16 v[244:247], v[28:31], v[196:199], v[244:247]
    v_cvt_pk_bf16_f32 v142, v226, v230
    v_cvt_pk_bf16_f32 v143, v227, v231
    v_mfma_f32_16x16x32_bf16 v[212:215], v[60:63], v[196:199], v[212:215]
    ds_read_b128 v[196:199], v2 offset:976
    v_cvt_pk_bf16_f32 v168, v232, v236
    v_mfma_f32_16x16x32_bf16 v[244:247], v[24:27], v[200:203], v[244:247]
    v_cvt_pk_bf16_f32 v169, v233, v237
    v_cvt_pk_bf16_f32 v170, v234, v238
    v_mfma_f32_16x16x32_bf16 v[212:215], v[56:59], v[200:203], v[212:215]
    ds_read_b128 v[200:203], v2 offset:1056
    v_cvt_pk_bf16_f32 v171, v235, v239
    v_mfma_f32_16x16x32_bf16 v[244:247], v[20:23], v[204:207], v[244:247]
    v_mfma_f32_16x16x32_bf16 v[212:215], v[52:55], v[204:207], v[212:215]
    ds_read_b128 v[204:207], v2 offset:1120
    s_waitcnt lgkmcnt(3)
    v_mfma_f32_16x16x32_bf16 v[244:247], v[16:19], v[208:211], v[244:247]
    v_mfma_f32_16x16x32_bf16 v[212:215], v[48:51], v[208:211], v[212:215]
    ds_read_b128 v[208:211], v2 offset:1184
    v_mfma_f32_16x16x32_bf16 v[244:247], v[12:15], v[184:187], v[244:247]
    v_mfma_f32_16x16x32_bf16 v[212:215], v[44:47], v[184:187], v[212:215]
    ds_read_b128 v[184:187], v2 offset:1248
    v_mfma_f32_16x16x32_bf16 v[244:247], v[8:11], v[188:191], v[244:247]
    v_mfma_f32_16x16x32_bf16 v[212:215], v[40:43], v[188:191], v[212:215]
    ds_read_b128 v[188:191], v2 offset:1312
    v_mfma_f32_16x16x32_bf16 v[244:247], v[4:7], v[192:195], v[244:247]
    v_mfma_f32_16x16x32_bf16 v[212:215], v[36:39], v[192:195], v[212:215]
    ds_read2_b32 v[88:89], v250 offset0:96 offset1:97
    v_mfma_f32_16x16x32_bf16 v[240:243], v[68:71], v[192:195], 0
    v_mfma_f32_16x16x32_bf16 v[216:219], v[192:195], v[116:119], 0
    ds_read2_b32 v[90:91], v250 offset0:98 offset1:99
    v_mfma_f32_16x16x32_bf16 v[220:223], v[192:195], v[120:123], 0
    v_mfma_f32_16x16x32_bf16 v[224:227], v[192:195], v[124:127], 0
    v_mfma_f32_16x16x32_bf16 v[232:235], v[192:195], v[128:131], 0
    ds_write_b128 v3, v[244:247] offset:1280
    s_waitcnt lgkmcnt(3)
    v_mfma_f32_16x16x32_bf16 v[228:231], v[196:199], v[120:123], 0
    ds_read_b128 v[192:195], v2 offset:1376
    v_mfma_f32_16x16x32_bf16 v[236:239], v[196:199], v[132:135], 0
    ds_read_b128 v[196:199], v2 offset:1440
    v_cvt_pk_bf16_f32 v144, v216, v220
    v_mfma_f32_16x16x32_bf16 v[212:215], v[32:35], v[200:203], v[212:215]
    ds_read2_b32 v[80:81], v250 offset0:16 offset1:17
    v_cvt_pk_bf16_f32 v145, v217, v221
    v_mfma_f32_16x16x32_bf16 v[240:243], v[64:67], v[200:203], v[240:243]
    s_waitcnt lgkmcnt(3)
    s_barrier
    v_mfma_f32_16x16x32_bf16 v[212:215], v[136:139], v[76:79], v[212:215]
    ds_read_b128 v[200:203], v2 offset:1504
    v_cvt_pk_bf16_f32 v146, v218, v222
    v_mfma_f32_16x16x32_bf16 v[212:215], v[28:31], v[204:207], v[212:215]
    v_cvt_pk_bf16_f32 v147, v219, v223
    v_cvt_pk_bf16_f32 v148, v224, v228
    v_mfma_f32_16x16x32_bf16 v[240:243], v[60:63], v[204:207], v[240:243]
    ds_read_b128 v[204:207], v2 offset:1488
    v_cvt_pk_bf16_f32 v149, v225, v229
    v_mfma_f32_16x16x32_bf16 v[212:215], v[140:143], v[88:91], v[212:215]
    v_cvt_pk_bf16_f32 v150, v226, v230
    v_cvt_pk_bf16_f32 v151, v227, v231
    v_mfma_f32_16x16x32_bf16 v[212:215], v[24:27], v[208:211], v[212:215]
    ds_read2_b32 v[82:83], v250 offset0:18 offset1:19
    v_cvt_pk_bf16_f32 v172, v232, v236
    v_mfma_f32_16x16x32_bf16 v[240:243], v[56:59], v[208:211], v[240:243]
    ds_read_b128 v[208:211], v2 offset:1568
    v_cvt_pk_bf16_f32 v173, v233, v237
    v_mfma_f32_16x16x32_bf16 v[212:215], v[20:23], v[184:187], v[212:215]
    ds_read2_b32 v[92:93], v250 offset0:80 offset1:81
    v_cvt_pk_bf16_f32 v174, v234, v238
    v_mfma_f32_16x16x32_bf16 v[240:243], v[52:55], v[184:187], v[240:243]
    ds_read_b128 v[184:187], v2 offset:1632
    v_cvt_pk_bf16_f32 v175, v235, v239
    v_mfma_f32_16x16x32_bf16 v[212:215], v[16:19], v[188:191], v[212:215]
    ds_read2_b32 v[94:95], v250 offset0:82 offset1:83
    v_and_b32 v72, s52, v72
    v_mfma_f32_16x16x32_bf16 v[240:243], v[48:51], v[188:191], v[240:243]
    ds_read_b128 v[188:191], v2 offset:1696
    s_waitcnt lgkmcnt(6)
    v_mfma_f32_16x16x32_bf16 v[212:215], v[12:15], v[192:195], v[212:215]
    ds_read2_b32 v[100:101], v250 offset0:176 offset1:177
    v_and_b32 v73, s52, v73
    v_mfma_f32_16x16x32_bf16 v[240:243], v[44:47], v[192:195], v[240:243]
    ds_read_b128 v[192:195], v2 offset:1760
    v_and_b32 v74, s52, v74
    v_mfma_f32_16x16x32_bf16 v[212:215], v[8:11], v[196:199], v[212:215]
    ds_read2_b32 v[102:103], v250 offset0:178 offset1:179
    v_and_b32 v75, s52, v75
    v_mfma_f32_16x16x32_bf16 v[240:243], v[40:43], v[196:199], v[240:243]
    ds_read_b128 v[196:199], v2 offset:1824
    v_mfma_f32_16x16x32_bf16 v[212:215], v[4:7], v[200:203], v[212:215]
    ds_read2_b32 v[84:85], v250 offset0:0 offset1:1
    v_mfma_f32_16x16x32_bf16 v[240:243], v[36:39], v[200:203], v[240:243]
    v_mfma_f32_16x16x32_bf16 v[244:247], v[68:71], v[200:203], 0
    ds_read2_b32 v[86:87], v250 offset0:2 offset1:3
    v_mfma_f32_16x16x32_bf16 v[216:219], v[200:203], v[116:119], 0
    v_mfma_f32_16x16x32_bf16 v[220:223], v[200:203], v[120:123], 0
    ds_read2_b32 v[96:97], v250 offset0:64 offset1:65
    v_mfma_f32_16x16x32_bf16 v[224:227], v[200:203], v[124:127], 0
    ds_write_b128 v3, v[212:215] offset:2560
    v_mfma_f32_16x16x32_bf16 v[232:235], v[200:203], v[128:131], 0
    ds_read_b128 v[200:203], v2 offset:1888
    v_mfma_f32_16x16x32_bf16 v[228:231], v[204:207], v[120:123], 0
    v_mfma_f32_16x16x32_bf16 v[236:239], v[204:207], v[132:135], 0
    ds_read_b128 v[204:207], v2 offset:1952
    s_waitcnt lgkmcnt(6)
    v_mfma_f32_16x16x32_bf16 v[240:243], v[32:35], v[208:211], v[240:243]
    v_cvt_pk_bf16_f32 v152, v216, v220
    v_cvt_pk_bf16_f32 v153, v217, v221
    v_mfma_f32_16x16x32_bf16 v[244:247], v[64:67], v[208:211], v[244:247]
    ds_read_b128 v[208:211], v2 offset:2016
    v_cvt_pk_bf16_f32 v154, v218, v222
    v_mfma_f32_16x16x32_bf16 v[240:243], v[136:139], v[80:83], v[240:243]
    v_cvt_pk_bf16_f32 v155, v219, v223
    v_cvt_pk_bf16_f32 v156, v224, v228
    v_mfma_f32_16x16x32_bf16 v[240:243], v[28:31], v[184:187], v[240:243]
    ds_read2_b32 v[98:99], v250 offset0:66 offset1:67
    v_cvt_pk_bf16_f32 v157, v225, v229
    v_mfma_f32_16x16x32_bf16 v[244:247], v[60:63], v[184:187], v[244:247]
    ds_read_b128 v[184:187], v2 offset:2000
    v_cvt_pk_bf16_f32 v158, v226, v230
    v_mfma_f32_16x16x32_bf16 v[240:243], v[140:143], v[92:95], v[240:243]
    ds_read2_b32 v[104:105], v250 offset0:160 offset1:161
    v_cvt_pk_bf16_f32 v159, v227, v231
    v_mfma_f32_16x16x32_bf16 v[240:243], v[24:27], v[188:191], v[240:243]
    v_cvt_pk_bf16_f32 v176, v232, v236
    v_cvt_pk_bf16_f32 v177, v233, v237
    v_mfma_f32_16x16x32_bf16 v[244:247], v[56:59], v[188:191], v[244:247]
    ds_read_b128 v[188:191], v2 offset:2080
    v_cvt_pk_bf16_f32 v178, v234, v238
    v_mfma_f32_16x16x32_bf16 v[240:243], v[144:147], v[76:79], v[240:243]
    v_cvt_pk_bf16_f32 v179, v235, v239
    v_mfma_f32_16x16x32_bf16 v[240:243], v[20:23], v[192:195], v[240:243]
    ds_read2_b32 v[106:107], v250 offset0:162 offset1:163
    v_mfma_f32_16x16x32_bf16 v[244:247], v[52:55], v[192:195], v[244:247]
    ds_read_b128 v[192:195], v2 offset:2144
    v_mfma_f32_16x16x32_bf16 v[240:243], v[148:151], v[88:91], v[240:243]
    v_mfma_f32_16x16x32_bf16 v[240:243], v[16:19], v[196:199], v[240:243]
    v_mfma_f32_16x16x32_bf16 v[244:247], v[48:51], v[196:199], v[244:247]
    ds_read_b128 v[196:199], v2 offset:2208
    s_waitcnt lgkmcnt(3)
    v_mfma_f32_16x16x32_bf16 v[240:243], v[12:15], v[200:203], v[240:243]
    v_mfma_f32_16x16x32_bf16 v[244:247], v[44:47], v[200:203], v[244:247]
    ds_read_b128 v[200:203], v2 offset:2272
    v_mfma_f32_16x16x32_bf16 v[240:243], v[8:11], v[204:207], v[240:243]
    v_mfma_f32_16x16x32_bf16 v[244:247], v[40:43], v[204:207], v[244:247]
    ds_read_b128 v[204:207], v2 offset:480
    v_mfma_f32_16x16x32_bf16 v[240:243], v[4:7], v[208:211], v[240:243]
    v_mfma_f32_16x16x32_bf16 v[244:247], v[36:39], v[208:211], v[244:247]
    v_mfma_f32_16x16x32_bf16 v[212:215], v[68:71], v[208:211], 0
    v_mfma_f32_16x16x32_bf16 v[216:219], v[208:211], v[116:119], 0
    v_mfma_f32_16x16x32_bf16 v[220:223], v[208:211], v[120:123], 0
    v_mfma_f32_16x16x32_bf16 v[224:227], v[208:211], v[124:127], 0
    v_mfma_f32_16x16x32_bf16 v[232:235], v[208:211], v[128:131], 0
    ds_read_b128 v[208:211], v2 offset:2336
    v_mfma_f32_16x16x32_bf16 v[228:231], v[184:187], v[120:123], 0
    ds_write_b128 v3, v[240:243] offset:3840
    v_mfma_f32_16x16x32_bf16 v[236:239], v[184:187], v[132:135], 0
    ds_read_b128 v[184:187], v2 offset:2400
    v_mfma_f32_16x16x32_bf16 v[244:247], v[32:35], v[188:191], v[244:247]
    ds_read2_b32 v[108:109], v250 offset0:144 offset1:145
    v_cvt_pk_bf16_f32 v160, v216, v220
    v_mfma_f32_16x16x32_bf16 v[212:215], v[64:67], v[188:191], v[212:215]
    ds_read_b128 v[188:191], v2 offset:2464
    v_cvt_pk_bf16_f32 v161, v217, v221
    v_mfma_f32_16x16x32_bf16 v[244:247], v[168:171], v[100:103], v[244:247]
    s_waitcnt lgkmcnt(3)
    global_load_dwordx4 v[252:255], v251, s[36:37] sc1
    s_barrier
    v_mfma_f32_16x16x32_bf16 v[244:247], v[28:31], v[192:195], v[244:247]
    v_cvt_pk_bf16_f32 v162, v218, v222
    v_cvt_pk_bf16_f32 v163, v219, v223
    v_mfma_f32_16x16x32_bf16 v[212:215], v[60:63], v[192:195], v[212:215]
    ds_read_b128 v[192:195], v2 offset:2528
    v_cvt_pk_bf16_f32 v164, v224, v228
    v_mfma_f32_16x16x32_bf16 v[244:247], v[136:139], v[84:87], v[244:247]
    v_cvt_pk_bf16_f32 v165, v225, v229
    v_cvt_pk_bf16_f32 v166, v226, v230
    v_mfma_f32_16x16x32_bf16 v[244:247], v[24:27], v[196:199], v[244:247]
    ds_read2_b32 v[110:111], v250 offset0:146 offset1:147
    v_cvt_pk_bf16_f32 v167, v227, v231
    v_mfma_f32_16x16x32_bf16 v[212:215], v[56:59], v[196:199], v[212:215]
    ds_read_b128 v[196:199], v2 offset:2512
    v_cvt_pk_bf16_f32 v180, v232, v236
    v_mfma_f32_16x16x32_bf16 v[244:247], v[140:143], v[96:99], v[244:247]
    ds_read2_b32 v[112:113], v250 offset0:128 offset1:129
    v_cvt_pk_bf16_f32 v181, v233, v237
    v_mfma_f32_16x16x32_bf16 v[244:247], v[20:23], v[200:203], v[244:247]
    v_cvt_pk_bf16_f32 v182, v234, v238
    v_cvt_pk_bf16_f32 v183, v235, v239
    v_mfma_f32_16x16x32_bf16 v[212:215], v[52:55], v[200:203], v[212:215]
    ds_read_b128 v[200:203], v2 offset:2592
    v_mfma_f32_16x16x32_bf16 v[244:247], v[144:147], v[80:83], v[244:247]
    v_mfma_f32_16x16x32_bf16 v[244:247], v[72:75], v[204:207], v[244:247]
    ds_read_b128 v[204:207], v2 offset:2656
    v_mfma_f32_16x16x32_bf16 v[244:247], v[16:19], v[208:211], v[244:247]
    v_mfma_f32_16x16x32_bf16 v[212:215], v[48:51], v[208:211], v[212:215]
    ds_read_b128 v[208:211], v2 offset:2720
    v_mfma_f32_16x16x32_bf16 v[244:247], v[148:151], v[92:95], v[244:247]
    s_waitcnt lgkmcnt(2)
    v_mfma_f32_16x16x32_bf16 v[244:247], v[12:15], v[184:187], v[244:247]
    ds_read2_b32 v[114:115], v250 offset0:130 offset1:131
    v_mfma_f32_16x16x32_bf16 v[212:215], v[44:47], v[184:187], v[212:215]
    ds_read_b128 v[184:187], v2 offset:2784
    v_mfma_f32_16x16x32_bf16 v[244:247], v[152:155], v[76:79], v[244:247]
    v_mfma_f32_16x16x32_bf16 v[244:247], v[8:11], v[188:191], v[244:247]
    v_mfma_f32_16x16x32_bf16 v[212:215], v[40:43], v[188:191], v[212:215]
    ds_read_b128 v[188:191], v2 offset:992
    v_mfma_f32_16x16x32_bf16 v[244:247], v[156:159], v[88:91], v[244:247]
    v_mfma_f32_16x16x32_bf16 v[244:247], v[4:7], v[192:195], v[244:247]
    v_mfma_f32_16x16x32_bf16 v[212:215], v[36:39], v[192:195], v[212:215]
    v_mfma_f32_16x16x32_bf16 v[240:243], v[68:71], v[192:195], 0
    v_mfma_f32_16x16x32_bf16 v[216:219], v[192:195], v[116:119], 0
    v_mfma_f32_16x16x32_bf16 v[220:223], v[192:195], v[120:123], 0
    v_mfma_f32_16x16x32_bf16 v[224:227], v[192:195], v[124:127], 0
    ds_read_b128 v[192:195], v2 offset:2848
    v_mfma_f32_16x16x32_bf16 v[228:231], v[196:199], v[120:123], 0
    ds_read_b128 v[196:199], v2 offset:2912
    v_mfma_f32_16x16x32_bf16 v[212:215], v[32:35], v[200:203], v[212:215]
    ds_write_b128 v3, v[244:247] offset:5120
    v_mfma_f32_16x16x32_bf16 v[240:243], v[64:67], v[200:203], v[240:243]
    ds_read_b128 v[200:203], v2 offset:2976
    v_cvt_pk_bf16_f32 v136, v216, v220
    v_mfma_f32_16x16x32_bf16 v[212:215], v[168:171], v[104:107], v[212:215]
    v_cvt_pk_bf16_f32 v137, v217, v221
    v_cvt_pk_bf16_f32 v138, v218, v222
    v_mfma_f32_16x16x32_bf16 v[212:215], v[172:175], v[100:103], v[212:215]
    v_cvt_pk_bf16_f32 v139, v219, v223
    s_waitcnt lgkmcnt(3)
    v_mfma_f32_16x16x32_bf16 v[212:215], v[28:31], v[204:207], v[212:215]
    v_cvt_pk_bf16_f32 v140, v224, v228
    v_cvt_pk_bf16_f32 v141, v225, v229
    v_mfma_f32_16x16x32_bf16 v[240:243], v[60:63], v[204:207], v[240:243]
    ds_read_b128 v[204:207], v2 offset:3040
    v_cvt_pk_bf16_f32 v142, v226, v230
    v_mfma_f32_16x16x32_bf16 v[212:215], v[144:147], v[84:87], v[212:215]
    v_cvt_pk_bf16_f32 v143, v227, v231
    v_mfma_f32_16x16x32_bf16 v[212:215], v[24:27], v[208:211], v[212:215]
    v_mfma_f32_16x16x32_bf16 v[240:243], v[56:59], v[208:211], v[240:243]
    ds_read_b128 v[208:211], v2 offset:3024
    v_mfma_f32_16x16x32_bf16 v[212:215], v[148:151], v[96:99], v[212:215]
    v_mfma_f32_16x16x32_bf16 v[212:215], v[20:23], v[184:187], v[212:215]
    v_mfma_f32_16x16x32_bf16 v[240:243], v[52:55], v[184:187], v[240:243]
    ds_read_b128 v[184:187], v2 offset:3104
    v_mfma_f32_16x16x32_bf16 v[212:215], v[152:155], v[80:83], v[212:215]
    v_mfma_f32_16x16x32_bf16 v[212:215], v[72:75], v[188:191], v[212:215]
    ds_read_b128 v[188:191], v2 offset:3168
    v_mfma_f32_16x16x32_bf16 v[212:215], v[16:19], v[192:195], v[212:215]
    v_mfma_f32_16x16x32_bf16 v[240:243], v[48:51], v[192:195], v[240:243]
    ds_read_b128 v[192:195], v2 offset:3232
    v_mfma_f32_16x16x32_bf16 v[212:215], v[156:159], v[92:95], v[212:215]
    s_waitcnt lgkmcnt(2)
    v_mfma_f32_16x16x32_bf16 v[212:215], v[12:15], v[196:199], v[212:215]
    v_mfma_f32_16x16x32_bf16 v[240:243], v[44:47], v[196:199], v[240:243]
    ds_read_b128 v[196:199], v2 offset:3296
    v_mfma_f32_16x16x32_bf16 v[212:215], v[160:163], v[76:79], v[212:215]
    v_mfma_f32_16x16x32_bf16 v[212:215], v[8:11], v[200:203], v[212:215]
    v_mfma_f32_16x16x32_bf16 v[240:243], v[40:43], v[200:203], v[240:243]
    ds_read_b128 v[200:203], v2 offset:1504
    v_mfma_f32_16x16x32_bf16 v[212:215], v[164:167], v[88:91], v[212:215]
    v_mfma_f32_16x16x32_bf16 v[212:215], v[4:7], v[204:207], v[212:215]
    v_mfma_f32_16x16x32_bf16 v[240:243], v[36:39], v[204:207], v[240:243]
    v_mfma_f32_16x16x32_bf16 v[244:247], v[68:71], v[204:207], 0
    v_mfma_f32_16x16x32_bf16 v[216:219], v[204:207], v[116:119], 0
    v_mfma_f32_16x16x32_bf16 v[220:223], v[204:207], v[120:123], 0
    v_mfma_f32_16x16x32_bf16 v[224:227], v[204:207], v[124:127], 0
    ds_read_b128 v[204:207], v2 offset:3360
    v_mfma_f32_16x16x32_bf16 v[228:231], v[208:211], v[120:123], 0
    ds_read_b128 v[208:211], v2 offset:3424
    v_mfma_f32_16x16x32_bf16 v[240:243], v[32:35], v[184:187], v[240:243]
    ds_write_b128 v3, v[212:215] offset:6400
    v_mfma_f32_16x16x32_bf16 v[244:247], v[64:67], v[184:187], v[244:247]
    ds_read_b128 v[184:187], v2 offset:3488
    v_cvt_pk_bf16_f32 v144, v216, v220
    v_mfma_f32_16x16x32_bf16 v[240:243], v[168:171], v[108:111], v[240:243]
    v_cvt_pk_bf16_f32 v145, v217, v221
    v_cvt_pk_bf16_f32 v146, v218, v222
    v_mfma_f32_16x16x32_bf16 v[240:243], v[172:175], v[104:107], v[240:243]
    v_cvt_pk_bf16_f32 v147, v219, v223
    s_waitcnt lgkmcnt(3)
    v_mfma_f32_16x16x32_bf16 v[240:243], v[28:31], v[188:191], v[240:243]
    s_waitcnt lgkmcnt(1)
    s_barrier
    v_mfma_f32_16x16x32_bf16 v[244:247], v[60:63], v[188:191], v[244:247]
    ds_read_b128 v[188:191], v2 offset:3552
    v_cvt_pk_bf16_f32 v148, v224, v228
    v_mfma_f32_16x16x32_bf16 v[240:243], v[176:179], v[100:103], v[240:243]
    v_cvt_pk_bf16_f32 v149, v225, v229
    v_cvt_pk_bf16_f32 v150, v226, v230
    v_mfma_f32_16x16x32_bf16 v[240:243], v[152:155], v[84:87], v[240:243]
    v_cvt_pk_bf16_f32 v151, v227, v231
    v_mov_b32 v232, 147328
    v_mfma_f32_16x16x32_bf16 v[240:243], v[24:27], v[192:195], v[240:243]
    v_lshrrev_b32 v234, 4, v1
    ds_read_b32 v232, v232
    v_mfma_f32_16x16x32_bf16 v[244:247], v[56:59], v[192:195], v[244:247]
    ds_read_b128 v[192:195], v2 offset:3616
    s_lshl_b32 s44, s42, 3
    v_mfma_f32_16x16x32_bf16 v[240:243], v[156:159], v[96:99], v[240:243]
    v_lshl_add_u32 v235, v234, 1, s44
    v_mul_u32_u24 v236, 4608, v234
    v_mfma_f32_16x16x32_bf16 v[240:243], v[20:23], v[196:199], v[240:243]
    v_mul_u32_u24 v237, 10240, v234
    s_movk_i32 s44, 1152
    v_mfma_f32_16x16x32_bf16 v[244:247], v[52:55], v[196:199], v[244:247]
    ds_read_b128 v[196:199], v2 offset:3680
    s_waitcnt lgkmcnt(2)
    s_waitcnt vmcnt(0)
    v_cmp_ne_u32 vcc, v232, v255
    s_cbranch_vccnz L_pollH
L_pollH_done:
    v_mfma_f32_16x16x32_bf16 v[240:243], v[160:163], v[80:83], v[240:243]
    v_readfirstlane_b32 s41, v232
    v_and_b32 v252, 2047, v252
    v_mfma_f32_16x16x32_bf16 v[240:243], v[72:75], v[200:203], v[240:243]
    ds_read_b128 v[200:203], v2 offset:3744
    v_add_u32 v233, 147392, v252
    v_mfma_f32_16x16x32_bf16 v[240:243], v[16:19], v[204:207], v[240:243]
    v_mov_b32 v232, 1
    v_mad_u32_u24 v235, v252, s44, v235
    v_mfma_f32_16x16x32_bf16 v[244:247], v[48:51], v[204:207], v[244:247]
    ds_read_b128 v[204:207], v2 offset:3808
    ds_write_b8 v233, v232
    v_mfma_f32_16x16x32_bf16 v[240:243], v[164:167], v[92:95], v[240:243]
    v_lshl_add_u32 v236, v252, 1, v236
    v_add_u32 v236, 109952, v236
    v_mfma_f32_16x16x32_bf16 v[240:243], v[12:15], v[208:211], v[240:243]
    v_lshrrev_b32 v239, 8, v252
    v_mul_u32_u24 v239, 1280, v239
    v_mfma_f32_16x16x32_bf16 v[244:247], v[44:47], v[208:211], v[244:247]
    ds_read_b128 v[208:211], v2 offset:2016
    v_add_u32 v237, v237, v239
    v_mfma_f32_16x16x32_bf16 v[240:243], v[136:139], v[76:79], v[240:243]
    v_bfe_u32 v239, v252, 2, 2
    v_mul_u32_u24 v239, 320, v239
    v_mfma_f32_16x16x32_bf16 v[240:243], v[8:11], v[184:187], v[240:243]
    v_add_u32 v237, v237, v239
    v_bfe_u32 v239, v252, 4, 4
    v_mfma_f32_16x16x32_bf16 v[244:247], v[40:43], v[184:187], v[244:247]
    ds_read_b128 v[184:187], v2 offset:3872
    v_lshl_add_u32 v237, v239, 4, v237
    v_mfma_f32_16x16x32_bf16 v[240:243], v[140:143], v[88:91], v[240:243]
    v_and_b32 v239, 3, v252
    v_lshl_add_u32 v237, v239, 2, v237
    v_mfma_f32_16x16x32_bf16 v[240:243], v[4:7], v[188:191], v[240:243]
    v_mul_f32 v254, 4021856827, v254
    v_add_u32 v239, 4096, v0
    v_mfma_f32_16x16x32_bf16 v[244:247], v[36:39], v[188:191], v[244:247]
    ds_read_b128 v[188:191], v2 offset:3936
    s_waitcnt lgkmcnt(2)
    v_mfma_f32_16x16x32_bf16 v[244:247], v[32:35], v[192:195], v[244:247]
    ds_read_b128 v[192:195], v2 offset:4000
    s_mov_b32 s45, 0
    v_mfma_f32_16x16x32_bf16 v[244:247], v[168:171], v[112:115], v[244:247]
    ds_write_b128 v3, v[240:243] offset:7680
    s_lshr_b32 s60, s41, 4
    v_mfma_f32_16x16x32_bf16 v[244:247], v[172:175], v[108:111], v[244:247]
    s_xor_b32 s60, s60, s41
    s_and_b32 s60, s60, 15
    v_mfma_f32_16x16x32_bf16 v[244:247], v[28:31], v[196:199], v[244:247]
    ds_read_b128 v[196:199], v2 offset:4064
    s_cselect_b32 s60, 0, 16
    v_mfma_f32_16x16x32_bf16 v[244:247], v[176:179], v[104:107], v[244:247]
    s_xor_b32 s60, s60, s41
    s_bfe_u32 s56, s60, 0x40000
    v_mfma_f32_16x16x32_bf16 v[244:247], v[180:183], v[100:103], v[244:247]
    s_waitcnt lgkmcnt(1)
    s_barrier
    v_mfma_f32_16x16x32_bf16 v[244:247], v[24:27], v[200:203], v[244:247]
    s_mul_i32 s56, s56, 0x08002000
    s_and_b32 s56, s56, 0x60006000
    v_mfma_f32_16x16x32_bf16 v[244:247], v[160:163], v[84:87], v[244:247]
    s_bfe_u32 s57, s60, 0x40004
    s_mul_i32 s57, s57, 0x08002000
    v_mfma_f32_16x16x32_bf16 v[244:247], v[164:167], v[96:99], v[244:247]
    s_and_b32 s57, s57, 0x60006000
    s_bfe_u32 s58, s60, 0x40008
    v_mfma_f32_16x16x32_bf16 v[244:247], v[20:23], v[204:207], v[244:247]
    s_mul_i32 s58, s58, 0x08002000
    s_and_b32 s58, s58, 0x60006000
    v_mfma_f32_16x16x32_bf16 v[244:247], v[136:139], v[80:83], v[244:247]
    s_bfe_u32 s59, s60, 0x4000c
    s_mul_i32 s59, s59, 0x08002000
    v_mfma_f32_16x16x32_bf16 v[244:247], v[72:75], v[208:211], v[244:247]
    s_and_b32 s59, s59, 0x60006000
    v_mfma_f32_16x16x32_bf16 v[244:247], v[16:19], v[184:187], v[244:247]
    v_mfma_f32_16x16x32_bf16 v[244:247], v[140:143], v[92:95], v[244:247]
    v_mfma_f32_16x16x32_bf16 v[244:247], v[12:15], v[188:191], v[244:247]
    v_mfma_f32_16x16x32_bf16 v[244:247], v[144:147], v[76:79], v[244:247]
    v_mfma_f32_16x16x32_bf16 v[244:247], v[8:11], v[192:195], v[244:247]
    v_mfma_f32_16x16x32_bf16 v[244:247], v[148:151], v[88:91], v[244:247]
    s_waitcnt lgkmcnt(0)
    v_mfma_f32_16x16x32_bf16 v[244:247], v[4:7], v[196:199], v[244:247]
    s_nop 7
    ds_write_b128 v3, v[244:247] offset:8960
    s_waitcnt lgkmcnt(0)
    s_barrier
    s_cmp_lg_u32 s38, 0
    s_cbranch_scc1 L_fin_done
    v_mov_b32 v2, 278528
    s_mov_b64 exec, 1
L_go:
    global_load_dword v3, v2, s[36:37] sc1
    s_add_u32 s45, s45, 1
    s_cmp_ge_u32 s45, 65536
    s_cbranch_scc1 L_go_done
    s_waitcnt vmcnt(0)
    v_cmp_ne_u32 vcc, s41, v3
    s_cbranch_vccnz L_go
L_go_done:
    s_mov_b64 exec, -1
    s_mov_b32 s45, 0
    s_waitcnt vmcnt(0)
    global_load_dwordx4 v[20:23], v0, s[36:37] offset:-4096 sc1
    global_load_dwordx4 v[24:27], v0, s[36:37] offset:-2048 sc1
    global_load_dwordx4 v[28:31], v0, s[36:37] offset:0 sc1
    global_load_dwordx4 v[32:35], v0, s[36:37] offset:2048 sc1
    s_mov_b32 exec_hi, 0
    global_load_dwordx4 v[36:39], v239, s[36:37] sc1
    s_mov_b32 exec_hi, -1
    global_load_ushort v238, v235, s[4:5]
    ds_read_u16 v14, v236
    ds_read_b32 v13, v237
    v_mov_b32 v15, 0x3f80
    v_mov_b32 v16, 1.0
    s_mov_b32 s48, 0xf0f0f0f0
    s_mov_b32 s49, 0xf0f0f0f0
    s_waitcnt vmcnt(5)
    v_xor_b32 v20, s56, v20
    v_xor_b32 v21, s57, v21
    v_xor_b32 v22, s58, v22
    v_xor_b32 v23, s59, v23
    v_or3_b32 v17, 0, v20, v21
    v_or3_b32 v17, v17, v22, v23
    v_dot2_f32_bf16 v44, v20, v15, 0
    v_dot2_f32_bf16 v45, v20, v16, 0
    v_dot2_f32_bf16 v46, v21, v15, 0
    v_dot2_f32_bf16 v47, v21, v16, 0
    v_dot2_f32_bf16 v48, v22, v15, 0
    v_dot2_f32_bf16 v49, v22, v16, 0
    v_dot2_f32_bf16 v50, v23, v15, 0
    v_dot2_f32_bf16 v51, v23, v16, 0
    s_waitcnt vmcnt(4)
    v_xor_b32 v24, s56, v24
    v_xor_b32 v25, s57, v25
    v_xor_b32 v26, s58, v26
    v_xor_b32 v27, s59, v27
    v_or3_b32 v17, v17, v24, v25
    v_or3_b32 v17, v17, v26, v27
    v_dot2_f32_bf16 v44, v24, v15, v44
    v_dot2_f32_bf16 v45, v24, v16, v45
    v_dot2_f32_bf16 v46, v25, v15, v46
    v_dot2_f32_bf16 v47, v25, v16, v47
    v_dot2_f32_bf16 v48, v26, v15, v48
    v_dot2_f32_bf16 v49, v26, v16, v49
    v_dot2_f32_bf16 v50, v27, v15, v50
    v_dot2_f32_bf16 v51, v27, v16, v51
    s_waitcnt vmcnt(3)
    v_xor_b32 v28, s56, v28
    v_xor_b32 v29, s57, v29
    v_xor_b32 v30, s58, v30
    v_xor_b32 v31, s59, v31
    v_or3_b32 v17, v17, v28, v29
    v_or3_b32 v17, v17, v30, v31
    v_dot2_f32_bf16 v44, v28, v15, v44
    v_dot2_f32_bf16 v45, v28, v16, v45
    v_dot2_f32_bf16 v46, v29, v15, v46
    v_dot2_f32_bf16 v47, v29, v16, v47
    v_dot2_f32_bf16 v48, v30, v15, v48
    v_dot2_f32_bf16 v49, v30, v16, v49
    v_dot2_f32_bf16 v50, v31, v15, v50
    v_dot2_f32_bf16 v51, v31, v16, v51
    s_waitcnt vmcnt(2)
    v_xor_b32 v32, s56, v32
    v_xor_b32 v33, s57, v33
    v_xor_b32 v34, s58, v34
    v_xor_b32 v35, s59, v35
    v_or3_b32 v17, v17, v32, v33
    v_or3_b32 v17, v17, v34, v35
    v_dot2_f32_bf16 v44, v32, v15, v44
    v_dot2_f32_bf16 v45, v32, v16, v45
    v_dot2_f32_bf16 v46, v33, v15, v46
    v_dot2_f32_bf16 v47, v33, v16, v47
    v_dot2_f32_bf16 v48, v34, v15, v48
    v_dot2_f32_bf16 v49, v34, v16, v49
    v_dot2_f32_bf16 v50, v35, v15, v50
    v_dot2_f32_bf16 v51, v35, v16, v51
    s_waitcnt vmcnt(1)
    s_mov_b32 exec_hi, 0
    v_xor_b32 v36, s56, v36
    v_xor_b32 v37, s57, v37
    v_xor_b32 v38, s58, v38
    v_xor_b32 v39, s59, v39
    v_or3_b32 v17, v17, v36, v37
    v_or3_b32 v17, v17, v38, v39
    v_dot2_f32_bf16 v44, v36, v15, v44
    v_dot2_f32_bf16 v45, v36, v16, v45
    v_dot2_f32_bf16 v46, v37, v15, v46
    v_dot2_f32_bf16 v47, v37, v16, v47
    v_dot2_f32_bf16 v48, v38, v15, v48
    v_dot2_f32_bf16 v49, v38, v16, v49
    v_dot2_f32_bf16 v50, v39, v15, v50
    v_dot2_f32_bf16 v51, v39, v16, v51
    s_mov_b32 exec_hi, -1
    v_and_b32 v17, 0x60006000, v17
    v_cmp_ne_u32 vcc, 0, v17
    s_cbranch_vccnz L_pollB
L_pollB_done:
    v_permlane32_swap_b32 v44, v48
    v_permlane32_swap_b32 v45, v49
    v_permlane32_swap_b32 v46, v50
    v_permlane32_swap_b32 v47, v51
    v_pk_add_f32 v[44:45], v[44:45], v[48:49]
    v_pk_add_f32 v[46:47], v[46:47], v[50:51]
    s_waitcnt vmcnt(0) lgkmcnt(0)
    v_lshlrev_b32 v14, 16, v14
    v_permlane16_swap_b32 v44, v46
    v_permlane16_swap_b32 v45, v47
    v_pk_add_f32 v[44:45], v[44:45], v[46:47]
    v_lshlrev_b32 v238, 16, v238
    s_mov_b32 s44, 0x00ff00ff
    v_add_f32_dpp v44, v44, v44 row_ror:4 row_mask:0xf bank_mask:0xf
    v_add_f32_dpp v45, v45, v45 row_ror:4 row_mask:0xf bank_mask:0xf
    v_cndmask_b32 v44, v44, v45, s[48:49]
    s_nop 1
    v_add_f32_dpp v44, v44, v44 row_ror:8 row_mask:0xf bank_mask:0xf
    v_fma_f32 v18, v44, v254, v14
    v_exp_f32 v19, v18
    v_mul_f32 v18, v18, v13
    v_add_f32 v19, 1.0, v19
    v_rcp_f32 v19, v19
    s_mov_b32 exec_lo, s44
    s_mov_b32 exec_hi, s44
    v_fma_f32 v18, v18, v19, v238
    v_cvt_pk_bf16_f32 v18, v18, v18
    s_barrier
    global_store_short v235, v18, s[32:33]
    s_cmp_lg_u32 s2, 8
    s_cbranch_scc1 L_fin_done
    s_mov_b64 exec, 1
    v_mov_b32 v2, 0
    v_mov_b32 v3, s41
    global_store_dword v2, v3, s[36:37]
L_fin_done:
    s_endpgm
L_pollB:
    global_load_dwordx4 v[20:23], v0, s[36:37] offset:-4096 sc1
    global_load_dwordx4 v[24:27], v0, s[36:37] offset:-2048 sc1
    global_load_dwordx4 v[28:31], v0, s[36:37] offset:0 sc1
    global_load_dwordx4 v[32:35], v0, s[36:37] offset:2048 sc1
    s_mov_b32 exec_hi, 0
    global_load_dwordx4 v[36:39], v239, s[36:37] sc1
    s_mov_b32 exec_hi, -1
    s_add_u32 s45, s45, 1
    s_waitcnt vmcnt(4)
    v_xor_b32 v20, s56, v20
    v_xor_b32 v21, s57, v21
    v_xor_b32 v22, s58, v22
    v_xor_b32 v23, s59, v23
    v_or3_b32 v17, 0, v20, v21
    v_or3_b32 v17, v17, v22, v23
    v_dot2_f32_bf16 v44, v20, v15, 0
    v_dot2_f32_bf16 v45, v20, v16, 0
    v_dot2_f32_bf16 v46, v21, v15, 0
    v_dot2_f32_bf16 v47, v21, v16, 0
    v_dot2_f32_bf16 v48, v22, v15, 0
    v_dot2_f32_bf16 v49, v22, v16, 0
    v_dot2_f32_bf16 v50, v23, v15, 0
    v_dot2_f32_bf16 v51, v23, v16, 0
    s_waitcnt vmcnt(3)
    v_xor_b32 v24, s56, v24
    v_xor_b32 v25, s57, v25
    v_xor_b32 v26, s58, v26
    v_xor_b32 v27, s59, v27
    v_or3_b32 v17, v17, v24, v25
    v_or3_b32 v17, v17, v26, v27
    v_dot2_f32_bf16 v44, v24, v15, v44
    v_dot2_f32_bf16 v45, v24, v16, v45
    v_dot2_f32_bf16 v46, v25, v15, v46
    v_dot2_f32_bf16 v47, v25, v16, v47
    v_dot2_f32_bf16 v48, v26, v15, v48
    v_dot2_f32_bf16 v49, v26, v16, v49
    v_dot2_f32_bf16 v50, v27, v15, v50
    v_dot2_f32_bf16 v51, v27, v16, v51
    s_waitcnt vmcnt(2)
    v_xor_b32 v28, s56, v28
    v_xor_b32 v29, s57, v29
    v_xor_b32 v30, s58, v30
    v_xor_b32 v31, s59, v31
    v_or3_b32 v17, v17, v28, v29
    v_or3_b32 v17, v17, v30, v31
    v_dot2_f32_bf16 v44, v28, v15, v44
    v_dot2_f32_bf16 v45, v28, v16, v45
    v_dot2_f32_bf16 v46, v29, v15, v46
    v_dot2_f32_bf16 v47, v29, v16, v47
    v_dot2_f32_bf16 v48, v30, v15, v48
    v_dot2_f32_bf16 v49, v30, v16, v49
    v_dot2_f32_bf16 v50, v31, v15, v50
    v_dot2_f32_bf16 v51, v31, v16, v51
    s_waitcnt vmcnt(1)
    v_xor_b32 v32, s56, v32
    v_xor_b32 v33, s57, v33
    v_xor_b32 v34, s58, v34
    v_xor_b32 v35, s59, v35
    v_or3_b32 v17, v17, v32, v33
    v_or3_b32 v17, v17, v34, v35
    v_dot2_f32_bf16 v44, v32, v15, v44
    v_dot2_f32_bf16 v45, v32, v16, v45
    v_dot2_f32_bf16 v46, v33, v15, v46
    v_dot2_f32_bf16 v47, v33, v16, v47
    v_dot2_f32_bf16 v48, v34, v15, v48
    v_dot2_f32_bf16 v49, v34, v16, v49
    v_dot2_f32_bf16 v50, v35, v15, v50
    v_dot2_f32_bf16 v51, v35, v16, v51
    s_waitcnt vmcnt(0)
    s_mov_b32 exec_hi, 0
    v_xor_b32 v36, s56, v36
    v_xor_b32 v37, s57, v37
    v_xor_b32 v38, s58, v38
    v_xor_b32 v39, s59, v39
    v_or3_b32 v17, v17, v36, v37
    v_or3_b32 v17, v17, v38, v39
    v_dot2_f32_bf16 v44, v36, v15, v44
    v_dot2_f32_bf16 v45, v36, v16, v45
    v_dot2_f32_bf16 v46, v37, v15, v46
    v_dot2_f32_bf16 v47, v37, v16, v47
    v_dot2_f32_bf16 v48, v38, v15, v48
    v_dot2_f32_bf16 v49, v38, v16, v49
    v_dot2_f32_bf16 v50, v39, v15, v50
    v_dot2_f32_bf16 v51, v39, v16, v51
    s_mov_b32 exec_hi, -1
    v_and_b32 v17, 0x60006000, v17
    v_cmp_ne_u32 vcc, 0, v17
    s_mov_b64 exec, -1
    s_cbranch_vccz L_pollB_done
    s_cmp_lt_u32 s45, 65536
    s_cbranch_scc1 L_pollB
    s_branch L_pollB_done
L_pollH:
    s_mov_b32 s45, 0
L_pollH2:
    global_load_dwordx4 v[252:255], v251, s[36:37] sc1
    s_add_u32 s45, s45, 1
    s_waitcnt vmcnt(0)
    v_cmp_ne_u32 vcc, v232, v255
    s_cbranch_vccz L_pollH_done
    s_cmp_lt_u32 s45, 65536
    s_cbranch_scc1 L_pollH2
    s_branch L_pollH_done
L_codeend:
    s_endpgm
.section .rodata,"a"
.p2align 6
.amdhsa_kernel recurrent_scan__ssm_conv_s4__moe_arch_mod__prompt_kernel
  .amdhsa_next_free_vgpr 256
  .amdhsa_next_free_sgpr 96
  .amdhsa_accum_offset 256
  .amdhsa_group_segment_fixed_size 0
  .amdhsa_kernarg_size 136
  .amdhsa_user_sgpr_count 2
  .amdhsa_user_sgpr_kernarg_segment_ptr 1
  .amdhsa_system_sgpr_workgroup_id_x 1
.end_amdhsa_kernel
```

```asm
; @launch grid=(256,1,1) block=(512,1,1) lds=149504
.amdgcn_target "amdgcn-amd-amdhsa--gfx950"
.text
.globl recurrent_scan__ssm_conv_s4__moe_arch_mod__prompt_kernel
.p2align 8
.type recurrent_scan__ssm_conv_s4__moe_arch_mod__prompt_kernel,@function
recurrent_scan__ssm_conv_s4__moe_arch_mod__prompt_kernel:
    s_load_dwordx16 s[4:19], s[0:1], 0
    s_load_dwordx16 s[20:35], s[0:1], 64
    s_load_dwordx2 s[36:37], s[0:1], 128
    v_lshrrev_b32 v2, 6, v0
    s_lshr_b32 s40, s2, 3
    v_readfirstlane_b32 s38, v2
    v_and_b32 v1, 63, v0
    s_and_b32 s39, s2, 7
    s_cmp_ge_u32 s2, 256
    s_cbranch_scc1 L_exit0
    s_cmp_lt_u32 s39, 2
    s_cselect_b32 s43, 24, 16
    s_sub_u32 s63, s40, s43
    s_lshl4_add_u32 s62, s39, s40
    s_lshl3_add_u32 s43, s39, s40
    s_add_u32 s43, s43, 112
    s_cmp_lt_u32 s40, 16
    s_cselect_b32 s62, s62, s43
    s_cmp_lt_u32 s38, 4
    s_cbranch_scc1 L_lo
    s_andn2_b32 s42, s2, 15
    s_lshl1_add_u32 s42, s39, s42
    s_and_b32 s43, s40, 1
    s_add_u32 s42, s42, s43
    s_lshl_b32 s42, s42, 3
    v_lshrrev_b32 v3, 5, v0
    v_add3_u32 v3, s42, v3, -8
    v_mul_u32_u24 v4, 1152, v3
    v_and_b32 v5, 31, v1
    v_lshlrev_b32 v8, 4, v5
    v_lshlrev_b32 v9, 2, v5
    v_add_u32 v6, v8, v4
    v_add_u32 v4, v9, v4
    s_waitcnt lgkmcnt(0)
    global_load_dwordx4 v[72:75], v6, s[4:5]
    global_load_dwordx4 v[76:79], v6, s[4:5] offset:512
    global_load_dword v80, v4, s[4:5] offset:1024
    global_load_dwordx4 v[84:87], v8, s[24:25]
    global_load_dwordx4 v[88:91], v8, s[24:25] offset:512
    global_load_dword v92, v9, s[24:25] offset:1024
    s_load_dword s41, s[36:37], 0
    s_branch L_ln2
L_exit0:
    s_endpgm
L_lo:
    s_cmp_ge_i32 s63, 0
    s_cbranch_scc1 L_roles
L_conv:
    s_getpc_b64 s[42:43]
    s_and_b32 s44, s40, 15
    s_lshl2_add_u32 s44, s44, s38
    s_mul_i32 s44, s44, 5
    v_add_u32 v4, s44, v1
    v_min_u32 v4, (L_codeend-L_conv-256)/128, v4
    v_lshlrev_b32 v4, 7, v4
    v_mov_b32 v5, 0
    v_lshl_add_u64 v[4:5], v[4:5], 0, s[42:43]
    s_mov_b64 exec, 31
    global_load_dword v255, v[4:5], off offset:128
    s_mov_b64 exec, -1
    s_lshl_b32 s63, s62, 3
    s_lshl_b32 s43, s62, 8
    v_add_lshl_u32 v2, v0, s43, 2
    v_mov_b32 v6, 0
    v_mov_b32 v4, 147328
    ds_write_b32 v4, v6 offset:4
    s_waitcnt lgkmcnt(0)
    s_load_dwordx2 s[44:45], s[18:19], s63
    global_load_dword v140, v2, s[6:7]
    global_load_dword v141, v2, s[8:9]
    global_load_dword v142, v2, s[10:11]
    global_load_dword v143, v2, s[12:13]
    global_load_dword v144, v2, s[14:15]
    global_load_dword v145, v2, s[16:17]
    s_barrier
    s_branch L_low
L_roles:
    s_waitcnt lgkmcnt(0)
    s_load_dword s41, s[36:37], 0
    s_mov_b32 s64, 1
    s_waitcnt lgkmcnt(0)
    s_mul_i32 s41, s41, 1664525
    s_add_u32 s41, s41, 1013904223
    s_branch L_roles2
L_ln2:
    s_cmp_lt_i32 s63, 0
    s_cbranch_scc1 L_ln3
    s_cmp_eq_u32 s38, 7
    s_cbranch_scc1 L_lnx
    s_branch L_ln4
L_ln3:
    s_barrier
L_ln4:
    s_setprio 3
    v_mov_b32 v46, 0x3f803f80
    v_lshlrev_b32 v3, 3, v3
    v_add_u32 v3, 4088, v3
    s_mov_b32 s64, 0
    s_waitcnt lgkmcnt(0)
    s_mul_i32 s41, s41, 1664525
    s_add_u32 s41, s41, 1013904223
    v_mov_b32 v59, s41
    s_lshr_b32 s52, s41, 4
    s_xor_b32 s52, s52, s41
    s_and_b32 s52, s52, 15
    s_cselect_b32 s52, 0, 16
    s_xor_b32 s52, s52, s41
    s_bfe_u32 s48, s52, 0x40000
    s_mul_i32 s48, s48, 0x08002000
    s_and_b32 s48, s48, 0x60006000
    s_bfe_u32 s49, s52, 0x40004
    s_mul_i32 s49, s49, 0x08002000
    s_and_b32 s49, s49, 0x60006000
    s_bfe_u32 s50, s52, 0x40008
    s_mul_i32 s50, s50, 0x08002000
    s_and_b32 s50, s50, 0x60006000
    s_bfe_u32 s51, s52, 0x4000c
    s_mul_i32 s51, s51, 0x08002000
    s_and_b32 s51, s51, 0x60006000
    s_waitcnt vmcnt(5)
    v_dot2_f32_bf16 v48, v72, v46, 0
    v_dot2_f32_bf16 v49, v72, v72, 0
    v_dot2_f32_bf16 v48, v73, v46, v48
    v_dot2_f32_bf16 v49, v73, v73, v49
    v_dot2_f32_bf16 v48, v74, v46, v48
    v_dot2_f32_bf16 v49, v74, v74, v49
    v_dot2_f32_bf16 v48, v75, v46, v48
    v_dot2_f32_bf16 v49, v75, v75, v49
    s_waitcnt vmcnt(4)
    v_dot2_f32_bf16 v48, v76, v46, v48
    v_dot2_f32_bf16 v49, v76, v76, v49
    v_dot2_f32_bf16 v48, v77, v46, v48
    v_dot2_f32_bf16 v49, v77, v77, v49
    v_dot2_f32_bf16 v48, v78, v46, v48
    v_dot2_f32_bf16 v49, v78, v78, v49
    v_dot2_f32_bf16 v48, v79, v46, v48
    v_dot2_f32_bf16 v49, v79, v79, v49
    s_waitcnt vmcnt(3)
    v_dot2_f32_bf16 v48, v80, v46, v48
    v_dot2_f32_bf16 v49, v80, v80, v49
    s_waitcnt vmcnt(2)
    v_dot2_f32_bf16 v51, v84, v46, 0
    v_dot2_f32_bf16 v50, v72, v84, 0
    v_dot2_f32_bf16 v51, v85, v46, v51
    v_dot2_f32_bf16 v50, v73, v85, v50
    v_dot2_f32_bf16 v51, v86, v46, v51
    v_dot2_f32_bf16 v50, v74, v86, v50
    v_dot2_f32_bf16 v51, v87, v46, v51
    v_dot2_f32_bf16 v50, v75, v87, v50
    s_waitcnt vmcnt(1)
    v_dot2_f32_bf16 v51, v88, v46, v51
    v_dot2_f32_bf16 v50, v76, v88, v50
    v_dot2_f32_bf16 v51, v89, v46, v51
    v_dot2_f32_bf16 v50, v77, v89, v50
    v_dot2_f32_bf16 v51, v90, v46, v51
    v_dot2_f32_bf16 v50, v78, v90, v50
    v_dot2_f32_bf16 v51, v91, v46, v51
    v_dot2_f32_bf16 v50, v79, v91, v50
    s_waitcnt vmcnt(0)
    v_dot2_f32_bf16 v51, v92, v46, v51
    v_dot2_f32_bf16 v50, v80, v92, v50
    v_add_f32_dpp v48, v48, v48 row_ror:8 row_mask:0xf bank_mask:0xf
    v_add_f32_dpp v49, v49, v49 row_ror:8 row_mask:0xf bank_mask:0xf
    v_add_f32_dpp v51, v51, v51 row_ror:8 row_mask:0xf bank_mask:0xf
    v_add_f32_dpp v50, v50, v50 row_ror:8 row_mask:0xf bank_mask:0xf
    v_add_f32_dpp v48, v48, v48 row_ror:4 row_mask:0xf bank_mask:0xf
    v_add_f32_dpp v49, v49, v49 row_ror:4 row_mask:0xf bank_mask:0xf
    v_add_f32_dpp v51, v51, v51 row_ror:4 row_mask:0xf bank_mask:0xf
    v_add_f32_dpp v50, v50, v50 row_ror:4 row_mask:0xf bank_mask:0xf
    v_add_f32_dpp v48, v48, v48 row_ror:2 row_mask:0xf bank_mask:0xf
    v_add_f32_dpp v49, v49, v49 row_ror:2 row_mask:0xf bank_mask:0xf
    v_add_f32_dpp v51, v51, v51 row_ror:2 row_mask:0xf bank_mask:0xf
    v_add_f32_dpp v50, v50, v50 row_ror:2 row_mask:0xf bank_mask:0xf
    v_add_f32_dpp v48, v48, v48 row_ror:1 row_mask:0xf bank_mask:0xf
    v_add_f32_dpp v49, v49, v49 row_ror:1 row_mask:0xf bank_mask:0xf
    v_add_f32_dpp v51, v51, v51 row_ror:1 row_mask:0xf bank_mask:0xf
    v_add_f32_dpp v50, v50, v50 row_ror:1 row_mask:0xf bank_mask:0xf
    v_add_f32_dpp v48, v48, v48 row_bcast:15 row_mask:0xa bank_mask:0xf
    v_add_f32_dpp v49, v49, v49 row_bcast:15 row_mask:0xa bank_mask:0xf
    v_add_f32_dpp v51, v51, v51 row_bcast:15 row_mask:0xa bank_mask:0xf
    v_add_f32_dpp v50, v50, v50 row_bcast:15 row_mask:0xa bank_mask:0xf
    v_mul_f32 v48, 0x3ae38e39, v48
    v_mul_f32 v49, 0x3ae38e39, v49
    v_fma_f32 v49, -v48, v48, v49
    v_max_f32 v49, 0, v49
    v_cvt_pk_bf16_f32 v52, v48, v49
    v_lshlrev_b32 v54, 16, v52
    v_and_b32 v52, 4294901760, v52
    v_add_f32 v52, 0x3727c5ac, v52
    v_cvt_pk_bf16_f32 v52, v52, v52
    v_and_b32 v52, 4294901760, v52
    v_sqrt_f32 v52, v52
    v_fma_f32 v50, -v54, v51, v50
    v_cvt_pk_bf16_f32 v56, v48, v52
    v_and_b32 v53, 4294901760, v56
    v_rcp_f32 v53, v53
    v_mov_b32 v57, v56
    v_mul_f32 v50, v50, v53
    v_cvt_pk_bf16_f32 v55, v50, v50
    v_ashrrev_i32 v61, 31, v55
    v_or_b32 v61, 0x80008000, v61
    v_xor_b32 v60, v55, v61
    v_xor_b32 v55, v55, v61
    v_permlane32_swap_b32 v56, v57
    s_mov_b32 s43, 0x07060100
    v_permlane32_swap_b32 v55, v60
    s_mov_b32 exec_lo, 0
    s_mov_b32 exec_hi, 0x10000
    v_perm_b32 v58, v60, v55, s43
    global_store_dwordx4 v3, v[56:59], s[36:37] sc1
    s_mov_b64 exec, -1
    s_setprio 0
    s_cmp_lt_i32 s63, 0
    s_cbranch_scc1 L_helper
    s_barrier
L_roles2:
    s_mov_b32 s60, 0x10001a0a
    s_mov_b32 s61, 0x3e342a20
    s_lshl_b32 s59, s39, 3
    s_lshr_b64 s[60:61], s[60:61], s59
    s_and_b32 s60, s60, 0xff
    s_lshl_b32 s59, s39, 2
    s_lshr_b32 s61, 0xaaaaaa66, s59
    s_and_b32 s61, s61, 15
    s_movk_i32 s59, 10923
    s_cmp_eq_u32 s61, 10
    s_cselect_b32 s59, 6554, s59
    s_cmp_ge_u32 s63, s61
    s_cbranch_scc1 L_pref
    s_add_u32 s42, s60, s63
    s_cmp_ge_u32 s38, 4
    s_cbranch_scc1 L_dn
    s_lshl_b32 s43, s42, 7
    s_mul_i32 s44, s38, 1327104
    s_add_u32 s43, s43, s44
    v_lshrrev_b32 v2, 5, v1
    v_mul_u32_u24 v2, 331776, v2
    v_bfe_u32 v3, v1, 4, 1
    v_mul_u32_u24 v6, 313344, v3
    v_add_u32 v6, v6, v2
    v_mul_u32_u24 v3, 18432, v3
    v_add3_u32 v2, v2, v3, s43
    v_and_b32 v3, 7, v1
    v_lshl_add_u32 v2, v3, 4, v2
    v_mov_b32 v3, 0
    v_bfe_i32 v4, v1, 3, 1
    v_add_u32 v6, 147456, v6
    v_mov_b32 v7, 0
    s_mov_b32 s48, 9216
    s_mov_b32 s49, 0
    s_mov_b32 s50, 156672
    s_mov_b32 s51, 0
    s_mov_b32 s52, 488448
    s_mov_b32 s53, 0
    s_mov_b32 s54, 4294165504
    s_mov_b32 s55, -1
    s_sub_u32 s46, s28, s26
    s_subb_u32 s47, s29, s27
    v_lshl_add_u64 v[2:3], v[2:3], 0, s[26:27]
    v_and_b32 v5, s47, v4
    v_and_b32 v4, s46, v4
    v_lshl_add_u64 v[2:3], v[2:3], 0, v[4:5]
    v_lshl_add_u64 v[4:5], v[2:3], 0, v[6:7]
    global_load_dwordx4 v[72:75], v[2:3], off nt
    v_lshl_add_u64 v[2:3], v[2:3], 0, s[48:49]
    global_load_dwordx4 v[76:79], v[2:3], off nt
    v_lshl_add_u64 v[2:3], v[2:3], 0, s[50:51]
    global_load_dwordx4 v[80:83], v[2:3], off nt
    v_lshl_add_u64 v[2:3], v[2:3], 0, s[48:49]
    global_load_dwordx4 v[84:87], v[2:3], off nt
    v_lshl_add_u64 v[2:3], v[2:3], 0, s[52:53]
    global_load_dwordx4 v[104:107], v[2:3], off nt
    v_lshl_add_u64 v[2:3], v[2:3], 0, s[48:49]
    s_barrier
    global_load_dwordx4 v[108:111], v[2:3], off nt
    v_lshl_add_u64 v[2:3], v[2:3], 0, s[50:51]
    global_load_dwordx4 v[112:115], v[2:3], off nt
    v_lshl_add_u64 v[2:3], v[2:3], 0, s[48:49]
    global_load_dwordx4 v[116:119], v[2:3], off nt
    v_lshl_add_u64 v[2:3], v[2:3], 0, s[54:55]
    global_load_dwordx4 v[88:91], v[2:3], off nt
    v_lshl_add_u64 v[2:3], v[2:3], 0, s[48:49]
    global_load_dwordx4 v[92:95], v[2:3], off nt
    v_lshl_add_u64 v[2:3], v[2:3], 0, s[50:51]
    global_load_dwordx4 v[96:99], v[2:3], off nt
    v_lshl_add_u64 v[2:3], v[2:3], 0, s[48:49]
    global_load_dwordx4 v[100:103], v[2:3], off nt
    v_lshl_add_u64 v[2:3], v[2:3], 0, s[52:53]
    global_load_dwordx4 v[120:123], v[2:3], off nt
    v_lshl_add_u64 v[2:3], v[2:3], 0, s[48:49]
    global_load_dwordx4 v[124:127], v[2:3], off nt
    v_lshl_add_u64 v[2:3], v[2:3], 0, s[50:51]
    global_load_dwordx4 v[128:131], v[2:3], off nt
    v_lshl_add_u64 v[2:3], v[2:3], 0, s[48:49]
    global_load_dwordx4 v[132:135], v[2:3], off nt
    v_lshl_add_u64 v[2:3], v[2:3], 0, s[54:55]
    global_load_dwordx4 v[136:139], v[2:3], off nt
    v_lshl_add_u64 v[2:3], v[2:3], 0, s[48:49]
    global_load_dwordx4 v[140:143], v[2:3], off nt
    v_lshl_add_u64 v[2:3], v[2:3], 0, s[50:51]
    global_load_dwordx4 v[144:147], v[2:3], off nt
    v_lshl_add_u64 v[2:3], v[2:3], 0, s[48:49]
    global_load_dwordx4 v[148:151], v[2:3], off nt
    v_lshl_add_u64 v[2:3], v[2:3], 0, s[52:53]
    global_load_dwordx4 v[168:171], v[2:3], off nt
    v_lshl_add_u64 v[2:3], v[2:3], 0, s[48:49]
    global_load_dwordx4 v[172:175], v[2:3], off nt
    v_lshl_add_u64 v[2:3], v[2:3], 0, s[50:51]
    global_load_dwordx4 v[176:179], v[2:3], off nt
    v_lshl_add_u64 v[2:3], v[2:3], 0, s[48:49]
    global_load_dwordx4 v[180:183], v[2:3], off nt
    v_lshl_add_u64 v[2:3], v[2:3], 0, s[54:55]
    s_barrier
    global_load_dwordx4 v[152:155], v[2:3], off nt
    v_lshl_add_u64 v[2:3], v[2:3], 0, s[48:49]
    global_load_dwordx4 v[156:159], v[2:3], off nt
    v_lshl_add_u64 v[2:3], v[2:3], 0, s[50:51]
    global_load_dwordx4 v[160:163], v[2:3], off nt
    v_lshl_add_u64 v[2:3], v[2:3], 0, s[48:49]
    global_load_dwordx4 v[164:167], v[2:3], off nt
    v_lshl_add_u64 v[2:3], v[2:3], 0, s[52:53]
    global_load_dwordx4 v[184:187], v[2:3], off nt
    v_lshl_add_u64 v[2:3], v[2:3], 0, s[48:49]
    global_load_dwordx4 v[188:191], v[2:3], off nt
    v_lshl_add_u64 v[2:3], v[2:3], 0, s[50:51]
    global_load_dwordx4 v[192:195], v[2:3], off nt
    v_lshl_add_u64 v[2:3], v[2:3], 0, s[48:49]
    global_load_dwordx4 v[196:199], v[2:3], off nt
    global_load_dwordx4 v[200:203], v[4:5], off nt
    v_lshl_add_u64 v[4:5], v[4:5], 0, s[48:49]
    global_load_dwordx4 v[204:207], v[4:5], off nt
    v_lshl_add_u64 v[4:5], v[4:5], 0, s[50:51]
    global_load_dwordx4 v[208:211], v[4:5], off nt
    v_lshl_add_u64 v[4:5], v[4:5], 0, s[48:49]
    global_load_dwordx4 v[212:215], v[4:5], off nt
    s_barrier
    v_lshrrev_b32 v252, 4, v1
    v_and_b32 v248, 15, v1
    v_lshlrev_b32 v248, 3, v248
    v_lshl_add_u32 v248, v252, 8, v248
    s_lshl_b32 s44, s38, 10
    v_add_u32 v248, s44, v248
    v_add_u32 v249, 128, v248
    s_and_b32 s44, s38, 1
    s_lshl_b32 s44, s44, 8
    s_and_b32 s45, s38, 2
    s_add_u32 s44, s44, s45
    v_lshl_add_u32 v250, v252, 6, s44
    v_bfe_u32 v252, v1, 3, 1
    v_lshl_add_u32 v250, v252, 9, v250
    v_and_b32 v252, 4, v1
    v_add_u32 v250, v250, v252
    v_and_b32 v252, 1, v1
    v_lshl_add_u32 v250, v252, 3, v250
    v_bfe_u32 v252, v1, 1, 1
    v_lshl_add_u32 v250, v252, 5, v250
    s_mov_b32 s58, 0x6f800000
    v_mul_u32_u24 v251, 0xaaaa, v252
    v_add_u32 v251, 0x4444, v251
    s_mov_b32 s46, 0x05040100
    s_mov_b32 s47, 0x07060302
    s_mul_i32 s44, s38, 3072
    s_lshl_b32 s45, s39, 14
    s_add_u32 s45, s45, 65536
    s_mov_b32 s59, 0
    s_add_u32 s44, s44, 65536
    s_add_u32 s44, s44, s59
    v_lshl_add_u32 v6, v1, 4, s44
    s_lshl_b32 s44, s38, 12
    v_lshl_add_u32 v7, v1, 4, s44
    v_bfe_i32 v253, v1, 1, 1
    v_not_b32 v252, v253
    s_mul_i32 s44, s42, 16
    s_lshl_b32 s45, s38, 15
    s_add_u32 s44, s44, s45
    s_add_u32 s44, s44, 262144
    s_cmp_eq_u32 s42, 11
    s_cselect_b32 s45, 0, 0x20000
    s_add_u32 s44, s44, s45
    v_mov_b32 v230, s44
    v_mov_b32 v231, s41
    s_waitcnt vmcnt(34)
    v_perm_b32 v8, v76, v72, s46
    v_perm_b32 v16, v76, v72, s47
    v_perm_b32 v24, v77, v73, s46
    v_perm_b32 v32, v77, v73, s47
    v_perm_b32 v40, v78, v74, s46
    v_perm_b32 v48, v78, v74, s47
    v_perm_b32 v56, v79, v75, s46
    v_perm_b32 v64, v79, v75, s47
    s_waitcnt vmcnt(32)
    v_perm_b32 v9, v84, v80, s46
    v_perm_b32 v17, v84, v80, s47
    v_perm_b32 v25, v85, v81, s46
    v_perm_b32 v33, v85, v81, s47
    v_perm_b32 v41, v86, v82, s46
    v_perm_b32 v49, v86, v82, s47
    v_perm_b32 v57, v87, v83, s46
    v_perm_b32 v65, v87, v83, s47
    s_waitcnt vmcnt(30)
    v_perm_b32 v12, v108, v104, s46
    v_perm_b32 v20, v108, v104, s47
    v_perm_b32 v28, v109, v105, s46
    v_perm_b32 v36, v109, v105, s47
    v_perm_b32 v44, v110, v106, s46
    v_perm_b32 v52, v110, v106, s47
    v_perm_b32 v60, v111, v107, s46
    v_perm_b32 v68, v111, v107, s47
    s_waitcnt vmcnt(28)
    v_perm_b32 v13, v116, v112, s46
    v_perm_b32 v21, v116, v112, s47
    v_perm_b32 v29, v117, v113, s46
    v_perm_b32 v37, v117, v113, s47
    v_perm_b32 v45, v118, v114, s46
    v_perm_b32 v53, v118, v114, s47
    v_perm_b32 v61, v119, v115, s46
    v_perm_b32 v69, v119, v115, s47
    s_waitcnt vmcnt(26)
    v_perm_b32 v10, v92, v88, s46
    v_perm_b32 v18, v92, v88, s47
    v_perm_b32 v26, v93, v89, s46
    v_perm_b32 v34, v93, v89, s47
    v_perm_b32 v42, v94, v90, s46
    v_perm_b32 v50, v94, v90, s47
    v_perm_b32 v58, v95, v91, s46
    v_perm_b32 v66, v95, v91, s47
    s_waitcnt vmcnt(24)
    v_perm_b32 v11, v100, v96, s46
    v_perm_b32 v19, v100, v96, s47
    v_perm_b32 v27, v101, v97, s46
    v_perm_b32 v35, v101, v97, s47
    v_perm_b32 v43, v102, v98, s46
    v_perm_b32 v51, v102, v98, s47
    v_perm_b32 v59, v103, v99, s46
    v_perm_b32 v67, v103, v99, s47
    s_waitcnt vmcnt(22)
    v_perm_b32 v14, v124, v120, s46
    v_perm_b32 v22, v124, v120, s47
    v_perm_b32 v30, v125, v121, s46
    v_perm_b32 v38, v125, v121, s47
    v_perm_b32 v46, v126, v122, s46
    v_perm_b32 v54, v126, v122, s47
    v_perm_b32 v62, v127, v123, s46
    v_perm_b32 v70, v127, v123, s47
    s_waitcnt vmcnt(20)
    v_perm_b32 v15, v132, v128, s46
    v_perm_b32 v23, v132, v128, s47
    v_perm_b32 v31, v133, v129, s46
    v_perm_b32 v39, v133, v129, s47
    v_perm_b32 v47, v134, v130, s46
    v_perm_b32 v55, v134, v130, s47
    v_perm_b32 v63, v135, v131, s46
    v_perm_b32 v71, v135, v131, s47
    s_waitcnt vmcnt(18)
    v_perm_b32 v72, v140, v136, s46
    v_perm_b32 v80, v140, v136, s47
    v_perm_b32 v88, v141, v137, s46
    v_perm_b32 v96, v141, v137, s47
    v_perm_b32 v104, v142, v138, s46
    v_perm_b32 v112, v142, v138, s47
    v_perm_b32 v120, v143, v139, s46
    v_perm_b32 v128, v143, v139, s47
    s_waitcnt vmcnt(16)
    v_perm_b32 v73, v148, v144, s46
    v_perm_b32 v81, v148, v144, s47
    v_perm_b32 v89, v149, v145, s46
    v_perm_b32 v97, v149, v145, s47
    v_perm_b32 v105, v150, v146, s46
    v_perm_b32 v113, v150, v146, s47
    v_perm_b32 v121, v151, v147, s46
    v_perm_b32 v129, v151, v147, s47
    s_waitcnt vmcnt(14)
    v_perm_b32 v76, v172, v168, s46
    v_perm_b32 v84, v172, v168, s47
    v_perm_b32 v92, v173, v169, s46
    v_perm_b32 v100, v173, v169, s47
    v_perm_b32 v108, v174, v170, s46
    v_perm_b32 v116, v174, v170, s47
    v_perm_b32 v124, v175, v171, s46
    v_perm_b32 v132, v175, v171, s47
    s_waitcnt vmcnt(12)
    v_perm_b32 v77, v180, v176, s46
    v_perm_b32 v85, v180, v176, s47
    v_perm_b32 v93, v181, v177, s46
    v_perm_b32 v101, v181, v177, s47
    v_perm_b32 v109, v182, v178, s46
    v_perm_b32 v117, v182, v178, s47
    v_perm_b32 v125, v183, v179, s46
    v_perm_b32 v133, v183, v179, s47
    s_waitcnt vmcnt(10)
    s_setprio 3
    global_load_dwordx4 v[216:219], v6, s[36:37] offset:0 sc1
    global_load_dwordx4 v[220:223], v6, s[36:37] offset:1024 sc1
    global_load_dwordx4 v[224:227], v6, s[36:37] offset:2048 sc1
    s_barrier
    v_perm_b32 v74, v156, v152, s46
    v_perm_b32 v82, v156, v152, s47
    v_perm_b32 v90, v157, v153, s46
    v_perm_b32 v98, v157, v153, s47
    v_perm_b32 v106, v158, v154, s46
    v_perm_b32 v114, v158, v154, s47
    v_perm_b32 v122, v159, v155, s46
    v_perm_b32 v130, v159, v155, s47
    s_waitcnt vmcnt(11)
    v_perm_b32 v75, v164, v160, s46
    v_perm_b32 v83, v164, v160, s47
    v_perm_b32 v91, v165, v161, s46
    v_perm_b32 v99, v165, v161, s47
    v_perm_b32 v107, v166, v162, s46
    v_perm_b32 v115, v166, v162, s47
    v_perm_b32 v123, v167, v163, s46
    v_perm_b32 v131, v167, v163, s47
    s_waitcnt vmcnt(9)
    v_perm_b32 v78, v188, v184, s46
    v_perm_b32 v86, v188, v184, s47
    v_perm_b32 v94, v189, v185, s46
    v_perm_b32 v102, v189, v185, s47
    v_perm_b32 v110, v190, v186, s46
    v_perm_b32 v118, v190, v186, s47
    v_perm_b32 v126, v191, v187, s46
    v_perm_b32 v134, v191, v187, s47
    s_waitcnt vmcnt(7)
    v_perm_b32 v79, v196, v192, s46
    v_perm_b32 v87, v196, v192, s47
    v_perm_b32 v95, v197, v193, s46
    v_perm_b32 v103, v197, v193, s47
    v_perm_b32 v111, v198, v194, s46
    v_perm_b32 v119, v198, v194, s47
    v_perm_b32 v127, v199, v195, s46
    v_perm_b32 v135, v199, v195, s47
    s_waitcnt vmcnt(5)
    v_perm_b32 v136, v204, v200, s46
    v_perm_b32 v138, v204, v200, s47
    v_perm_b32 v140, v205, v201, s46
    v_perm_b32 v142, v205, v201, s47
    v_perm_b32 v144, v206, v202, s46
    v_perm_b32 v146, v206, v202, s47
    v_perm_b32 v148, v207, v203, s46
    v_perm_b32 v150, v207, v203, s47
    s_waitcnt vmcnt(3)
    v_perm_b32 v137, v212, v208, s46
    v_perm_b32 v139, v212, v208, s47
    v_perm_b32 v141, v213, v209, s46
    v_perm_b32 v143, v213, v209, s47
    v_perm_b32 v145, v214, v210, s46
    v_perm_b32 v147, v214, v210, s47
    v_perm_b32 v149, v215, v211, s46
    v_perm_b32 v151, v215, v211, s47
    s_mov_b32 s48, 0
    s_waitcnt vmcnt(0)
    v_and_b32 v228, v252, v226
    v_and_b32 v229, v253, v226
    v_cmp_ne_u32 s[50:51], s41, v219
    v_cmp_ne_u32 s[52:53], s41, v223
    v_cmp_ne_u32 vcc, s41, v227
L_pollM_done:
    v_mfma_f32_16x16x16_bf16 v[152:155], v[228:229], v[136:137], 0
    s_or_b64 s[50:51], s[50:51], s[52:53]
    s_or_b64 vcc, vcc, s[50:51]
    s_cbranch_vccnz L_pollM
    s_lshl2_add_u32 s44, s42, s38
    s_cmp_lg_u32 s44, 44
    s_cbranch_scc1 L_nofl
    s_mov_b64 exec, 1
    global_store_dword v230, v231, s[36:37] sc1
    s_mov_b64 exec, -1
L_nofl:
    v_swap_b32 v217, v218
    v_mfma_f32_16x16x16_bf16 v[156:159], v[228:229], v[138:139], 0
    v_mov_b32 v219, v220
    v_mfma_f32_16x16x16_bf16 v[160:163], v[228:229], v[140:141], 0
    v_mov_b32 v220, v221
    v_mfma_f32_16x16x16_bf16 v[164:167], v[228:229], v[142:143], 0
    v_mov_b32 v221, v224
    v_mfma_f32_16x16x16_bf16 v[168:171], v[228:229], v[144:145], 0
    v_mov_b32 v223, v225
    v_mfma_f32_16x16x16_bf16 v[172:175], v[228:229], v[146:147], 0
    v_mfma_f32_16x16x16_bf16 v[176:179], v[228:229], v[148:149], 0
    v_mfma_f32_16x16x16_bf16 v[180:183], v[228:229], v[150:151], 0
    v_smfmac_f32_16x16x64_bf16 v[152:155], v[216:219], v[8:15], v251
    v_smfmac_f32_16x16x64_bf16 v[152:155], v[220:223], v[72:79], v251
    v_smfmac_f32_16x16x64_bf16 v[156:159], v[216:219], v[16:23], v251
    v_smfmac_f32_16x16x64_bf16 v[156:159], v[220:223], v[80:87], v251
    v_smfmac_f32_16x16x64_bf16 v[160:163], v[216:219], v[24:31], v251
    v_smfmac_f32_16x16x64_bf16 v[160:163], v[220:223], v[88:95], v251
    v_smfmac_f32_16x16x64_bf16 v[164:167], v[216:219], v[32:39], v251
    v_smfmac_f32_16x16x64_bf16 v[164:167], v[220:223], v[96:103], v251
    s_nop 1
    v_add_f32 v184, v152, v154
    v_add_f32 v185, v153, v155
    v_smfmac_f32_16x16x64_bf16 v[168:171], v[216:219], v[40:47], v251
    v_smfmac_f32_16x16x64_bf16 v[168:171], v[220:223], v[104:111], v251
    v_add_f32 v186, v156, v158
    v_add_f32 v187, v157, v159
    ds_write_b128 v7, v[184:187] offset:0
    v_smfmac_f32_16x16x64_bf16 v[172:175], v[216:219], v[48:55], v251
    v_smfmac_f32_16x16x64_bf16 v[172:175], v[220:223], v[112:119], v251
    v_add_f32 v188, v160, v162
    v_add_f32 v189, v161, v163
    v_smfmac_f32_16x16x64_bf16 v[176:179], v[216:219], v[56:63], v251
    v_smfmac_f32_16x16x64_bf16 v[176:179], v[220:223], v[120:127], v251
    v_add_f32 v190, v164, v166
    v_add_f32 v191, v165, v167
    ds_write_b128 v7, v[188:191] offset:1024
    v_smfmac_f32_16x16x64_bf16 v[180:183], v[216:219], v[64:71], v251
    v_smfmac_f32_16x16x64_bf16 v[180:183], v[220:223], v[128:135], v251
    v_add_f32 v192, v168, v170
    v_add_f32 v193, v169, v171
    v_add_f32 v194, v172, v174
    v_add_f32 v195, v173, v175
    ds_write_b128 v7, v[192:195] offset:2048
    v_add_f32 v196, v176, v178
    v_add_f32 v197, v177, v179
    s_nop 0
    v_add_f32 v198, v180, v182
    v_add_f32 v199, v181, v183
    ds_write_b128 v7, v[196:199] offset:3072
    s_waitcnt lgkmcnt(0)
    s_barrier
    ds_read2st64_b64 v[104:107], v248 offset0:0 offset1:8
    ds_read2st64_b64 v[108:111], v248 offset0:16 offset1:24
    ds_read2st64_b64 v[112:115], v249 offset0:0 offset1:8
    ds_read2st64_b64 v[116:119], v249 offset0:16 offset1:24
    s_waitcnt lgkmcnt(2)
    v_pk_add_f32 v[104:105], v[104:105], v[106:107]
    v_pk_add_f32 v[108:109], v[108:109], v[110:111]
    v_pk_add_f32 v[104:105], v[104:105], v[108:109]
    v_mul_f32 v106, 3216550459, v104
    v_mul_f32 v107, 3216550459, v105
    v_exp_f32 v106, v106
    v_exp_f32 v107, v107
    s_waitcnt lgkmcnt(0)
    v_pk_add_f32 v[112:113], v[112:113], v[114:115]
    v_fma_f32 v106, v106, s58, s58
    v_fma_f32 v107, v107, s58, s58
    v_rcp_f32 v106, v106
    v_rcp_f32 v107, v107
    v_pk_add_f32 v[116:117], v[116:117], v[118:119]
    v_pk_add_f32 v[112:113], v[112:113], v[116:117]
    v_pk_mul_f32 v[104:105], v[104:105], v[106:107]
    v_pk_mul_f32 v[104:105], v[104:105], v[112:113]
    v_cvt_pk_bf16_f32 v104, v104, v105
    ds_write_b16 v250, v104 offset:16384
    ds_write_b16_d16_hi v250, v104 offset:16400
    s_waitcnt lgkmcnt(0)
    s_barrier
    s_endpgm
L_pollM:
    v_mov_b32 v228, 77836
    s_mov_b64 exec, 1
L_pollMh:
    global_load_dword v229, v228, s[36:37] sc1
    s_add_u32 s48, s48, 1
    s_cmp_ge_u32 s48, 65536
    s_cbranch_scc1 L_pollMx
    s_waitcnt vmcnt(0)
    v_cmp_ne_u32 vcc, s41, v229
    s_cbranch_vccnz L_pollMh
L_pollMx:
    s_mov_b64 exec, -1
    s_waitcnt vmcnt(0)
    global_load_dwordx4 v[216:219], v6, s[36:37] offset:0 sc1
    global_load_dwordx4 v[220:223], v6, s[36:37] offset:1024 sc1
    global_load_dwordx4 v[224:227], v6, s[36:37] offset:2048 sc1
    s_add_u32 s48, s48, 1
    s_waitcnt vmcnt(0)
    v_and_b32 v228, v252, v226
    v_and_b32 v229, v253, v226
    v_cmp_ne_u32 s[50:51], s41, v219
    v_cmp_ne_u32 s[52:53], s41, v223
    v_cmp_ne_u32 vcc, s41, v227
    s_or_b64 s[50:51], s[50:51], s[52:53]
    s_or_b64 vcc, vcc, s[50:51]
    s_cbranch_vccz L_pollM_done
    s_cmp_lt_u32 s48, 65536
    s_cbranch_scc1 L_pollM
    s_mov_b64 s[50:51], 0
    s_mov_b64 s[52:53], 0
    s_mov_b64 vcc, 0
    s_branch L_pollM_done
L_lnx:
    s_mov_b32 s60, 0x10001a0a
    s_mov_b32 s61, 0x3e342a20
    s_lshl_b32 s59, s39, 3
    s_lshr_b64 s[60:61], s[60:61], s59
    s_and_b32 s60, s60, 0xff
    s_lshl_b32 s59, s39, 2
    s_lshr_b32 s61, 0xaaaaaa66, s59
    s_and_b32 s61, s61, 15
    s_movk_i32 s59, 10923
    s_cmp_eq_u32 s61, 10
    s_cselect_b32 s59, 6554, s59
    s_cmp_ge_u32 s63, s61
    s_cbranch_scc1 L_ln4
    s_add_u32 s42, s60, s63
    s_mul_i32 s45, s42, 73728
    v_lshrrev_b32 v4, 4, v1
    v_mul_u32_u24 v4, 1152, v4
    v_and_b32 v5, 15, v1
    v_lshl_add_u32 v4, v5, 3, v4
    v_add_u32 v4, s45, v4
    global_load_dwordx2 v[168:169], v4, s[30:31] offset:1024
    v_add_u32 v4, 4608, v4
    global_load_dwordx2 v[170:171], v4, s[30:31] offset:1024
    v_add_u32 v4, 4608, v4
    global_load_dwordx2 v[172:173], v4, s[30:31] offset:1024
    v_add_u32 v4, 4608, v4
    global_load_dwordx2 v[174:175], v4, s[30:31] offset:1024
    v_add_u32 v4, 4608, v4
    global_load_dwordx2 v[176:177], v4, s[30:31] offset:1024
    v_add_u32 v4, 4608, v4
    global_load_dwordx2 v[178:179], v4, s[30:31] offset:1024
    v_add_u32 v4, 4608, v4
    global_load_dwordx2 v[180:181], v4, s[30:31] offset:1024
    v_add_u32 v4, 4608, v4
    global_load_dwordx2 v[182:183], v4, s[30:31] offset:1024
    v_add_u32 v4, 4608, v4
    global_load_dwordx2 v[184:185], v4, s[30:31] offset:1024
    v_add_u32 v4, 4608, v4
    global_load_dwordx2 v[186:187], v4, s[30:31] offset:1024
    v_add_u32 v4, 4608, v4
    global_load_dwordx2 v[188:189], v4, s[30:31] offset:1024
    v_add_u32 v4, 4608, v4
    global_load_dwordx2 v[190:191], v4, s[30:31] offset:1024
    v_add_u32 v4, 4608, v4
    global_load_dwordx2 v[192:193], v4, s[30:31] offset:1024
    v_add_u32 v4, 4608, v4
    global_load_dwordx2 v[194:195], v4, s[30:31] offset:1024
    v_add_u32 v4, 4608, v4
    global_load_dwordx2 v[196:197], v4, s[30:31] offset:1024
    v_add_u32 v4, 4608, v4
    global_load_dwordx2 v[198:199], v4, s[30:31] offset:1024
    s_setprio 3
    v_mov_b32 v46, 0x3f803f80
    v_lshlrev_b32 v3, 3, v3
    v_add_u32 v3, 4088, v3
    s_mov_b32 s64, 0
    s_waitcnt lgkmcnt(0)
    s_mul_i32 s41, s41, 1664525
    s_add_u32 s41, s41, 1013904223
    v_mov_b32 v59, s41
    s_lshr_b32 s52, s41, 4
    s_xor_b32 s52, s52, s41
    s_and_b32 s52, s52, 15
    s_cselect_b32 s52, 0, 16
    s_xor_b32 s52, s52, s41
    s_bfe_u32 s48, s52, 0x40000
    s_mul_i32 s48, s48, 0x08002000
    s_and_b32 s48, s48, 0x60006000
    s_bfe_u32 s49, s52, 0x40004
    s_mul_i32 s49, s49, 0x08002000
    s_and_b32 s49, s49, 0x60006000
    s_bfe_u32 s50, s52, 0x40008
    s_mul_i32 s50, s50, 0x08002000
    s_and_b32 s50, s50, 0x60006000
    s_bfe_u32 s51, s52, 0x4000c
    s_mul_i32 s51, s51, 0x08002000
    s_and_b32 s51, s51, 0x60006000
    s_waitcnt vmcnt(21)
    v_dot2_f32_bf16 v48, v72, v46, 0
    v_dot2_f32_bf16 v49, v72, v72, 0
    v_dot2_f32_bf16 v48, v73, v46, v48
    v_dot2_f32_bf16 v49, v73, v73, v49
    v_dot2_f32_bf16 v48, v74, v46, v48
    v_dot2_f32_bf16 v49, v74, v74, v49
    v_dot2_f32_bf16 v48, v75, v46, v48
    v_dot2_f32_bf16 v49, v75, v75, v49
    s_waitcnt vmcnt(20)
    v_dot2_f32_bf16 v48, v76, v46, v48
    v_dot2_f32_bf16 v49, v76, v76, v49
    v_dot2_f32_bf16 v48, v77, v46, v48
    v_dot2_f32_bf16 v49, v77, v77, v49
    v_dot2_f32_bf16 v48, v78, v46, v48
    v_dot2_f32_bf16 v49, v78, v78, v49
    v_dot2_f32_bf16 v48, v79, v46, v48
    v_dot2_f32_bf16 v49, v79, v79, v49
    s_waitcnt vmcnt(19)
    v_dot2_f32_bf16 v48, v80, v46, v48
    v_dot2_f32_bf16 v49, v80, v80, v49
    s_waitcnt vmcnt(18)
    v_dot2_f32_bf16 v51, v84, v46, 0
    v_dot2_f32_bf16 v50, v72, v84, 0
    v_dot2_f32_bf16 v51, v85, v46, v51
    v_dot2_f32_bf16 v50, v73, v85, v50
    v_dot2_f32_bf16 v51, v86, v46, v51
    v_dot2_f32_bf16 v50, v74, v86, v50
    v_dot2_f32_bf16 v51, v87, v46, v51
    v_dot2_f32_bf16 v50, v75, v87, v50
    s_waitcnt vmcnt(17)
    v_dot2_f32_bf16 v51, v88, v46, v51
    v_dot2_f32_bf16 v50, v76, v88, v50
    v_dot2_f32_bf16 v51, v89, v46, v51
    v_dot2_f32_bf16 v50, v77, v89, v50
    v_dot2_f32_bf16 v51, v90, v46, v51
    v_dot2_f32_bf16 v50, v78, v90, v50
    v_dot2_f32_bf16 v51, v91, v46, v51
    v_dot2_f32_bf16 v50, v79, v91, v50
    s_waitcnt vmcnt(16)
    v_dot2_f32_bf16 v51, v92, v46, v51
    v_dot2_f32_bf16 v50, v80, v92, v50
    v_add_f32_dpp v48, v48, v48 row_ror:8 row_mask:0xf bank_mask:0xf
    v_add_f32_dpp v49, v49, v49 row_ror:8 row_mask:0xf bank_mask:0xf
    v_add_f32_dpp v51, v51, v51 row_ror:8 row_mask:0xf bank_mask:0xf
    v_add_f32_dpp v50, v50, v50 row_ror:8 row_mask:0xf bank_mask:0xf
    v_add_f32_dpp v48, v48, v48 row_ror:4 row_mask:0xf bank_mask:0xf
    v_add_f32_dpp v49, v49, v49 row_ror:4 row_mask:0xf bank_mask:0xf
    v_add_f32_dpp v51, v51, v51 row_ror:4 row_mask:0xf bank_mask:0xf
    v_add_f32_dpp v50, v50, v50 row_ror:4 row_mask:0xf bank_mask:0xf
    v_add_f32_dpp v48, v48, v48 row_ror:2 row_mask:0xf bank_mask:0xf
    v_add_f32_dpp v49, v49, v49 row_ror:2 row_mask:0xf bank_mask:0xf
    v_add_f32_dpp v51, v51, v51 row_ror:2 row_mask:0xf bank_mask:0xf
    v_add_f32_dpp v50, v50, v50 row_ror:2 row_mask:0xf bank_mask:0xf
    v_add_f32_dpp v48, v48, v48 row_ror:1 row_mask:0xf bank_mask:0xf
    v_add_f32_dpp v49, v49, v49 row_ror:1 row_mask:0xf bank_mask:0xf
    v_add_f32_dpp v51, v51, v51 row_ror:1 row_mask:0xf bank_mask:0xf
    v_add_f32_dpp v50, v50, v50 row_ror:1 row_mask:0xf bank_mask:0xf
    v_add_f32_dpp v48, v48, v48 row_bcast:15 row_mask:0xa bank_mask:0xf
    v_add_f32_dpp v49, v49, v49 row_bcast:15 row_mask:0xa bank_mask:0xf
    v_add_f32_dpp v51, v51, v51 row_bcast:15 row_mask:0xa bank_mask:0xf
    v_add_f32_dpp v50, v50, v50 row_bcast:15 row_mask:0xa bank_mask:0xf
    v_mul_f32 v48, 0x3ae38e39, v48
    v_mul_f32 v49, 0x3ae38e39, v49
    v_fma_f32 v49, -v48, v48, v49
    v_max_f32 v49, 0, v49
    v_cvt_pk_bf16_f32 v52, v48, v49
    v_lshlrev_b32 v54, 16, v52
    v_and_b32 v52, 4294901760, v52
    v_add_f32 v52, 0x3727c5ac, v52
    v_cvt_pk_bf16_f32 v52, v52, v52
    v_and_b32 v52, 4294901760, v52
    v_sqrt_f32 v52, v52
    v_fma_f32 v50, -v54, v51, v50
    v_cvt_pk_bf16_f32 v56, v48, v52
    v_and_b32 v53, 4294901760, v56
    v_rcp_f32 v53, v53
    v_mov_b32 v57, v56
    v_mul_f32 v50, v50, v53
    v_cvt_pk_bf16_f32 v55, v50, v50
    v_ashrrev_i32 v61, 31, v55
    v_or_b32 v61, 0x80008000, v61
    v_xor_b32 v60, v55, v61
    v_xor_b32 v55, v55, v61
    v_permlane32_swap_b32 v56, v57
    s_mov_b32 s43, 0x07060100
    v_permlane32_swap_b32 v55, v60
    s_mov_b32 exec_lo, 0
    s_mov_b32 exec_hi, 0x10000
    v_perm_b32 v58, v60, v55, s43
    global_store_dwordx4 v3, v[56:59], s[36:37] sc1
    s_mov_b64 exec, -1
    s_setprio 0
    s_barrier
    s_branch L_roles2
L_dn:
    s_sub_u32 s43, s38, 4
    s_mul_i32 s45, s42, 73728
    v_lshrrev_b32 v3, 4, v1
    v_mul_u32_u24 v2, 1152, v3
    v_and_b32 v5, 15, v1
    v_add_u32 v2, s45, v2
    v_lshl_add_u32 v4, v5, 3, v2
    v_lshl_add_u32 v2, v5, 4, v2
    s_lshl_b32 s44, s43, 8
    v_add_u32 v2, s44, v2
    s_lshl_b32 s45, s42, 7
    s_add_u32 s45, s45, 1048576
    v_lshl_add_u32 v3, v3, 4, s45
    v_and_b32 v6, 1, v1
    v_lshl_add_u32 v3, v6, 6, v3
    v_lshrrev_b32 v5, 1, v5
    v_mul_u32_u24 v5, 9216, v5
    v_add_u32 v7, v3, v5
    v_add_u32 v5, v7, v5
    s_mul_i32 s44, s43, 147456
    v_add_u32 v5, s44, v5
    v_add_u32 v6, 9216, v5
    v_add_u32 v7, 589824, v7
    v_lshlrev_b32 v253, 4, v1
    v_mov_b32 v254, 0x9fff9fff
    v_bfe_u32 v252, v1, 1, 1
    v_mul_u32_u24 v251, 0xaaaa, v252
    v_add_u32 v251, 0x4444, v251
    s_mov_b32 s46, 0x05040100
    s_mov_b32 s47, 0x07060302
    v_mov_b32 v200, 0
    v_mov_b32 v201, 0
    v_mov_b32 v202, 0
    v_mov_b32 v203, 0
    v_mov_b32 v204, 0
    v_mov_b32 v205, 0
    v_mov_b32 v206, 0
    v_mov_b32 v207, 0
    v_mov_b32 v208, 0
    v_mov_b32 v209, 0
    v_mov_b32 v210, 0
    v_mov_b32 v211, 0
    v_mov_b32 v212, 0
    v_mov_b32 v213, 0
    v_mov_b32 v214, 0
    v_mov_b32 v215, 0
    v_mov_b32 v216, 0
    v_mov_b32 v217, 0
    v_mov_b32 v218, 0
    v_mov_b32 v219, 0
    v_mov_b32 v220, 0
    v_mov_b32 v221, 0
    v_mov_b32 v222, 0
    v_mov_b32 v223, 0
    v_mov_b32 v224, 0
    v_mov_b32 v225, 0
    v_mov_b32 v226, 0
    v_mov_b32 v227, 0
    v_mov_b32 v228, 0
    v_mov_b32 v229, 0
    v_mov_b32 v230, 0
    v_mov_b32 v231, 0
    v_mov_b32 v232, 0
    v_mov_b32 v233, 0
    v_mov_b32 v234, 0
    v_mov_b32 v235, 0
    v_mov_b32 v236, 0
    v_mov_b32 v237, 0
    v_mov_b32 v238, 0
    v_mov_b32 v239, 0
    v_mov_b32 v240, 0
    v_mov_b32 v241, 0
    v_mov_b32 v242, 0
    v_mov_b32 v243, 0
    v_mov_b32 v244, 0
    v_mov_b32 v245, 0
    v_mov_b32 v246, 0
    v_mov_b32 v247, 0
    s_cmp_eq_u32 s38, 7
    s_cbranch_scc1 L_dnx
    s_barrier
    s_barrier
    global_load_dwordx4 v[104:107], v2, s[30:31] nt
    v_add_u32 v2, 4608, v2
    global_load_dwordx4 v[108:111], v2, s[30:31] nt
    v_add_u32 v2, 4608, v2
    global_load_dwordx4 v[112:115], v2, s[30:31] nt
    v_add_u32 v2, 4608, v2
    global_load_dwordx4 v[116:119], v2, s[30:31] nt
    v_add_u32 v2, 4608, v2
    s_barrier
    global_load_dwordx4 v[120:123], v2, s[30:31] nt
    v_add_u32 v2, 4608, v2
    global_load_dwordx4 v[124:127], v2, s[30:31] nt
    v_add_u32 v2, 4608, v2
    global_load_dwordx4 v[128:131], v2, s[30:31] nt
    v_add_u32 v2, 4608, v2
    global_load_dwordx4 v[132:135], v2, s[30:31] nt
    v_add_u32 v2, 4608, v2
    global_load_dwordx4 v[136:139], v2, s[30:31] nt
    v_add_u32 v2, 4608, v2
    global_load_dwordx4 v[140:143], v2, s[30:31] nt
    s_waitcnt vmcnt(8)
    v_perm_b32 v8, v108, v104, s46
    v_perm_b32 v16, v108, v104, s47
    v_perm_b32 v24, v109, v105, s46
    v_perm_b32 v32, v109, v105, s47
    v_perm_b32 v40, v110, v106, s46
    v_perm_b32 v48, v110, v106, s47
    v_perm_b32 v56, v111, v107, s46
    v_perm_b32 v64, v111, v107, s47
    v_add_u32 v2, 4608, v2
    global_load_dwordx4 v[144:147], v2, s[30:31] nt
    v_add_u32 v2, 4608, v2
    global_load_dwordx4 v[148:151], v2, s[30:31] nt
    s_waitcnt vmcnt(8)
    v_perm_b32 v9, v116, v112, s46
    v_perm_b32 v17, v116, v112, s47
    v_perm_b32 v25, v117, v113, s46
    v_perm_b32 v33, v117, v113, s47
    v_perm_b32 v41, v118, v114, s46
    v_perm_b32 v49, v118, v114, s47
    v_perm_b32 v57, v119, v115, s46
    v_perm_b32 v65, v119, v115, s47
    v_add_u32 v2, 4608, v2
    global_load_dwordx4 v[152:155], v2, s[30:31] nt
    v_add_u32 v2, 4608, v2
    global_load_dwordx4 v[156:159], v2, s[30:31] nt
    s_waitcnt vmcnt(8)
    v_perm_b32 v10, v124, v120, s46
    v_perm_b32 v18, v124, v120, s47
    v_perm_b32 v26, v125, v121, s46
    v_perm_b32 v34, v125, v121, s47
    v_perm_b32 v42, v126, v122, s46
    v_perm_b32 v50, v126, v122, s47
    v_perm_b32 v58, v127, v123, s46
    v_perm_b32 v66, v127, v123, s47
    v_add_u32 v2, 4608, v2
    global_load_dwordx4 v[160:163], v2, s[30:31] nt
    v_add_u32 v2, 4608, v2
    global_load_dwordx4 v[164:167], v2, s[30:31] nt
    s_waitcnt vmcnt(8)
    v_perm_b32 v11, v132, v128, s46
    v_perm_b32 v19, v132, v128, s47
    v_perm_b32 v27, v133, v129, s46
    v_perm_b32 v35, v133, v129, s47
    v_perm_b32 v43, v134, v130, s46
    v_perm_b32 v51, v134, v130, s47
    v_perm_b32 v59, v135, v131, s46
    v_perm_b32 v67, v135, v131, s47
    s_barrier
    s_waitcnt vmcnt(6)
    v_perm_b32 v12, v140, v136, s46
    v_perm_b32 v20, v140, v136, s47
    v_perm_b32 v28, v141, v137, s46
    v_perm_b32 v36, v141, v137, s47
    v_perm_b32 v44, v142, v138, s46
    v_perm_b32 v52, v142, v138, s47
    v_perm_b32 v60, v143, v139, s46
    v_perm_b32 v68, v143, v139, s47
    s_waitcnt vmcnt(4)
    v_perm_b32 v13, v148, v144, s46
    v_perm_b32 v21, v148, v144, s47
    v_perm_b32 v29, v149, v145, s46
    v_perm_b32 v37, v149, v145, s47
    v_perm_b32 v45, v150, v146, s46
    v_perm_b32 v53, v150, v146, s47
    v_perm_b32 v61, v151, v147, s46
    v_perm_b32 v69, v151, v147, s47
    s_waitcnt vmcnt(2)
    v_perm_b32 v14, v156, v152, s46
    v_perm_b32 v22, v156, v152, s47
    v_perm_b32 v30, v157, v153, s46
    v_perm_b32 v38, v157, v153, s47
    v_perm_b32 v46, v158, v154, s46
    v_perm_b32 v54, v158, v154, s47
    v_perm_b32 v62, v159, v155, s46
    v_perm_b32 v70, v159, v155, s47
    s_barrier
    ds_read_b128 v[112:115], v253 offset:16384
    s_waitcnt vmcnt(0)
    v_perm_b32 v15, v164, v160, s46
    v_perm_b32 v23, v164, v160, s47
    s_waitcnt lgkmcnt(0)
    v_smfmac_f32_16x16x64_bf16 v[200:203], v[112:115], v[8:15], v251
    v_perm_b32 v31, v165, v161, s46
    s_nop 0
    v_smfmac_f32_16x16x64_bf16 v[204:207], v[112:115], v[16:23], v251
    v_perm_b32 v39, v165, v161, s47
    s_nop 0
    v_smfmac_f32_16x16x64_bf16 v[208:211], v[112:115], v[24:31], v251
    v_perm_b32 v47, v166, v162, s46
    s_nop 0
    v_smfmac_f32_16x16x64_bf16 v[212:215], v[112:115], v[32:39], v251
    v_perm_b32 v55, v166, v162, s47
    v_add_f32 v200, v200, v202
    v_smfmac_f32_16x16x64_bf16 v[216:219], v[112:115], v[40:47], v251
    v_perm_b32 v63, v167, v163, s46
    v_add_f32 v201, v201, v203
    v_smfmac_f32_16x16x64_bf16 v[220:223], v[112:115], v[48:55], v251
    v_perm_b32 v71, v167, v163, s47
    v_cvt_pk_bf16_f32 v120, v200, v201
    v_smfmac_f32_16x16x64_bf16 v[224:227], v[112:115], v[56:63], v251
    v_and_or_b32 v120, v120, v254, s48
    v_add_f32 v204, v204, v206
    v_smfmac_f32_16x16x64_bf16 v[228:231], v[112:115], v[64:71], v251
    v_add_f32 v205, v205, v207
    v_cvt_pk_bf16_f32 v121, v204, v205
    v_and_or_b32 v121, v121, v254, s49
    v_add_f32 v208, v208, v210
    v_add_f32 v209, v209, v211
    v_cvt_pk_bf16_f32 v122, v208, v209
    v_and_or_b32 v122, v122, v254, s50
    v_pk_add_f32 v[212:213], v[212:213], v[214:215]
    v_cvt_pk_bf16_f32 v123, v212, v213
    v_and_or_b32 v123, v123, v254, s51
    global_store_dwordx4 v5, v[120:123], s[36:37] sc1
    v_pk_add_f32 v[216:217], v[216:217], v[218:219]
    v_cvt_pk_bf16_f32 v124, v216, v217
    v_and_or_b32 v124, v124, v254, s48
    v_pk_add_f32 v[220:221], v[220:221], v[222:223]
    v_cvt_pk_bf16_f32 v125, v220, v221
    v_and_or_b32 v125, v125, v254, s49
    v_pk_add_f32 v[224:225], v[224:225], v[226:227]
    v_cvt_pk_bf16_f32 v126, v224, v225
    v_and_or_b32 v126, v126, v254, s50
    v_pk_add_f32 v[228:229], v[228:229], v[230:231]
    v_cvt_pk_bf16_f32 v127, v228, v229
    v_and_or_b32 v127, v127, v254, s51
    global_store_dwordx4 v6, v[124:127], s[36:37] sc1
    s_endpgm
L_dnx:
    s_barrier
    s_waitcnt vmcnt(0)
    v_perm_b32 v72, v170, v168, s46
    v_perm_b32 v80, v170, v168, s47
    v_perm_b32 v88, v171, v169, s46
    v_perm_b32 v96, v171, v169, s47
    v_perm_b32 v73, v174, v172, s46
    v_perm_b32 v81, v174, v172, s47
    v_perm_b32 v89, v175, v173, s46
    v_perm_b32 v97, v175, v173, s47
    v_perm_b32 v74, v178, v176, s46
    v_perm_b32 v82, v178, v176, s47
    v_perm_b32 v90, v179, v177, s46
    v_perm_b32 v98, v179, v177, s47
    v_perm_b32 v75, v182, v180, s46
    v_perm_b32 v83, v182, v180, s47
    v_perm_b32 v91, v183, v181, s46
    v_perm_b32 v99, v183, v181, s47
    v_perm_b32 v76, v186, v184, s46
    v_perm_b32 v84, v186, v184, s47
    v_perm_b32 v92, v187, v185, s46
    v_perm_b32 v100, v187, v185, s47
    v_perm_b32 v77, v190, v188, s46
    v_perm_b32 v85, v190, v188, s47
    v_perm_b32 v93, v191, v189, s46
    v_perm_b32 v101, v191, v189, s47
    v_perm_b32 v78, v194, v192, s46
    v_perm_b32 v86, v194, v192, s47
    v_perm_b32 v94, v195, v193, s46
    v_perm_b32 v102, v195, v193, s47
    v_perm_b32 v79, v198, v196, s46
    v_perm_b32 v87, v198, v196, s47
    v_perm_b32 v95, v199, v197, s46
    v_perm_b32 v103, v199, v197, s47
    s_mul_i32 s44, s42, 16
    s_add_u32 s44, s44, 262144
    s_cmp_eq_u32 s42, 11
    s_cselect_b32 s45, 262144, 0
    s_add_u32 s44, s44, s45
    v_mov_b32 v249, s44
    v_mov_b32 v250, s41
    s_barrier
    global_load_dwordx4 v[104:107], v2, s[30:31] nt
    v_add_u32 v2, 4608, v2
    global_load_dwordx4 v[108:111], v2, s[30:31] nt
    v_add_u32 v2, 4608, v2
    global_load_dwordx4 v[112:115], v2, s[30:31] nt
    v_add_u32 v2, 4608, v2
    global_load_dwordx4 v[116:119], v2, s[30:31] nt
    v_add_u32 v2, 4608, v2
    s_barrier
    global_load_dwordx4 v[120:123], v2, s[30:31] nt
    v_add_u32 v2, 4608, v2
    global_load_dwordx4 v[124:127], v2, s[30:31] nt
    v_add_u32 v2, 4608, v2
    global_load_dwordx4 v[128:131], v2, s[30:31] nt
    v_add_u32 v2, 4608, v2
    global_load_dwordx4 v[132:135], v2, s[30:31] nt
    v_add_u32 v2, 4608, v2
    global_load_dwordx4 v[136:139], v2, s[30:31] nt
    v_add_u32 v2, 4608, v2
    global_load_dwordx4 v[140:143], v2, s[30:31] nt
    s_mov_b64 exec, 1
    global_store_dword v249, v250, s[36:37] sc1
    s_mov_b64 exec, -1
    s_waitcnt vmcnt(8)
    v_perm_b32 v8, v108, v104, s46
    v_perm_b32 v16, v108, v104, s47
    v_perm_b32 v24, v109, v105, s46
    v_perm_b32 v32, v109, v105, s47
    v_perm_b32 v40, v110, v106, s46
    v_perm_b32 v48, v110, v106, s47
    v_perm_b32 v56, v111, v107, s46
    v_perm_b32 v64, v111, v107, s47
    v_add_u32 v2, 4608, v2
    global_load_dwordx4 v[144:147], v2, s[30:31] nt
    v_add_u32 v2, 4608, v2
    global_load_dwordx4 v[148:151], v2, s[30:31] nt
    s_waitcnt vmcnt(8)
    v_perm_b32 v9, v116, v112, s46
    v_perm_b32 v17, v116, v112, s47
    v_perm_b32 v25, v117, v113, s46
    v_perm_b32 v33, v117, v113, s47
    v_perm_b32 v41, v118, v114, s46
    v_perm_b32 v49, v118, v114, s47
    v_perm_b32 v57, v119, v115, s46
    v_perm_b32 v65, v119, v115, s47
    v_add_u32 v2, 4608, v2
    global_load_dwordx4 v[152:155], v2, s[30:31] nt
    v_add_u32 v2, 4608, v2
    global_load_dwordx4 v[156:159], v2, s[30:31] nt
    s_waitcnt vmcnt(8)
    v_perm_b32 v10, v124, v120, s46
    v_perm_b32 v18, v124, v120, s47
    v_perm_b32 v26, v125, v121, s46
    v_perm_b32 v34, v125, v121, s47
    v_perm_b32 v42, v126, v122, s46
    v_perm_b32 v50, v126, v122, s47
    v_perm_b32 v58, v127, v123, s46
    v_perm_b32 v66, v127, v123, s47
    v_add_u32 v2, 4608, v2
    global_load_dwordx4 v[160:163], v2, s[30:31] nt
    v_add_u32 v2, 4608, v2
    global_load_dwordx4 v[164:167], v2, s[30:31] nt
    s_waitcnt vmcnt(8)
    v_perm_b32 v11, v132, v128, s46
    v_perm_b32 v19, v132, v128, s47
    v_perm_b32 v27, v133, v129, s46
    v_perm_b32 v35, v133, v129, s47
    v_perm_b32 v43, v134, v130, s46
    v_perm_b32 v51, v134, v130, s47
    v_perm_b32 v59, v135, v131, s46
    v_perm_b32 v67, v135, v131, s47
    s_barrier
    s_waitcnt vmcnt(6)
    v_perm_b32 v12, v140, v136, s46
    v_perm_b32 v20, v140, v136, s47
    v_perm_b32 v28, v141, v137, s46
    v_perm_b32 v36, v141, v137, s47
    v_perm_b32 v44, v142, v138, s46
    v_perm_b32 v52, v142, v138, s47
    v_perm_b32 v60, v143, v139, s46
    v_perm_b32 v68, v143, v139, s47
    s_waitcnt vmcnt(4)
    v_perm_b32 v13, v148, v144, s46
    v_perm_b32 v21, v148, v144, s47
    v_perm_b32 v29, v149, v145, s46
    v_perm_b32 v37, v149, v145, s47
    v_perm_b32 v45, v150, v146, s46
    v_perm_b32 v53, v150, v146, s47
    v_perm_b32 v61, v151, v147, s46
    v_perm_b32 v69, v151, v147, s47
    s_waitcnt vmcnt(2)
    v_perm_b32 v14, v156, v152, s46
    v_perm_b32 v22, v156, v152, s47
    v_perm_b32 v30, v157, v153, s46
    v_perm_b32 v38, v157, v153, s47
    v_perm_b32 v46, v158, v154, s46
    v_perm_b32 v54, v158, v154, s47
    v_perm_b32 v62, v159, v155, s46
    v_perm_b32 v70, v159, v155, s47
    s_barrier
    ds_read_b128 v[112:115], v253 offset:16384
    s_waitcnt lgkmcnt(0)
    v_smfmac_f32_16x16x64_bf16 v[232:235], v[112:115], v[72:79], v251
    s_nop 0
    s_nop 0
    v_smfmac_f32_16x16x64_bf16 v[236:239], v[112:115], v[80:87], v251
    s_nop 0
    s_nop 0
    v_smfmac_f32_16x16x64_bf16 v[240:243], v[112:115], v[88:95], v251
    s_nop 0
    s_nop 0
    v_smfmac_f32_16x16x64_bf16 v[244:247], v[112:115], v[96:103], v251
    v_add_f32 v232, v232, v234
    v_add_f32 v233, v233, v235
    v_cvt_pk_bf16_f32 v128, v232, v233
    v_and_or_b32 v128, v128, v254, s48
    v_add_f32 v236, v236, v238
    v_add_f32 v237, v237, v239
    v_cvt_pk_bf16_f32 v129, v236, v237
    v_and_or_b32 v129, v129, v254, s49
    v_add_f32 v240, v240, v242
    v_add_f32 v241, v241, v243
    v_cvt_pk_bf16_f32 v130, v240, v241
    v_and_or_b32 v130, v130, v254, s50
    v_add_f32 v244, v244, v246
    v_add_f32 v245, v245, v247
    v_cvt_pk_bf16_f32 v131, v244, v245
    v_and_or_b32 v131, v131, v254, s51
    global_store_dwordx4 v7, v[128:131], s[36:37] sc1
    s_waitcnt vmcnt(1)
    v_perm_b32 v15, v164, v160, s46
    v_perm_b32 v23, v164, v160, s47
    s_nop 0
    v_smfmac_f32_16x16x64_bf16 v[200:203], v[112:115], v[8:15], v251
    v_perm_b32 v31, v165, v161, s46
    s_nop 0
    v_smfmac_f32_16x16x64_bf16 v[204:207], v[112:115], v[16:23], v251
    v_perm_b32 v39, v165, v161, s47
    s_nop 0
    v_smfmac_f32_16x16x64_bf16 v[208:211], v[112:115], v[24:31], v251
    v_perm_b32 v47, v166, v162, s46
    s_nop 0
    v_smfmac_f32_16x16x64_bf16 v[212:215], v[112:115], v[32:39], v251
    v_perm_b32 v55, v166, v162, s47
    v_add_f32 v200, v200, v202
    v_smfmac_f32_16x16x64_bf16 v[216:219], v[112:115], v[40:47], v251
    v_perm_b32 v63, v167, v163, s46
    v_add_f32 v201, v201, v203
    v_smfmac_f32_16x16x64_bf16 v[220:223], v[112:115], v[48:55], v251
    v_perm_b32 v71, v167, v163, s47
    v_cvt_pk_bf16_f32 v120, v200, v201
    v_smfmac_f32_16x16x64_bf16 v[224:227], v[112:115], v[56:63], v251
    v_and_or_b32 v120, v120, v254, s48
    v_add_f32 v204, v204, v206
    v_smfmac_f32_16x16x64_bf16 v[228:231], v[112:115], v[64:71], v251
    v_add_f32 v205, v205, v207
    v_cvt_pk_bf16_f32 v121, v204, v205
    v_and_or_b32 v121, v121, v254, s49
    v_add_f32 v208, v208, v210
    v_add_f32 v209, v209, v211
    v_cvt_pk_bf16_f32 v122, v208, v209
    v_and_or_b32 v122, v122, v254, s50
    v_pk_add_f32 v[212:213], v[212:213], v[214:215]
    v_cvt_pk_bf16_f32 v123, v212, v213
    v_and_or_b32 v123, v123, v254, s51
    global_store_dwordx4 v5, v[120:123], s[36:37] sc1
    v_pk_add_f32 v[216:217], v[216:217], v[218:219]
    v_cvt_pk_bf16_f32 v124, v216, v217
    v_and_or_b32 v124, v124, v254, s48
    v_pk_add_f32 v[220:221], v[220:221], v[222:223]
    v_cvt_pk_bf16_f32 v125, v220, v221
    v_and_or_b32 v125, v125, v254, s49
    v_pk_add_f32 v[224:225], v[224:225], v[226:227]
    v_cvt_pk_bf16_f32 v126, v224, v225
    v_and_or_b32 v126, v126, v254, s50
    v_pk_add_f32 v[228:229], v[228:229], v[230:231]
    v_cvt_pk_bf16_f32 v127, v228, v229
    v_and_or_b32 v127, v127, v254, s51
    global_store_dwordx4 v6, v[124:127], s[36:37] sc1
    s_endpgm
L_pref:
    s_cmp_ge_u32 s2, 255
    s_cbranch_scc1 L_sel_lo
    s_sub_u32 s43, s63, s61
    s_cmp_lt_u32 s39, 2
    s_cselect_b32 s47, 8, 16
    s_sub_u32 s47, s47, s61
    s_cmp_ge_u32 s39, 7
    s_subb_u32 s47, s47, 0
    s_mul_i32 s42, s38, s47
    s_add_u32 s42, s42, s43
    s_mul_i32 s47, s47, 8
    s_mul_i32 s46, s60, 73728
    s_movk_i32 s52, 42
    s_cmp_eq_u32 s61, 10
    s_cselect_b32 s52, 58, s52
    s_movk_i32 s53, 0
    s_cmp_eq_u32 s61, 10
    s_cselect_b32 s53, 80, s53
    s_movk_i32 s54, 18
    s_cmp_eq_u32 s61, 10
    s_cselect_b32 s54, 10, s54
    v_lshlrev_b32 v2, 7, v1
    s_cmp_lt_u32 s38, 2
    s_cbranch_scc1 L_pf_e
    s_cmp_eq_u32 s64, 0
    s_cbranch_scc1 L_lb_pf2
    s_barrier
L_lb_pf2:
    s_mov_b32 s64, 0
L_pf_e:
    s_cmp_ge_u32 s42, s53
    s_cbranch_scc1 L_pf_d0
    s_mul_i32 s44, s42, s59
    s_lshr_b32 s44, s44, 16
    s_mul_i32 s45, s44, s61
    s_sub_u32 s45, s42, s45
    v_lshl_add_u32 v4, s45, 6, v1
    v_mul_u32_u24 v5, s59, v4
    v_lshrrev_b32 v5, 16, v5
    v_mul_u32_u24 v6, s61, v5
    v_sub_u32 v6, v4, v6
    v_and_b32 v7, 31, v5
    v_lshrrev_b32 v5, 5, v5
    v_mul_u32_u24 v7, 18, v7
    s_andn2_b32 s45, s44, 1
    s_add_u32 s45, s45, s54
    v_add3_u32 v5, v5, v7, s45
    v_mul_u32_u24 v5, 9216, v5
    v_add_u32 v6, s60, v6
    v_lshl_add_u32 v5, v6, 7, v5
    s_bitcmp0_b32 s44, 0
    s_cselect_b64 s[56:57], s[26:27], s[28:29]
    global_load_dword v10, v5, s[56:57]
    s_branch L_pf_n0
L_pf_d0:
    s_sub_u32 s45, s42, s53
    s_cmp_ge_u32 s45, s52
    s_cbranch_scc1 L_pref_done
    s_mul_i32 s43, s45, s59
    s_lshr_b32 s43, s43, 16
    s_mul_i32 s44, s43, s61
    s_sub_u32 s44, s45, s44
    s_mul_i32 s44, s44, 73728
    s_lshl_b32 s43, s43, 13
    s_add_u32 s43, s43, s44
    s_add_u32 s43, s43, s46
    v_add_u32 v3, s43, v2
    global_load_dword v10, v3, s[30:31]
L_pf_n0:
    s_add_u32 s42, s42, s47
    s_cmp_eq_u32 s64, 0
    s_cbranch_scc1 L_lb_pf3
    s_barrier
L_lb_pf3:
    s_cmp_ge_u32 s42, s53
    s_cbranch_scc1 L_pf_d1
    s_mul_i32 s44, s42, s59
    s_lshr_b32 s44, s44, 16
    s_mul_i32 s45, s44, s61
    s_sub_u32 s45, s42, s45
    v_lshl_add_u32 v4, s45, 6, v1
    v_mul_u32_u24 v5, s59, v4
    v_lshrrev_b32 v5, 16, v5
    v_mul_u32_u24 v6, s61, v5
    v_sub_u32 v6, v4, v6
    v_and_b32 v7, 31, v5
    v_lshrrev_b32 v5, 5, v5
    v_mul_u32_u24 v7, 18, v7
    s_andn2_b32 s45, s44, 1
    s_add_u32 s45, s45, s54
    v_add3_u32 v5, v5, v7, s45
    v_mul_u32_u24 v5, 9216, v5
    v_add_u32 v6, s60, v6
    v_lshl_add_u32 v5, v6, 7, v5
    s_bitcmp0_b32 s44, 0
    s_cselect_b64 s[56:57], s[26:27], s[28:29]
    global_load_dword v11, v5, s[56:57]
    s_branch L_pf_n1
L_pf_d1:
    s_sub_u32 s45, s42, s53
    s_cmp_ge_u32 s45, s52
    s_cbranch_scc1 L_pref_done
    s_mul_i32 s43, s45, s59
    s_lshr_b32 s43, s43, 16
    s_mul_i32 s44, s43, s61
    s_sub_u32 s44, s45, s44
    s_mul_i32 s44, s44, 73728
    s_lshl_b32 s43, s43, 13
    s_add_u32 s43, s43, s44
    s_add_u32 s43, s43, s46
    v_add_u32 v3, s43, v2
    global_load_dword v11, v3, s[30:31]
L_pf_n1:
    s_add_u32 s42, s42, s47
    s_cmp_ge_u32 s42, s53
    s_cbranch_scc1 L_pf_d2
    s_mul_i32 s44, s42, s59
    s_lshr_b32 s44, s44, 16
    s_mul_i32 s45, s44, s61
    s_sub_u32 s45, s42, s45
    v_lshl_add_u32 v4, s45, 6, v1
    v_mul_u32_u24 v5, s59, v4
    v_lshrrev_b32 v5, 16, v5
    v_mul_u32_u24 v6, s61, v5
    v_sub_u32 v6, v4, v6
    v_and_b32 v7, 31, v5
    v_lshrrev_b32 v5, 5, v5
    v_mul_u32_u24 v7, 18, v7
    s_andn2_b32 s45, s44, 1
    s_add_u32 s45, s45, s54
    v_add3_u32 v5, v5, v7, s45
    v_mul_u32_u24 v5, 9216, v5
    v_add_u32 v6, s60, v6
    v_lshl_add_u32 v5, v6, 7, v5
    s_bitcmp0_b32 s44, 0
    s_cselect_b64 s[56:57], s[26:27], s[28:29]
    global_load_dword v12, v5, s[56:57]
    s_branch L_pf_n2
L_pf_d2:
    s_sub_u32 s45, s42, s53
    s_cmp_ge_u32 s45, s52
    s_cbranch_scc1 L_pref_done
    s_mul_i32 s43, s45, s59
    s_lshr_b32 s43, s43, 16
    s_mul_i32 s44, s43, s61
    s_sub_u32 s44, s45, s44
    s_mul_i32 s44, s44, 73728
    s_lshl_b32 s43, s43, 13
    s_add_u32 s43, s43, s44
    s_add_u32 s43, s43, s46
    v_add_u32 v3, s43, v2
    global_load_dword v12, v3, s[30:31]
L_pf_n2:
    s_add_u32 s42, s42, s47
    s_cmp_ge_u32 s42, s53
    s_cbranch_scc1 L_pf_d3
    s_mul_i32 s44, s42, s59
    s_lshr_b32 s44, s44, 16
    s_mul_i32 s45, s44, s61
    s_sub_u32 s45, s42, s45
    v_lshl_add_u32 v4, s45, 6, v1
    v_mul_u32_u24 v5, s59, v4
    v_lshrrev_b32 v5, 16, v5
    v_mul_u32_u24 v6, s61, v5
    v_sub_u32 v6, v4, v6
    v_and_b32 v7, 31, v5
    v_lshrrev_b32 v5, 5, v5
    v_mul_u32_u24 v7, 18, v7
    s_andn2_b32 s45, s44, 1
    s_add_u32 s45, s45, s54
    v_add3_u32 v5, v5, v7, s45
    v_mul_u32_u24 v5, 9216, v5
    v_add_u32 v6, s60, v6
    v_lshl_add_u32 v5, v6, 7, v5
    s_bitcmp0_b32 s44, 0
    s_cselect_b64 s[56:57], s[26:27], s[28:29]
    global_load_dword v13, v5, s[56:57]
    s_branch L_pf_n3
L_pf_d3:
    s_sub_u32 s45, s42, s53
    s_cmp_ge_u32 s45, s52
    s_cbranch_scc1 L_pref_done
    s_mul_i32 s43, s45, s59
    s_lshr_b32 s43, s43, 16
    s_mul_i32 s44, s43, s61
    s_sub_u32 s44, s45, s44
    s_mul_i32 s44, s44, 73728
    s_lshl_b32 s43, s43, 13
    s_add_u32 s43, s43, s44
    s_add_u32 s43, s43, s46
    v_add_u32 v3, s43, v2
    global_load_dword v13, v3, s[30:31]
L_pf_n3:
    s_add_u32 s42, s42, s47
L_pref_done:
    s_endpgm
L_sel_lo:
    v_mov_b32 v2, 0
    v_lshlrev_b32 v3, 2, v1
    ds_write_b32 v3, v2 offset:8192
    ds_write_b32 v2, v2 offset:16640
    ds_write_b32 v2, v2 offset:16644
    s_cmp_eq_u32 s64, 0
    s_cbranch_scc1 L_lb_sel
    s_barrier
L_lb_sel:
    v_lshlrev_b32 v2, 4, v0
    v_add_u32 v3, 12288, v2
    v_add_u32 v2, 4096, v2
    v_lshlrev_b32 v4, 1, v0
    v_sub_u32 v4, 2047, v4
    v_add_u32 v5, -1, v4
    v_add_u32 v6, 0xfffffc00, v4
    v_add_u32 v7, 0xfffffc00, v5
    v_lshlrev_b32 v8, 3, v0
    s_mul_i32 s44, s38, 43
    s_lshr_b32 s44, s44, 7
    s_mul_i32 s44, s44, 252
    s_mul_i32 s45, s38, 12
    s_add_u32 s44, s44, s45
    v_lshrrev_b32 v9, 4, v1
    v_mul_u32_u24 v9, 72, v9
    v_bfe_u32 v10, v1, 1, 1
    v_mul_u32_u24 v10, 36, v10
    v_add_u32 v10, v9, v10
    v_add_u32 v9, s44, v10
    s_cmp_eq_u32 s38, 0
    s_cselect_b32 s44, 0, 252
    s_add_u32 s44, s44, s45
    s_add_u32 s44, s44, 600
    v_add_u32 v10, s44, v10
    s_mov_b32 s43, 65536
    v_lshl_add_u32 v11, v0, 4, s43
    v_add_u32 v12, 8192, v11
    v_lshrrev_b32 v13, 3, v0
    v_lshlrev_b32 v13, 2, v13
    v_and_b32 v61, 7, v1
    v_lshlrev_b32 v61, 5, v61
    s_mov_b32 s56, 0xff00ff00
    s_mov_b32 s57, 0xff00ff00
    s_mov_b32 s59, 0
    s_mov_b32 s65, 8
    s_movk_i32 s58, 1152
    s_mov_b32 s60, 0x01010101
    s_mov_b32 s61, 0x01010101
    v_mov_b32 v14, 0
    v_mov_b32 v15, 4
    v_and_b32 v16, 15, v1
    v_lshlrev_b32 v16, 2, v16
    v_and_b32 v17, 0x30, v1
    v_and_b32 v18, 12, v1
    v_and_b32 v19, 1, v1
    v_lshl_add_u32 v18, v19, 4, v18
    s_mov_b32 s42, 0
    s_mov_b32 s54, 0xffff
    s_mov_b32 s55, 4294901760
    v_mov_b32 v39, s41
    v_mov_b32 v43, s41
    v_mov_b32 v47, s41
    s_waitcnt vmcnt(0) lgkmcnt(0)
    s_barrier
L_pollS:
    global_load_dwordx4 v[20:23], v2, s[36:37] sc1
    global_load_dwordx4 v[24:27], v3, s[36:37] sc1
    s_add_u32 s42, s42, 1
    s_cmp_ge_u32 s42, 65536
    s_cbranch_scc1 L_pollS_done
    s_waitcnt vmcnt(0)
    v_cmp_ne_u32 s[46:47], s41, v23
    v_cmp_ne_u32 vcc, s41, v27
    s_nop 0
    s_or_b64 exec, vcc, s[46:47]
    s_cbranch_scc1 L_pollS
L_pollS_done:
    s_mov_b64 exec, -1
    s_waitcnt vmcnt(0)
    v_and_b32 v28, s54, v22
    v_lshrrev_b32 v29, 16, v22
    v_and_b32 v30, s54, v26
    v_lshrrev_b32 v31, 16, v26
    v_lshl_or_b32 v28, v28, 11, v4
    v_lshl_or_b32 v29, v29, 11, v5
    v_lshl_or_b32 v30, v30, 11, v6
    v_lshl_or_b32 v31, v31, 11, v7
    v_max3_u32 v32, v28, v29, v30
    v_med3_u32 v33, v28, v29, v30
    v_med3_u32 v33, v32, v33, v31
    v_max_u32 v32, v32, v31
    s_nop 1
    v_min_u32_dpp v34, v32, v32 row_ror:8 row_mask:0xf bank_mask:0xf
    v_max_u32_dpp v32, v32, v32 row_ror:8 row_mask:0xf bank_mask:0xf
    v_max_u32_dpp v33, v33, v33 row_ror:8 row_mask:0xf bank_mask:0xf
    v_max_u32 v33, v33, v34
    v_min_u32_dpp v34, v32, v32 row_ror:4 row_mask:0xf bank_mask:0xf
    v_max_u32_dpp v32, v32, v32 row_ror:4 row_mask:0xf bank_mask:0xf
    v_max_u32_dpp v33, v33, v33 row_ror:4 row_mask:0xf bank_mask:0xf
    v_max_u32 v33, v33, v34
    v_min_u32_dpp v34, v32, v32 row_ror:2 row_mask:0xf bank_mask:0xf
    v_max_u32_dpp v32, v32, v32 row_ror:2 row_mask:0xf bank_mask:0xf
    v_max_u32_dpp v33, v33, v33 row_ror:2 row_mask:0xf bank_mask:0xf
    v_max_u32 v33, v33, v34
    v_min_u32_dpp v34, v32, v32 row_ror:1 row_mask:0xf bank_mask:0xf
    v_max_u32_dpp v32, v32, v32 row_ror:1 row_mask:0xf bank_mask:0xf
    v_max_u32_dpp v33, v33, v33 row_ror:1 row_mask:0xf bank_mask:0xf
    v_max_u32 v33, v33, v34
    v_cndmask_b32 v34, v32, v33, s[56:57]
    ds_write_b32 v13, v34 offset:16384
    s_waitcnt lgkmcnt(0)
    s_barrier
    ds_read_b128 v[48:51], v61 offset:16384
    ds_read_b128 v[52:55], v61 offset:16400
    s_waitcnt lgkmcnt(1)
    v_sub_u32 v48, v34, v48
    v_alignbit_b32 v35, 0, v48, 31
    v_sub_u32 v49, v34, v49
    v_alignbit_b32 v35, v35, v49, 31
    v_sub_u32 v50, v34, v50
    v_alignbit_b32 v35, v35, v50, 31
    v_sub_u32 v51, v34, v51
    v_alignbit_b32 v35, v35, v51, 31
    s_waitcnt lgkmcnt(0)
    v_sub_u32 v52, v34, v52
    v_alignbit_b32 v35, v35, v52, 31
    v_sub_u32 v53, v34, v53
    v_alignbit_b32 v35, v35, v53, 31
    v_sub_u32 v54, v34, v54
    v_alignbit_b32 v35, v35, v54, 31
    v_sub_u32 v55, v34, v55
    v_alignbit_b32 v35, v35, v55, 31
    v_bcnt_u32_b32 v35, v35, 0
    s_nop 1
    v_add_u32_dpp v35, v35, v35 quad_perm:[1,0,3,2] row_mask:0xf bank_mask:0xf
    s_nop 1
    v_add_u32_dpp v35, v35, v35 quad_perm:[2,3,0,1] row_mask:0xf bank_mask:0xf
    s_nop 1
    v_add_u32_dpp v35, v35, v35 row_half_mirror row_mask:0xf bank_mask:0xf
    v_min_u32 v35, 8, v35
    v_lshlrev_b32 v35, 2, v35
    ds_write_b32 v35, v34 offset:16672
    s_waitcnt lgkmcnt(0)
    s_barrier
L_sel_got:
    ds_read_b32 v34, v18 offset:16672
    ds_read_b32 v33, v14 offset:16700
    s_waitcnt lgkmcnt(1)
    v_and_b32 v36, 2047, v34
    v_sub_u32 v36, 2047, v36
    v_mad_u32_u24 v62, v36, s58, v9
    global_load_dwordx3 v[40:42], v62, s[4:5]
    s_cmp_ge_u32 s38, 4
    s_cbranch_scc1 L_sel_one
    v_mad_u32_u24 v62, v36, s58, v10
    global_load_dwordx3 v[44:46], v62, s[4:5]
L_sel_one:
    ds_write_b64 v8, v[20:21] offset:0
    ds_write_b64 v8, v[24:25] offset:4096
    s_waitcnt lgkmcnt(2)
    v_cmp_le_u32 s[46:47], v33, v28
    v_cmp_le_u32 s[48:49], v33, v29
    v_cmp_le_u32 s[50:51], v33, v30
    v_cmp_le_u32 s[52:53], v33, v31
    v_lshlrev_b32 v19, 2, v36
    s_bcnt1_i32_b64 s44, s[46:47]
    s_bcnt1_i32_b64 s45, s[48:49]
    s_bcnt1_i32_b64 s62, s[50:51]
    s_bcnt1_i32_b64 s63, s[52:53]
    s_add_u32 s44, s44, s45
    s_add_u32 s62, s62, s63
    s_add_u32 s44, s44, s62
    v_mov_b32 v35, s44
    s_mov_b64 exec, 1
    ds_add_u32 v14, v35 offset:16644
    s_mov_b64 exec, -1
    s_waitcnt lgkmcnt(0)
    s_barrier
    ds_read_b32 v35, v14 offset:16644
    ds_read_b32 v37, v19 offset:0
    s_waitcnt lgkmcnt(0)
    v_max_u32 v35, s59, v35
    v_cmp_ne_u32 vcc, s65, v35
    s_cbranch_vccnz L_sel_fb
    v_and_b32 v50, s55, v37
    v_rcp_f32 v50, v50
    v_lshlrev_b32 v48, 16, v37
    v_mul_f32 v48, v48, v50
    s_cmp_ge_u32 s38, 4
    s_cbranch_scc1 L_sel_w
    s_waitcnt vmcnt(1)
    v_lshlrev_b32 v52, 16, v40
    v_and_b32 v53, s55, v40
    v_lshlrev_b32 v54, 16, v41
    v_and_b32 v55, s55, v41
    v_lshlrev_b32 v56, 16, v42
    v_and_b32 v57, s55, v42
    v_pk_fma_f32 v[52:53], v[52:53], v[50:51], v[48:49] op_sel_hi:[1,0,0] neg_lo:[0,0,1] neg_hi:[0,0,1]
    v_pk_fma_f32 v[54:55], v[54:55], v[50:51], v[48:49] op_sel_hi:[1,0,0] neg_lo:[0,0,1] neg_hi:[0,0,1]
    v_pk_fma_f32 v[56:57], v[56:57], v[50:51], v[48:49] op_sel_hi:[1,0,0] neg_lo:[0,0,1] neg_hi:[0,0,1]
    v_cvt_pk_bf16_f32 v40, v52, v53
    v_cvt_pk_bf16_f32 v41, v54, v55
    v_cvt_pk_bf16_f32 v42, v56, v57
    global_store_dwordx4 v11, v[40:43], s[36:37] sc1
    s_waitcnt vmcnt(1)
    v_lshlrev_b32 v52, 16, v44
    v_and_b32 v53, s55, v44
    v_lshlrev_b32 v54, 16, v45
    v_and_b32 v55, s55, v45
    v_lshlrev_b32 v56, 16, v46
    v_and_b32 v57, s55, v46
    v_pk_fma_f32 v[52:53], v[52:53], v[50:51], v[48:49] op_sel_hi:[1,0,0] neg_lo:[0,0,1] neg_hi:[0,0,1]
    v_pk_fma_f32 v[54:55], v[54:55], v[50:51], v[48:49] op_sel_hi:[1,0,0] neg_lo:[0,0,1] neg_hi:[0,0,1]
    v_pk_fma_f32 v[56:57], v[56:57], v[50:51], v[48:49] op_sel_hi:[1,0,0] neg_lo:[0,0,1] neg_hi:[0,0,1]
    v_cvt_pk_bf16_f32 v44, v52, v53
    v_cvt_pk_bf16_f32 v45, v54, v55
    v_cvt_pk_bf16_f32 v46, v56, v57
    global_store_dwordx4 v12, v[44:47], s[36:37] sc1
    s_branch L_sel_done
L_sel_w:
    s_waitcnt vmcnt(0)
    v_lshlrev_b32 v52, 16, v40
    v_and_b32 v53, s55, v40
    v_lshlrev_b32 v54, 16, v41
    v_and_b32 v55, s55, v41
    v_lshlrev_b32 v56, 16, v42
    v_and_b32 v57, s55, v42
    v_pk_fma_f32 v[52:53], v[52:53], v[50:51], v[48:49] op_sel_hi:[1,0,0] neg_lo:[0,0,1] neg_hi:[0,0,1]
    v_pk_fma_f32 v[54:55], v[54:55], v[50:51], v[48:49] op_sel_hi:[1,0,0] neg_lo:[0,0,1] neg_hi:[0,0,1]
    v_pk_fma_f32 v[56:57], v[56:57], v[50:51], v[48:49] op_sel_hi:[1,0,0] neg_lo:[0,0,1] neg_hi:[0,0,1]
    v_cvt_pk_bf16_f32 v40, v52, v53
    v_cvt_pk_bf16_f32 v41, v54, v55
    v_cvt_pk_bf16_f32 v42, v56, v57
    global_store_dwordx4 v11, v[40:43], s[36:37] sc1
    s_lshl3_add_u32 s44, s2, s38
    s_cmp_lg_u32 s44, 2047
    s_cbranch_scc1 L_sel_done
    v_lshlrev_b32 v38, 5, v34
    v_and_b32 v38, s55, v38
    v_ashrrev_i32 v35, 31, v38
    v_not_b32 v35, v35
    v_or_b32 v35, 0x80000000, v35
    v_xor_b32 v38, v38, v35
    v_and_b32 v38, s55, v38
    v_mul_f32 v38, 3216550459, v38
    v_exp_f32 v38, v38
    s_nop 0
    v_add_f32 v38, 1.0, v38
    v_rcp_f32 v38, v38
    s_nop 0
    v_cvt_pk_bf16_f32 v38, v38, v38
    v_and_b32 v38, s55, v38
    s_add_u32 s43, s43, 12288
    v_lshl_add_u32 v35, v18, 2, s43
    s_mov_b64 exec, 0x3333
    global_store_dwordx4 v35, v[36:39], s[36:37] sc1
    s_mov_b64 exec, -1
L_sel_done:
    s_cmp_lg_u32 s38, 4
    s_cbranch_scc1 L_agg_done
    v_mul_u32_u24 v2, 16, v1
    v_add_u32 v2, 262144, v2
    v_and_b32 v3, 7, v1
    v_mul_u32_u24 v3, 16, v3
    v_add_u32 v3, 263168, v3
    v_mov_b32 v6, 278528
    s_mov_b32 s42, 0
L_agg:
    global_load_dword v4, v2, s[36:37] sc1
    global_load_dword v5, v3, s[36:37] sc1
    s_add_u32 s42, s42, 1
    s_cmp_ge_u32 s42, 65536
    s_cbranch_scc1 L_agg_go
    s_waitcnt vmcnt(0)
    v_cmp_ne_u32 s[46:47], s41, v4
    v_cmp_ne_u32 vcc, s41, v5
    s_nop 0
    s_or_b64 exec, vcc, s[46:47]
    s_cbranch_scc1 L_agg
L_agg_go:
    s_mov_b64 exec, 1
    global_store_dword v6, v39, s[36:37] sc1
L_agg_done:
L_sel_end:
    s_endpgm
L_sel_fb:
    s_mov_b32 s59, -1
    s_mov_b32 s65, -1
    s_waitcnt vmcnt(0)
    s_mov_b64 exec, s[46:47]
    ds_add_rtn_u32 v52, v14, v15 offset:16640
    s_mov_b64 exec, s[48:49]
    ds_add_rtn_u32 v53, v14, v15 offset:16640
    s_mov_b64 exec, s[50:51]
    ds_add_rtn_u32 v54, v14, v15 offset:16640
    s_mov_b64 exec, s[52:53]
    ds_add_rtn_u32 v55, v14, v15 offset:16640
    s_waitcnt lgkmcnt(0)
    ds_write_b32 v55, v31 offset:8192
    s_mov_b64 exec, s[50:51]
    ds_write_b32 v54, v30 offset:8192
    s_mov_b64 exec, s[48:49]
    ds_write_b32 v53, v29 offset:8192
    s_mov_b64 exec, s[46:47]
    ds_write_b32 v52, v28 offset:8192
    s_mov_b64 exec, -1
    s_waitcnt lgkmcnt(0)
    s_barrier
    ds_read_b32 v34, v16 offset:8192
    ds_read_b128 v[48:51], v17 offset:8192
    ds_read_b32 v33, v14 offset:16640
    s_waitcnt lgkmcnt(1)
    v_sub_u32 v48, v34, v48
    v_sub_u32 v49, v34, v49
    v_sub_u32 v50, v34, v50
    v_sub_u32 v51, v34, v51
    v_lshrrev_b32 v48, 31, v48
    v_lshrrev_b32 v49, 31, v49
    v_lshrrev_b32 v50, 31, v50
    v_lshrrev_b32 v51, 31, v51
    v_add3_u32 v48, v48, v49, v50
    v_add_u32 v35, v48, v51
    v_add_u32 v48, v48, v51
    s_nop 1
    v_permlane16_swap_b32 v35, v48
    v_add_u32 v49, v35, v48
    v_add_u32 v35, v35, v48
    s_nop 1
    v_permlane32_swap_b32 v35, v49
    v_add_u32 v35, v35, v49
    v_cmp_gt_u32 vcc, 8, v35
    v_lshlrev_b32 v35, 2, v35
    s_waitcnt lgkmcnt(0)
    v_readfirstlane_b32 s45, v33
    s_mov_b64 exec, vcc
    ds_write_b32 v35, v34 offset:16672
    s_mov_b64 exec, -1
    s_cmp_gt_u32 s45, 64
    s_cbranch_scc1 L_sel_slow
    s_branch L_sel_got
L_sel_slow:
    s_waitcnt lgkmcnt(0)
    s_barrier
    v_lshlrev_b32 v16, 2, v0
    s_mov_b32 s47, 0
L_slow_outer:
    ds_read_b32 v34, v16 offset:8192
    v_mov_b32 v35, 0
    v_mov_b32 v17, 0
    s_mov_b32 s46, 0
L_slow_inner:
    ds_read_b32 v36, v17 offset:8192
    v_add_u32 v17, 4, v17
    s_add_u32 s46, s46, 4
    s_waitcnt lgkmcnt(0)
    v_cmp_gt_u32 vcc, v36, v34
    s_nop 1
    v_addc_co_u32 v35, vcc, 0, v35, vcc
    s_cmp_lt_u32 s46, s45
    s_cbranch_scc1 L_slow_inner
    v_cmp_gt_u32 vcc, 8, v35
    v_cmp_gt_u32 s[48:49], s45, v16
    v_lshlrev_b32 v35, 2, v35
    s_and_b64 exec, vcc, s[48:49]
    ds_write_b32 v35, v34 offset:16672
    s_mov_b64 exec, -1
    v_add_u32 v16, 2048, v16
    s_add_u32 s47, s47, 2048
    s_cmp_lt_u32 s47, s45
    s_cbranch_scc1 L_slow_outer
    s_waitcnt lgkmcnt(0)
    s_barrier
    s_branch L_sel_got
L_helper:
    v_mov_b32 v42, 147328
    v_mov_b32 v4, 1
    s_mov_b64 exec, 1
    ds_write_b32 v42, v59
    ds_add_u32 v42, v4 offset:4
    s_mov_b64 exec, -1
    s_lshl_b32 s63, s62, 3
    v_add_u32 v8, 0xffffff00, v0
    v_mul_u32_u24 v64, 2304, v8
    v_add_u32 v64, s63, v64
    v_add_u32 v65, 1152, v64
    v_add_u32 v66, 589824, v64
    v_add_u32 v67, 589824, v65
    v_add_u32 v68, 1179648, v64
    v_add_u32 v69, 1179648, v65
    v_add_u32 v70, 1769472, v64
    v_add_u32 v71, 1769472, v65
    s_mov_b32 s42, 0
L_hsync:
    ds_read_b32 v4, v42 offset:4
    s_add_u32 s42, s42, 1
    s_cmp_ge_u32 s42, 65536
    s_cbranch_scc1 L_hs_out
    s_waitcnt lgkmcnt(0)
    v_cmp_ne_u32 vcc, 4, v4
    s_cbranch_vccnz L_hsync
L_hs_out:
    global_load_dwordx2 v[10:11], v64, s[4:5]
    global_load_dwordx2 v[12:13], v65, s[4:5]
    global_load_dwordx2 v[14:15], v66, s[4:5]
    global_load_dwordx2 v[16:17], v67, s[4:5]
    v_lshlrev_b32 v2, 4, v8
    v_add_u32 v2, 8192, v2
    v_add_u32 v3, 8192, v2
    v_lshlrev_b32 v9, 2, v8
    v_lshrrev_b32 v42, 7, v8
    v_mul_u32_u24 v42, 1280, v42
    v_bfe_u32 v43, v8, 1, 2
    v_mul_u32_u24 v43, 320, v43
    v_add_u32 v42, v42, v43
    v_bfe_u32 v43, v8, 3, 4
    v_lshl_add_u32 v42, v43, 4, v42
    v_and_b32 v43, 1, v8
    v_add_u32 v8, 109952, v9
    v_lshl_add_u32 v9, v43, 3, v42
    s_mov_b32 s48, 4294901760
    v_and_b32 v240, 15, v1
    v_lshrrev_b32 v241, 1, v1
    v_and_b32 v241, 24, v241
    s_mov_b32 s51, 0x05040100
    s_and_b32 s56, s38, 3
    s_mov_b32 s53, 0x3f803f80
    s_lshl_b32 s57, s56, 2
    s_lshr_b32 s49, 0xc4536b, s57
    s_lshr_b32 s58, 0x297353, s57
    s_and_b32 s49, s49, 15
    s_and_b32 s58, s58, 15
    s_bfm_b32 s49, s58, s49
    s_lshl_b32 s56, s56, 10
    s_add_u32 s56, s56, 141184
    v_lshlrev_b32 v242, v240, s49
    v_lshrrev_b32 v242, v241, v242
    v_lshl_add_u32 v245, v1, 4, s56
    v_bfe_i32 v243, v242, 0, 1
    v_bfe_i32 v244, v242, 1, 1
    v_perm_b32 v243, v244, v243, s51
    v_and_b32 v248, s53, v243
    v_bfe_i32 v243, v242, 2, 1
    v_bfe_i32 v244, v242, 3, 1
    v_perm_b32 v243, v244, v243, s51
    v_and_b32 v249, s53, v243
    v_bfe_i32 v243, v242, 4, 1
    v_bfe_i32 v244, v242, 5, 1
    v_perm_b32 v243, v244, v243, s51
    v_and_b32 v250, s53, v243
    v_bfe_i32 v243, v242, 6, 1
    v_bfe_i32 v244, v242, 7, 1
    v_perm_b32 v243, v244, v243, s51
    v_and_b32 v251, s53, v243
    ds_write_b128 v245, v[248:251]
    s_and_b32 s56, s38, 1
    s_cselect_b32 s53, -1, s53
    s_or_b32 s56, s56, 4
    s_lshl_b32 s57, s56, 2
    s_lshr_b32 s49, 0xc4536b, s57
    s_lshr_b32 s58, 0x297353, s57
    s_and_b32 s49, s49, 15
    s_and_b32 s58, s58, 15
    s_bfm_b32 s49, s58, s49
    s_lshl_b32 s56, s56, 10
    s_add_u32 s56, s56, 141184
    v_lshlrev_b32 v242, v240, s49
    v_lshrrev_b32 v242, v241, v242
    v_lshl_add_u32 v245, v1, 4, s56
    v_bfe_i32 v243, v242, 0, 1
    v_bfe_i32 v244, v242, 1, 1
    v_perm_b32 v243, v244, v243, s51
    v_and_b32 v248, s53, v243
    v_bfe_i32 v243, v242, 2, 1
    v_bfe_i32 v244, v242, 3, 1
    v_perm_b32 v243, v244, v243, s51
    v_and_b32 v249, s53, v243
    v_bfe_i32 v243, v242, 4, 1
    v_bfe_i32 v244, v242, 5, 1
    v_perm_b32 v243, v244, v243, s51
    v_and_b32 v250, s53, v243
    v_bfe_i32 v243, v242, 6, 1
    v_bfe_i32 v244, v242, 7, 1
    v_perm_b32 v243, v244, v243, s51
    v_and_b32 v251, s53, v243
    ds_write_b128 v245, v[248:251]
    s_mov_b32 s60, 0x10001a0a
    s_mov_b32 s61, 0x3e342a20
    s_lshl_b32 s59, s39, 3
    s_lshr_b64 s[60:61], s[60:61], s59
    s_and_b32 s60, s60, 0xff
    s_lshl_b32 s59, s39, 2
    s_lshr_b32 s61, 0xaaaaaa66, s59
    s_and_b32 s61, s61, 15
    s_movk_i32 s59, 10923
    s_cmp_eq_u32 s61, 10
    s_cselect_b32 s59, 6554, s59
    s_cmp_lt_u32 s39, 2
    s_cselect_b32 s42, 24, 16
    s_sub_u32 s43, s38, 4
    s_mul_i32 s43, s43, s42
    s_add_u32 s65, s43, s40
    s_movk_i32 s42, 12
    s_cmp_eq_u32 s61, 10
    s_cselect_b32 s42, 32, s42
    s_mul_i32 s43, s61, 9
    s_sub_u32 s43, s43, s42
    s_mov_b32 s46, 0
    s_add_u32 s46, s46, s65
    s_cmp_lt_u32 s46, s42
    s_cselect_b64 s[54:55], -1, 1
    s_cselect_b32 s46, s46, 0
    s_add_u32 s43, s43, s46
    s_mul_i32 s46, s43, s59
    s_lshr_b32 s46, s46, 16
    s_mul_i32 s47, s46, s61
    s_sub_u32 s43, s43, s47
    s_add_u32 s43, s43, s60
    s_mul_i32 s43, s43, 576
    s_lshl_b32 s46, s46, 6
    s_add_u32 s43, s43, s46
    v_add_lshl_u32 v62, v1, s43, 7
    s_movk_i32 s42, 12
    s_cmp_eq_u32 s61, 10
    s_cselect_b32 s42, 32, s42
    s_mul_i32 s43, s61, 9
    s_sub_u32 s43, s43, s42
    s_cmp_lt_u32 s39, 2
    s_cselect_b32 s46, 96, 64
    s_add_u32 s46, s46, s65
    s_cmp_lt_u32 s46, s42
    s_cselect_b64 s[50:51], -1, 1
    s_cselect_b32 s46, s46, 0
    s_add_u32 s43, s43, s46
    s_mul_i32 s46, s43, s59
    s_lshr_b32 s46, s46, 16
    s_mul_i32 s47, s46, s61
    s_sub_u32 s43, s43, s47
    s_add_u32 s43, s43, s60
    s_mul_i32 s43, s43, 576
    s_lshl_b32 s46, s46, 6
    s_add_u32 s43, s43, s46
    v_add_lshl_u32 v46, v1, s43, 7
    s_waitcnt vmcnt(2)
    global_load_dwordx4 v[26:29], v2, s[36:37] offset:-4096 sc1
    global_load_dwordx4 v[30:33], v2, s[36:37] offset:0 sc1
    global_load_dwordx4 v[34:37], v3, s[36:37] offset:-4096 sc1
    global_load_dwordx4 v[38:41], v3, s[36:37] offset:0 sc1
    s_and_b32 s56, s40, 15
    s_and_b32 s57, s38, 3
    s_lshl2_add_u32 s56, s56, s57
    s_cmp_lt_u32 s40, 16
    s_cselect_b32 s57, 16, 32
    s_cselect_b64 s[66:67], 0xffff, -1
    s_mul_i32 s56, s56, s57
    s_add_u32 s56, s56, 1024
    v_and_b32 v5, 31, v1
    v_add_u32 v5, s56, v5
    v_mul_u32_u24 v5, 1152, v5
    s_lshr_b32 s56, s62, 4
    s_lshl_b32 s56, s56, 7
    v_add_u32 v5, s56, v5
    s_mov_b32 exec_lo, s66
    s_mov_b32 exec_hi, 0
    global_load_dword v61, v5, s[4:5]
    s_mov_b64 exec, -1
    s_waitcnt vmcnt(7)
    v_lshlrev_b32 v72, 16, v10
    v_lshlrev_b32 v73, 16, v12
    v_and_b32 v74, s48, v10
    v_and_b32 v75, s48, v12
    v_lshlrev_b32 v76, 16, v11
    v_lshlrev_b32 v77, 16, v13
    v_and_b32 v78, s48, v11
    v_and_b32 v79, s48, v13
    s_waitcnt vmcnt(5)
    v_lshlrev_b32 v80, 16, v14
    v_lshlrev_b32 v81, 16, v16
    v_and_b32 v82, s48, v14
    v_and_b32 v83, s48, v16
    v_lshlrev_b32 v84, 16, v15
    v_lshlrev_b32 v85, 16, v17
    v_and_b32 v86, s48, v15
    v_and_b32 v87, s48, v17
    s_setprio 3
    s_mov_b32 s49, 3216550459
    s_mov_b32 s42, 0
    s_waitcnt vmcnt(1)
    v_cmp_ne_u32 s[56:57], s41, v29
    v_cmp_ne_u32 s[58:59], s41, v33
    v_cmp_ne_u32 s[60:61], s41, v37
    v_cmp_ne_u32 vcc, s41, v41
    s_or_b64 s[56:57], s[56:57], s[58:59]
    s_or_b64 s[60:61], s[60:61], vcc
    s_or_b64 vcc, s[56:57], s[60:61]
    s_cbranch_vccnz L_pollA
L_pollA_done:
    global_load_dwordx2 v[18:19], v68, s[4:5]
    global_load_dwordx2 v[20:21], v69, s[4:5]
    v_and_b32 v170, s48, v26
    v_and_b32 v171, s48, v27
    v_rcp_f32 v170, v170
    v_rcp_f32 v171, v171
    v_lshlrev_b32 v168, 16, v26
    v_lshlrev_b32 v169, 16, v27
    v_mul_f32 v170, s49, v170
    v_mul_f32 v171, s49, v171
    v_mul_f32 v168, v168, v170
    v_mul_f32 v169, v169, v171
    v_pk_fma_f32 v[104:105], v[72:73], v[170:171], v[168:169] neg_lo:[0,0,1] neg_hi:[0,0,1]
    v_cvt_pk_bf16_f32 v172, v104, v105
    v_pk_fma_f32 v[106:107], v[74:75], v[170:171], v[168:169] neg_lo:[0,0,1] neg_hi:[0,0,1]
    v_cvt_pk_bf16_f32 v173, v106, v107
    v_pk_fma_f32 v[108:109], v[76:77], v[170:171], v[168:169] neg_lo:[0,0,1] neg_hi:[0,0,1]
    v_cvt_pk_bf16_f32 v174, v108, v109
    v_pk_fma_f32 v[110:111], v[78:79], v[170:171], v[168:169] neg_lo:[0,0,1] neg_hi:[0,0,1]
    v_cvt_pk_bf16_f32 v175, v110, v111
    ds_write_b32 v8, v172 offset:0
    ds_write_b32 v8, v173 offset:4608
    ds_write_b32 v8, v174 offset:9216
    ds_write_b32 v8, v175 offset:13824
    v_and_b32 v170, s48, v30
    v_and_b32 v171, s48, v31
    v_rcp_f32 v170, v170
    v_rcp_f32 v171, v171
    v_lshlrev_b32 v168, 16, v30
    v_lshlrev_b32 v169, 16, v31
    v_mul_f32 v170, s49, v170
    v_mul_f32 v171, s49, v171
    v_mul_f32 v168, v168, v170
    v_mul_f32 v169, v169, v171
    v_pk_fma_f32 v[112:113], v[80:81], v[170:171], v[168:169] neg_lo:[0,0,1] neg_hi:[0,0,1]
    v_cvt_pk_bf16_f32 v172, v112, v113
    v_pk_fma_f32 v[114:115], v[82:83], v[170:171], v[168:169] neg_lo:[0,0,1] neg_hi:[0,0,1]
    v_cvt_pk_bf16_f32 v173, v114, v115
    v_pk_fma_f32 v[116:117], v[84:85], v[170:171], v[168:169] neg_lo:[0,0,1] neg_hi:[0,0,1]
    v_cvt_pk_bf16_f32 v174, v116, v117
    v_pk_fma_f32 v[118:119], v[86:87], v[170:171], v[168:169] neg_lo:[0,0,1] neg_hi:[0,0,1]
    v_cvt_pk_bf16_f32 v175, v118, v119
    ds_write_b32 v8, v172 offset:1024
    ds_write_b32 v8, v173 offset:5632
    ds_write_b32 v8, v174 offset:10240
    ds_write_b32 v8, v175 offset:14848
    global_load_dwordx2 v[22:23], v70, s[4:5]
    global_load_dwordx2 v[24:25], v71, s[4:5]
    s_setprio 0
    s_waitcnt lgkmcnt(0)
    s_barrier
    s_mov_b64 exec, s[54:55]
    global_load_dword v47, v62, s[30:31]
    s_mov_b64 exec, -1
    v_exp_f32 v136, v104
    v_exp_f32 v137, v105
    v_exp_f32 v138, v106
    v_exp_f32 v139, v107
    v_exp_f32 v140, v108
    v_exp_f32 v141, v109
    v_exp_f32 v142, v110
    v_exp_f32 v143, v111
    v_add_f32 v136, 1.0, v136
    v_add_f32 v137, 1.0, v137
    v_add_f32 v138, 1.0, v138
    v_add_f32 v139, 1.0, v139
    v_add_f32 v140, 1.0, v140
    v_add_f32 v141, 1.0, v141
    v_add_f32 v142, 1.0, v142
    v_add_f32 v143, 1.0, v143
    v_rcp_f32 v136, v136
    v_rcp_f32 v137, v137
    v_rcp_f32 v138, v138
    v_rcp_f32 v139, v139
    v_rcp_f32 v140, v140
    v_rcp_f32 v141, v141
    v_rcp_f32 v142, v142
    v_rcp_f32 v143, v143
    v_mul_f32 v136, v104, v136
    v_mul_f32 v137, v105, v137
    v_mul_f32 v138, v106, v138
    v_mul_f32 v139, v107, v139
    v_mul_f32 v140, v108, v140
    v_mul_f32 v141, v109, v141
    v_mul_f32 v142, v110, v142
    v_mul_f32 v143, v111, v143
    s_waitcnt vmcnt(3)
    v_lshlrev_b32 v88, 16, v18
    v_lshlrev_b32 v89, 16, v20
    v_and_b32 v90, s48, v18
    v_and_b32 v91, s48, v20
    v_lshlrev_b32 v92, 16, v19
    v_lshlrev_b32 v93, 16, v21
    v_and_b32 v94, s48, v19
    v_and_b32 v95, s48, v21
    v_and_b32 v170, s48, v34
    v_and_b32 v171, s48, v35
    v_rcp_f32 v170, v170
    v_rcp_f32 v171, v171
    v_lshlrev_b32 v168, 16, v34
    v_lshlrev_b32 v169, 16, v35
    v_mul_f32 v170, s49, v170
    v_mul_f32 v171, s49, v171
    v_mul_f32 v168, v168, v170
    v_mul_f32 v169, v169, v171
    v_fma_f32 v120, v88, v170, -v168
    v_fma_f32 v121, v89, v171, -v169
    v_cvt_pk_bf16_f32 v172, v120, v121
    v_fma_f32 v122, v90, v170, -v168
    v_fma_f32 v123, v91, v171, -v169
    v_cvt_pk_bf16_f32 v173, v122, v123
    v_fma_f32 v124, v92, v170, -v168
    v_fma_f32 v125, v93, v171, -v169
    v_cvt_pk_bf16_f32 v174, v124, v125
    v_fma_f32 v126, v94, v170, -v168
    v_fma_f32 v127, v95, v171, -v169
    v_cvt_pk_bf16_f32 v175, v126, v127
    ds_write_b32 v8, v172 offset:2048
    ds_write_b32 v8, v173 offset:6656
    ds_write_b32 v8, v174 offset:11264
    ds_write_b32 v8, v175 offset:15872
    s_waitcnt lgkmcnt(0)
    s_barrier
    ds_read_b64 v[176:177], v9 offset:0
    ds_read_b64 v[178:179], v9 offset:10240
    ds_read_b64 v[180:181], v9 offset:20480
    ds_read_b64 v[182:183], v9 offset:30720
    s_waitcnt lgkmcnt(3)
    v_fma_f32 v176, v176, v136, v72
    v_fma_f32 v177, v177, v137, v73
    s_waitcnt lgkmcnt(2)
    v_fma_f32 v178, v178, v138, v74
    v_fma_f32 v179, v179, v139, v75
    s_waitcnt lgkmcnt(1)
    v_fma_f32 v180, v180, v140, v76
    v_fma_f32 v181, v181, v141, v77
    s_waitcnt lgkmcnt(0)
    v_fma_f32 v182, v182, v142, v78
    v_fma_f32 v183, v183, v143, v79
    v_cvt_pk_bf16_f32 v184, v176, v178
    v_cvt_pk_bf16_f32 v185, v180, v182
    v_cvt_pk_bf16_f32 v186, v177, v179
    v_cvt_pk_bf16_f32 v187, v181, v183
    global_store_dwordx2 v64, v[184:185], s[32:33]
    global_store_dwordx2 v65, v[186:187], s[32:33]
    s_waitcnt vmcnt(3)
    v_lshlrev_b32 v96, 16, v22
    v_lshlrev_b32 v97, 16, v24
    v_and_b32 v98, s48, v22
    v_and_b32 v99, s48, v24
    v_lshlrev_b32 v100, 16, v23
    v_lshlrev_b32 v101, 16, v25
    v_and_b32 v102, s48, v23
    v_and_b32 v103, s48, v25
    v_and_b32 v170, s48, v38
    v_and_b32 v171, s48, v39
    v_rcp_f32 v170, v170
    v_rcp_f32 v171, v171
    v_lshlrev_b32 v168, 16, v38
    v_lshlrev_b32 v169, 16, v39
    v_mul_f32 v170, s49, v170
    v_mul_f32 v171, s49, v171
    v_mul_f32 v168, v168, v170
    v_mul_f32 v169, v169, v171
    v_fma_f32 v128, v96, v170, -v168
    v_fma_f32 v129, v97, v171, -v169
    v_cvt_pk_bf16_f32 v172, v128, v129
    v_fma_f32 v130, v98, v170, -v168
    v_fma_f32 v131, v99, v171, -v169
    v_cvt_pk_bf16_f32 v173, v130, v131
    v_fma_f32 v132, v100, v170, -v168
    v_fma_f32 v133, v101, v171, -v169
    v_cvt_pk_bf16_f32 v174, v132, v133
    v_fma_f32 v134, v102, v170, -v168
    v_fma_f32 v135, v103, v171, -v169
    v_cvt_pk_bf16_f32 v175, v134, v135
    ds_write_b32 v8, v172 offset:3072
    ds_write_b32 v8, v173 offset:7680
    ds_write_b32 v8, v174 offset:12288
    ds_write_b32 v8, v175 offset:16896
    v_exp_f32 v144, v112
    v_exp_f32 v145, v113
    v_exp_f32 v146, v114
    v_exp_f32 v147, v115
    v_exp_f32 v148, v116
    v_exp_f32 v149, v117
    v_exp_f32 v150, v118
    v_exp_f32 v151, v119
    v_add_f32 v144, 1.0, v144
    v_add_f32 v145, 1.0, v145
    v_add_f32 v146, 1.0, v146
    v_add_f32 v147, 1.0, v147
    v_add_f32 v148, 1.0, v148
    v_add_f32 v149, 1.0, v149
    v_add_f32 v150, 1.0, v150
    v_add_f32 v151, 1.0, v151
    v_rcp_f32 v144, v144
    v_rcp_f32 v145, v145
    v_rcp_f32 v146, v146
    v_rcp_f32 v147, v147
    v_rcp_f32 v148, v148
    v_rcp_f32 v149, v149
    v_rcp_f32 v150, v150
    v_rcp_f32 v151, v151
    v_mul_f32 v144, v112, v144
    v_mul_f32 v145, v113, v145
    v_mul_f32 v146, v114, v146
    v_mul_f32 v147, v115, v147
    v_mul_f32 v148, v116, v148
    v_mul_f32 v149, v117, v149
    v_mul_f32 v150, v118, v150
    v_mul_f32 v151, v119, v151
    s_waitcnt lgkmcnt(0)
    s_barrier
    ds_read_b64 v[176:177], v9 offset:2560
    ds_read_b64 v[178:179], v9 offset:12800
    ds_read_b64 v[180:181], v9 offset:23040
    ds_read_b64 v[182:183], v9 offset:33280
    s_waitcnt lgkmcnt(3)
    v_fma_f32 v176, v176, v144, v80
    v_fma_f32 v177, v177, v145, v81
    s_waitcnt lgkmcnt(2)
    v_fma_f32 v178, v178, v146, v82
    v_fma_f32 v179, v179, v147, v83
    s_waitcnt lgkmcnt(1)
    v_fma_f32 v180, v180, v148, v84
    v_fma_f32 v181, v181, v149, v85
    s_waitcnt lgkmcnt(0)
    v_fma_f32 v182, v182, v150, v86
    v_fma_f32 v183, v183, v151, v87
    v_cvt_pk_bf16_f32 v188, v176, v178
    v_cvt_pk_bf16_f32 v189, v180, v182
    v_cvt_pk_bf16_f32 v190, v177, v179
    v_cvt_pk_bf16_f32 v191, v181, v183
    global_store_dwordx2 v66, v[188:189], s[32:33]
    global_store_dwordx2 v67, v[190:191], s[32:33]
    v_exp_f32 v152, v120
    v_exp_f32 v153, v121
    v_exp_f32 v154, v122
    v_exp_f32 v155, v123
    v_exp_f32 v156, v124
    v_exp_f32 v157, v125
    v_exp_f32 v158, v126
    v_exp_f32 v159, v127
    v_add_f32 v152, 1.0, v152
    v_add_f32 v153, 1.0, v153
    v_add_f32 v154, 1.0, v154
    v_add_f32 v155, 1.0, v155
    v_add_f32 v156, 1.0, v156
    v_add_f32 v157, 1.0, v157
    v_add_f32 v158, 1.0, v158
    v_add_f32 v159, 1.0, v159
    v_rcp_f32 v152, v152
    v_rcp_f32 v153, v153
    v_rcp_f32 v154, v154
    v_rcp_f32 v155, v155
    v_rcp_f32 v156, v156
    v_rcp_f32 v157, v157
    v_rcp_f32 v158, v158
    v_rcp_f32 v159, v159
    v_mul_f32 v152, v120, v152
    v_mul_f32 v153, v121, v153
    v_mul_f32 v154, v122, v154
    v_mul_f32 v155, v123, v155
    v_mul_f32 v156, v124, v156
    v_mul_f32 v157, v125, v157
    v_mul_f32 v158, v126, v158
    v_mul_f32 v159, v127, v159
    v_lshlrev_b32 v42, 1, v0
    v_add_u32 v42, 146880, v42
    v_xor_b32 v43, 1, v42
    s_barrier
    ds_read_b64 v[176:177], v9 offset:5120
    ds_read_b64 v[178:179], v9 offset:15360
    ds_read_b64 v[180:181], v9 offset:25600
    ds_read_b64 v[182:183], v9 offset:35840
    s_waitcnt lgkmcnt(3)
    v_fma_f32 v176, v176, v152, v88
    v_fma_f32 v177, v177, v153, v89
    s_waitcnt lgkmcnt(2)
    v_fma_f32 v178, v178, v154, v90
    v_fma_f32 v179, v179, v155, v91
    s_waitcnt lgkmcnt(1)
    v_fma_f32 v180, v180, v156, v92
    v_fma_f32 v181, v181, v157, v93
    s_waitcnt lgkmcnt(0)
    v_fma_f32 v182, v182, v158, v94
    v_fma_f32 v183, v183, v159, v95
    v_cvt_pk_bf16_f32 v192, v176, v178
    v_cvt_pk_bf16_f32 v193, v180, v182
    v_cvt_pk_bf16_f32 v194, v177, v179
    v_cvt_pk_bf16_f32 v195, v181, v183
    global_store_dwordx2 v68, v[192:193], s[32:33]
    global_store_dwordx2 v69, v[194:195], s[32:33]
    v_exp_f32 v160, v128
    v_exp_f32 v161, v129
    v_exp_f32 v162, v130
    v_exp_f32 v163, v131
    v_exp_f32 v164, v132
    v_exp_f32 v165, v133
    v_exp_f32 v166, v134
    v_exp_f32 v167, v135
    v_add_f32 v160, 1.0, v160
    v_add_f32 v161, 1.0, v161
    v_add_f32 v162, 1.0, v162
    v_add_f32 v163, 1.0, v163
    v_add_f32 v164, 1.0, v164
    v_add_f32 v165, 1.0, v165
    v_add_f32 v166, 1.0, v166
    v_add_f32 v167, 1.0, v167
    v_rcp_f32 v160, v160
    v_rcp_f32 v161, v161
    v_rcp_f32 v162, v162
    v_rcp_f32 v163, v163
    v_rcp_f32 v164, v164
    v_rcp_f32 v165, v165
    v_rcp_f32 v166, v166
    v_rcp_f32 v167, v167
    v_mul_f32 v160, v128, v160
    v_mul_f32 v161, v129, v161
    v_mul_f32 v162, v130, v162
    v_mul_f32 v163, v131, v163
    v_mul_f32 v164, v132, v164
    v_mul_f32 v165, v133, v165
    v_mul_f32 v166, v134, v166
    v_mul_f32 v167, v135, v167
    s_barrier
    s_cmp_lt_u32 s38, 6
    s_cbranch_scc1 L_t6
    s_barrier
    ds_read_u8 v44, v42 offset:1536
    ds_read_u8 v45, v43 offset:1536
    ds_read_b64 v[176:177], v9 offset:7680
    ds_read_b64 v[178:179], v9 offset:17920
    ds_read_b64 v[180:181], v9 offset:28160
    ds_read_b64 v[182:183], v9 offset:38400
    s_waitcnt lgkmcnt(3)
    v_cmp_eq_u32 s[66:67], 0, v44
    v_cmp_eq_u32 s[68:69], 0, v45
    v_pk_fma_f32 v[176:177], v[176:177], v[160:161], v[96:97]
    s_waitcnt lgkmcnt(2)
    v_pk_fma_f32 v[178:179], v[178:179], v[162:163], v[98:99]
    s_waitcnt lgkmcnt(1)
    v_pk_fma_f32 v[180:181], v[180:181], v[164:165], v[100:101]
    s_waitcnt lgkmcnt(0)
    v_pk_fma_f32 v[182:183], v[182:183], v[166:167], v[102:103]
    v_cvt_pk_bf16_f32 v196, v176, v178
    v_cvt_pk_bf16_f32 v197, v180, v182
    v_cvt_pk_bf16_f32 v198, v177, v179
    v_cvt_pk_bf16_f32 v199, v181, v183
    s_mov_b64 exec, s[66:67]
    global_store_dwordx2 v70, v[196:197], s[32:33]
    s_mov_b64 exec, s[68:69]
    global_store_dwordx2 v71, v[198:199], s[32:33]
    s_waitcnt vmcnt(2)
    s_barrier
    s_endpgm
L_t6:
    ds_read_u8 v44, v42 offset:1536
    ds_read_u8 v45, v43 offset:1536
    ds_read_b64 v[176:177], v9 offset:7680
    ds_read_b64 v[178:179], v9 offset:17920
    ds_read_b64 v[180:181], v9 offset:28160
    ds_read_b64 v[182:183], v9 offset:38400
    s_waitcnt lgkmcnt(3)
    v_cmp_eq_u32 s[66:67], 0, v44
    v_cmp_eq_u32 s[68:69], 0, v45
    v_fma_f32 v176, v176, v160, v96
    v_fma_f32 v177, v177, v161, v97
    s_waitcnt lgkmcnt(2)
    v_fma_f32 v178, v178, v162, v98
    v_fma_f32 v179, v179, v163, v99
    s_waitcnt lgkmcnt(1)
    v_fma_f32 v180, v180, v164, v100
    v_fma_f32 v181, v181, v165, v101
    s_waitcnt lgkmcnt(0)
    v_fma_f32 v182, v182, v166, v102
    v_fma_f32 v183, v183, v167, v103
    v_cvt_pk_bf16_f32 v196, v176, v178
    v_cvt_pk_bf16_f32 v197, v180, v182
    v_cvt_pk_bf16_f32 v198, v177, v179
    v_cvt_pk_bf16_f32 v199, v181, v183
    s_mov_b64 exec, s[66:67]
    global_store_dwordx2 v70, v[196:197], s[32:33]
    s_mov_b64 exec, s[68:69]
    global_store_dwordx2 v71, v[198:199], s[32:33]
    s_barrier
    s_waitcnt vmcnt(2)
    s_barrier
    s_endpgm
L_pollA:
    s_mov_b64 exec, vcc
    global_load_dwordx4 v[26:29], v2, s[36:37] offset:-4096 sc1
    global_load_dwordx4 v[30:33], v2, s[36:37] offset:0 sc1
    global_load_dwordx4 v[34:37], v3, s[36:37] offset:-4096 sc1
    global_load_dwordx4 v[38:41], v3, s[36:37] offset:0 sc1
    s_mov_b64 exec, -1
    s_add_u32 s42, s42, 1
    s_waitcnt vmcnt(0)
    v_cmp_ne_u32 s[56:57], s41, v29
    v_cmp_ne_u32 s[58:59], s41, v33
    v_cmp_ne_u32 s[60:61], s41, v37
    v_cmp_ne_u32 vcc, s41, v41
    s_or_b64 s[56:57], s[56:57], s[58:59]
    s_or_b64 s[60:61], s[60:61], vcc
    s_or_b64 vcc, s[56:57], s[60:61]
    s_cbranch_vccz L_pollA_done
    s_cmp_lt_u32 s42, 65536
    s_cbranch_scc1 L_pollA
    s_branch L_pollA_done
L_low:
    s_mov_b32 s42, s62
    s_mul_i32 s48, s38, 3328
    s_add_u32 s48, s48, 127872
    s_mul_i32 s49, s38, 4608
    s_add_u32 s49, s49, 109440
    v_mov_b32 v4, 0
    v_mov_b32 v5, 0
    v_mov_b32 v6, 0
    v_mov_b32 v7, 0
    v_lshl_add_u32 v3, v1, 4, s48
    v_lshl_add_u32 v9, v1, 3, s49
    ds_write_b128 v3, v[4:7]
    ds_write_b128 v3, v[4:7] offset:1024
    ds_write_b128 v3, v[4:7] offset:2048
    ds_write_b128 v3, v[4:7] offset:2304
    ds_write_b64 v9, v[4:5]
    v_lshlrev_b32 v9, 3, v0
    v_add_u32 v9, 147392, v9
    ds_write_b64 v9, v[4:5]
    v_and_b32 v252, 15, v1
    v_lshrrev_b32 v253, 4, v1
    s_and_b32 s50, s38, 3
    s_lshl_b32 s50, s50, 9
    s_lshr_b32 s51, s38, 2
    s_lshl_b32 s51, s51, 8
    s_add_u32 s50, s50, s51
    s_mov_b32 m0, s50
    v_mov_b32 v209, 0x3f80
    ds_write_addtid_b32 v209
    ds_write_addtid_b32 v209 offset:256
    v_and_b32 v200, 31, v1
    v_lshrrev_b32 v201, 5, v1
    v_mul_u32_u24 v208, 2064, v200
    v_lshl_add_u32 v208, v201, 4, v208
    v_add_u32 v208, s50, v208
    v_add_u32 v209, 66048, v208
    v_mov_b32 v207, s63
    v_lshl_add_u32 v207, s38, 1, v207
    global_load_ushort v207, v207, s[20:21]
    s_waitcnt lgkmcnt(0)
    s_bitcmp0_b32 s38, 1
    s_cselect_b32 s44, s44, s45
    s_lshl_b32 s45, s44, 16
    s_and_b32 s44, s44, 4294901760
    s_bitcmp0_b32 s38, 0
    s_cselect_b32 s44, s45, s44
    v_mov_b32 v148, 1069066811
    v_mul_f32 v147, s44, v148
    v_fma_f32 v148, s44, v148, -v147
    v_mov_b32 v149, 0x32a5705f
    v_fma_f32 v148, s44, v149, v148
    v_exp_f32 v147, v147
    v_mul_f32 v148, 0x3f317218, v148
    v_fma_f32 v147, v147, v148, v147
    v_cvt_pk_bf16_f32 v147, v147, v147
    v_and_b32 v148, 4294901760, v147
    v_mul_f32 v149, 1056308720, v148
    s_and_b32 s56, s40, 15
    s_and_b32 s57, s38, 3
    s_lshl2_add_u32 s56, s56, s57
    s_cmp_lt_u32 s40, 16
    s_cselect_b32 s57, 16, 32
    s_cselect_b64 s[66:67], 0xffff, -1
    s_mul_i32 s56, s56, s57
    s_add_u32 s56, s56, 0
    v_and_b32 v5, 31, v1
    v_add_u32 v5, s56, v5
    v_mul_u32_u24 v5, 1152, v5
    s_lshr_b32 s56, s62, 4
    s_lshl_b32 s56, s56, 7
    v_add_u32 v5, s56, v5
    s_mov_b32 exec_lo, s66
    s_mov_b32 exec_hi, 0
    global_load_dword v254, v5, s[4:5]
    s_mov_b64 exec, -1
    s_mov_b32 s60, 0x10001a0a
    s_mov_b32 s61, 0x3e342a20
    s_lshl_b32 s59, s39, 3
    s_lshr_b64 s[60:61], s[60:61], s59
    s_and_b32 s60, s60, 0xff
    s_lshl_b32 s59, s39, 2
    s_lshr_b32 s61, 0xaaaaaa66, s59
    s_and_b32 s61, s61, 15
    s_movk_i32 s59, 10923
    s_cmp_eq_u32 s61, 10
    s_cselect_b32 s59, 6554, s59
    s_cmp_lt_u32 s39, 2
    s_cselect_b32 s65, 24, 16
    s_mul_i32 s65, s65, s38
    s_add_u32 s65, s65, s40
    s_movk_i32 s51, 18
    s_cmp_eq_u32 s61, 10
    s_cselect_b32 s51, 10, s51
    s_sub_u32 s54, 3, s60
    s_and_b32 s54, s54, 7
    s_cmp_ge_u32 s65, s51
    s_cselect_b32 s56, 8, 0
    s_cselect_b32 s57, s51, 0
    s_add_u32 s54, s54, s56
    s_sub_u32 s57, s65, s57
    s_cmp_lt_u32 s57, s51
    s_cselect_b32 s54, s54, 99
    s_cmp_lt_u32 s54, s61
    s_cselect_b64 s[52:53], -1, 1
    s_cselect_b32 s54, s54, 0
    s_cselect_b32 s57, s57, 0
    s_add_u32 s54, s54, s60
    s_lshl_b32 s54, s54, 7
    s_andn2_b32 s56, s57, 1
    s_add_u32 s56, s56, 0
    s_mul_i32 s56, s56, 9216
    s_add_u32 s54, s54, s56
    v_and_b32 v4, 31, v1
    v_mul_u32_u24 v4, 18, v4
    v_lshrrev_b32 v5, 5, v1
    v_add_u32 v4, v4, v5
    v_mul_u32_u24 v4, 9216, v4
    v_add_u32 v4, s54, v4
    s_bitcmp0_b32 s57, 0
    s_cselect_b64 s[56:57], s[26:27], s[28:29]
    s_mov_b64 exec, s[52:53]
    global_load_dword v254, v4, s[56:57]
    s_mov_b64 exec, -1
    s_waitcnt vmcnt(3)
    v_lshlrev_b32 v150, 16, v140
    v_lshlrev_b32 v151, 16, v141
    v_lshlrev_b32 v152, 16, v142
    v_lshlrev_b32 v153, 16, v143
    v_lshlrev_b32 v154, 16, v144
    v_lshlrev_b32 v155, 16, v145
    v_pk_mul_f32 v[150:151], v[150:151], v[148:149] op_sel_hi:[1,0]
    v_mul_f32 v150, 1069066811, v150
    v_mul_f32 v151, 1042479491, v151
    v_mul_f32 v186, 0x41000000, v150
    v_mul_f32 v187, 0x41000000, v151
    v_exp_f32 v186, v186
    v_fract_f32 v187, v187
    v_cos_f32 v158, v187
    v_sin_f32 v159, v187
    v_exp_f32 v190, v150
    v_fract_f32 v191, v151
    v_cos_f32 v156, v191
    v_sin_f32 v157, v191
    v_mul_f32 v194, 0x43800000, v150
    v_mul_f32 v195, 0x43800000, v151
    v_exp_f32 v194, v194
    v_fract_f32 v195, v195
    v_cos_f32 v160, v195
    v_sin_f32 v161, v195
.p2align 3
    v_pk_mul_f32 v[162:163], v[154:155], v[152:153] op_sel:[0,0] op_sel_hi:[0,1]
    v_pk_fma_f32 v[76:77], v[154:155], v[152:153], v[162:163] op_sel:[1,1,0] op_sel_hi:[1,0,1] neg_lo:[0,1,0]
    v_pk_mul_f32 v[158:159], v[158:159], v[186:187] op_sel_hi:[1,0]
    v_pk_mul_f32 v[156:157], v[156:157], v[190:191] op_sel_hi:[1,0]
    v_pk_mul_f32 v[160:161], v[160:161], v[194:195] op_sel_hi:[1,0]
    v_pk_mul_f32 v[76:77], v[76:77], v[148:149] op_sel:[0,1] op_sel_hi:[1,1] neg_hi:[0,1]
    v_pk_mul_f32 v[162:163], v[158:159], v[158:159] op_sel:[0,0] op_sel_hi:[0,1]
    v_pk_fma_f32 v[94:95], v[158:159], v[158:159], v[162:163] op_sel:[1,1,0] op_sel_hi:[1,0,1] neg_lo:[0,1,0]
    v_pk_mul_f32 v[162:163], v[94:95], v[158:159] op_sel:[0,0] op_sel_hi:[0,1]
    v_pk_fma_f32 v[96:97], v[94:95], v[158:159], v[162:163] op_sel:[1,1,0] op_sel_hi:[1,0,1] neg_lo:[0,1,0]
    v_pk_mul_f32 v[162:163], v[96:97], v[158:159] op_sel:[0,0] op_sel_hi:[0,1]
    v_pk_fma_f32 v[98:99], v[96:97], v[158:159], v[162:163] op_sel:[1,1,0] op_sel_hi:[1,0,1] neg_lo:[0,1,0]
    v_cvt_pk_bf16_f32 v164, v158, v159
    v_cvt_pk_bf16_f32 v165, v94, v95
    v_cvt_pk_bf16_f32 v166, v96, v97
    v_cvt_pk_bf16_f32 v167, v98, v99
    ds_write_addtid_b32 v164 offset:2064
    ds_write_addtid_b32 v165 offset:4128
    ds_write_addtid_b32 v166 offset:6192
    ds_write_addtid_b32 v167 offset:8256
    v_pk_mul_f32 v[162:163], v[98:99], v[158:159] op_sel:[0,0] op_sel_hi:[0,1]
    v_pk_fma_f32 v[100:101], v[98:99], v[158:159], v[162:163] op_sel:[1,1,0] op_sel_hi:[1,0,1] neg_lo:[0,1,0]
    v_pk_mul_f32 v[162:163], v[100:101], v[158:159] op_sel:[0,0] op_sel_hi:[0,1]
    v_pk_fma_f32 v[102:103], v[100:101], v[158:159], v[162:163] op_sel:[1,1,0] op_sel_hi:[1,0,1] neg_lo:[0,1,0]
    v_pk_mul_f32 v[162:163], v[102:103], v[158:159] op_sel:[0,0] op_sel_hi:[0,1]
    v_pk_fma_f32 v[104:105], v[102:103], v[158:159], v[162:163] op_sel:[1,1,0] op_sel_hi:[1,0,1] neg_lo:[0,1,0]
    v_pk_mul_f32 v[162:163], v[104:105], v[158:159] op_sel:[0,0] op_sel_hi:[0,1]
    v_pk_fma_f32 v[106:107], v[104:105], v[158:159], v[162:163] op_sel:[1,1,0] op_sel_hi:[1,0,1] neg_lo:[0,1,0]
    v_cvt_pk_bf16_f32 v164, v100, v101
    v_cvt_pk_bf16_f32 v165, v102, v103
    v_cvt_pk_bf16_f32 v166, v104, v105
    v_cvt_pk_bf16_f32 v167, v106, v107
    ds_write_addtid_b32 v164 offset:10320
    ds_write_addtid_b32 v165 offset:12384
    ds_write_addtid_b32 v166 offset:14448
    ds_write_addtid_b32 v167 offset:16512
    v_pk_mul_f32 v[162:163], v[106:107], v[158:159] op_sel:[0,0] op_sel_hi:[0,1]
    v_pk_fma_f32 v[108:109], v[106:107], v[158:159], v[162:163] op_sel:[1,1,0] op_sel_hi:[1,0,1] neg_lo:[0,1,0]
    v_pk_mul_f32 v[162:163], v[108:109], v[158:159] op_sel:[0,0] op_sel_hi:[0,1]
    v_pk_fma_f32 v[110:111], v[108:109], v[158:159], v[162:163] op_sel:[1,1,0] op_sel_hi:[1,0,1] neg_lo:[0,1,0]
    v_pk_mul_f32 v[162:163], v[110:111], v[158:159] op_sel:[0,0] op_sel_hi:[0,1]
    v_pk_fma_f32 v[112:113], v[110:111], v[158:159], v[162:163] op_sel:[1,1,0] op_sel_hi:[1,0,1] neg_lo:[0,1,0]
    v_pk_mul_f32 v[162:163], v[112:113], v[158:159] op_sel:[0,0] op_sel_hi:[0,1]
    v_pk_fma_f32 v[94:95], v[112:113], v[158:159], v[162:163] op_sel:[1,1,0] op_sel_hi:[1,0,1] neg_lo:[0,1,0]
    v_cvt_pk_bf16_f32 v164, v108, v109
    v_cvt_pk_bf16_f32 v165, v110, v111
    v_cvt_pk_bf16_f32 v166, v112, v113
    v_cvt_pk_bf16_f32 v167, v94, v95
    ds_write_addtid_b32 v164 offset:18576
    ds_write_addtid_b32 v165 offset:20640
    ds_write_addtid_b32 v166 offset:22704
    ds_write_addtid_b32 v167 offset:24768
    v_pk_mul_f32 v[162:163], v[94:95], v[158:159] op_sel:[0,0] op_sel_hi:[0,1]
    v_pk_fma_f32 v[96:97], v[94:95], v[158:159], v[162:163] op_sel:[1,1,0] op_sel_hi:[1,0,1] neg_lo:[0,1,0]
    v_pk_mul_f32 v[162:163], v[96:97], v[158:159] op_sel:[0,0] op_sel_hi:[0,1]
    v_pk_fma_f32 v[98:99], v[96:97], v[158:159], v[162:163] op_sel:[1,1,0] op_sel_hi:[1,0,1] neg_lo:[0,1,0]
    v_pk_mul_f32 v[162:163], v[98:99], v[158:159] op_sel:[0,0] op_sel_hi:[0,1]
    v_pk_fma_f32 v[100:101], v[98:99], v[158:159], v[162:163] op_sel:[1,1,0] op_sel_hi:[1,0,1] neg_lo:[0,1,0]
    v_pk_mul_f32 v[162:163], v[100:101], v[158:159] op_sel:[0,0] op_sel_hi:[0,1]
    v_pk_fma_f32 v[102:103], v[100:101], v[158:159], v[162:163] op_sel:[1,1,0] op_sel_hi:[1,0,1] neg_lo:[0,1,0]
    v_cvt_pk_bf16_f32 v164, v96, v97
    v_cvt_pk_bf16_f32 v165, v98, v99
    v_cvt_pk_bf16_f32 v166, v100, v101
    v_cvt_pk_bf16_f32 v167, v102, v103
    ds_write_addtid_b32 v164 offset:26832
    ds_write_addtid_b32 v165 offset:28896
    ds_write_addtid_b32 v166 offset:30960
    ds_write_addtid_b32 v167 offset:33024
    v_pk_mul_f32 v[162:163], v[102:103], v[158:159] op_sel:[0,0] op_sel_hi:[0,1]
    v_pk_fma_f32 v[104:105], v[102:103], v[158:159], v[162:163] op_sel:[1,1,0] op_sel_hi:[1,0,1] neg_lo:[0,1,0]
    v_pk_mul_f32 v[162:163], v[104:105], v[158:159] op_sel:[0,0] op_sel_hi:[0,1]
    v_pk_fma_f32 v[106:107], v[104:105], v[158:159], v[162:163] op_sel:[1,1,0] op_sel_hi:[1,0,1] neg_lo:[0,1,0]
    v_pk_mul_f32 v[162:163], v[106:107], v[158:159] op_sel:[0,0] op_sel_hi:[0,1]
    v_pk_fma_f32 v[108:109], v[106:107], v[158:159], v[162:163] op_sel:[1,1,0] op_sel_hi:[1,0,1] neg_lo:[0,1,0]
    v_pk_mul_f32 v[162:163], v[108:109], v[158:159] op_sel:[0,0] op_sel_hi:[0,1]
    v_pk_fma_f32 v[110:111], v[108:109], v[158:159], v[162:163] op_sel:[1,1,0] op_sel_hi:[1,0,1] neg_lo:[0,1,0]
    v_cvt_pk_bf16_f32 v164, v104, v105
    v_cvt_pk_bf16_f32 v165, v106, v107
    v_cvt_pk_bf16_f32 v166, v108, v109
    v_cvt_pk_bf16_f32 v167, v110, v111
    ds_write_addtid_b32 v164 offset:35088
    ds_write_addtid_b32 v165 offset:37152
    ds_write_addtid_b32 v166 offset:39216
    ds_write_addtid_b32 v167 offset:41280
    v_pk_mul_f32 v[162:163], v[110:111], v[158:159] op_sel:[0,0] op_sel_hi:[0,1]
    v_pk_fma_f32 v[112:113], v[110:111], v[158:159], v[162:163] op_sel:[1,1,0] op_sel_hi:[1,0,1] neg_lo:[0,1,0]
    v_pk_mul_f32 v[162:163], v[112:113], v[158:159] op_sel:[0,0] op_sel_hi:[0,1]
    v_pk_fma_f32 v[94:95], v[112:113], v[158:159], v[162:163] op_sel:[1,1,0] op_sel_hi:[1,0,1] neg_lo:[0,1,0]
    v_pk_mul_f32 v[162:163], v[94:95], v[158:159] op_sel:[0,0] op_sel_hi:[0,1]
    v_pk_fma_f32 v[96:97], v[94:95], v[158:159], v[162:163] op_sel:[1,1,0] op_sel_hi:[1,0,1] neg_lo:[0,1,0]
    v_pk_mul_f32 v[162:163], v[96:97], v[158:159] op_sel:[0,0] op_sel_hi:[0,1]
    v_pk_fma_f32 v[98:99], v[96:97], v[158:159], v[162:163] op_sel:[1,1,0] op_sel_hi:[1,0,1] neg_lo:[0,1,0]
    v_cvt_pk_bf16_f32 v164, v112, v113
    v_cvt_pk_bf16_f32 v165, v94, v95
    v_cvt_pk_bf16_f32 v166, v96, v97
    v_cvt_pk_bf16_f32 v167, v98, v99
    ds_write_addtid_b32 v164 offset:43344
    ds_write_addtid_b32 v165 offset:45408
    ds_write_addtid_b32 v166 offset:47472
    ds_write_addtid_b32 v167 offset:49536
    v_pk_mul_f32 v[162:163], v[98:99], v[158:159] op_sel:[0,0] op_sel_hi:[0,1]
    v_pk_fma_f32 v[100:101], v[98:99], v[158:159], v[162:163] op_sel:[1,1,0] op_sel_hi:[1,0,1] neg_lo:[0,1,0]
    v_pk_mul_f32 v[162:163], v[100:101], v[158:159] op_sel:[0,0] op_sel_hi:[0,1]
    v_pk_fma_f32 v[102:103], v[100:101], v[158:159], v[162:163] op_sel:[1,1,0] op_sel_hi:[1,0,1] neg_lo:[0,1,0]
    v_pk_mul_f32 v[162:163], v[102:103], v[158:159] op_sel:[0,0] op_sel_hi:[0,1]
    v_pk_fma_f32 v[104:105], v[102:103], v[158:159], v[162:163] op_sel:[1,1,0] op_sel_hi:[1,0,1] neg_lo:[0,1,0]
    v_pk_mul_f32 v[162:163], v[104:105], v[158:159] op_sel:[0,0] op_sel_hi:[0,1]
    v_pk_fma_f32 v[106:107], v[104:105], v[158:159], v[162:163] op_sel:[1,1,0] op_sel_hi:[1,0,1] neg_lo:[0,1,0]
    v_cvt_pk_bf16_f32 v164, v100, v101
    v_cvt_pk_bf16_f32 v165, v102, v103
    v_cvt_pk_bf16_f32 v166, v104, v105
    v_cvt_pk_bf16_f32 v167, v106, v107
    ds_write_addtid_b32 v164 offset:51600
    ds_write_addtid_b32 v165 offset:53664
    ds_write_addtid_b32 v166 offset:55728
    ds_write_addtid_b32 v167 offset:57792
    v_pk_mul_f32 v[162:163], v[106:107], v[158:159] op_sel:[0,0] op_sel_hi:[0,1]
    v_pk_fma_f32 v[108:109], v[106:107], v[158:159], v[162:163] op_sel:[1,1,0] op_sel_hi:[1,0,1] neg_lo:[0,1,0]
    v_pk_mul_f32 v[162:163], v[108:109], v[158:159] op_sel:[0,0] op_sel_hi:[0,1]
    v_pk_fma_f32 v[110:111], v[108:109], v[158:159], v[162:163] op_sel:[1,1,0] op_sel_hi:[1,0,1] neg_lo:[0,1,0]
    v_pk_mul_f32 v[162:163], v[110:111], v[158:159] op_sel:[0,0] op_sel_hi:[0,1]
    v_pk_fma_f32 v[112:113], v[110:111], v[158:159], v[162:163] op_sel:[1,1,0] op_sel_hi:[1,0,1] neg_lo:[0,1,0]
    v_cvt_pk_bf16_f32 v164, v108, v109
    v_cvt_pk_bf16_f32 v165, v110, v111
    v_cvt_pk_bf16_f32 v166, v112, v113
    ds_write_addtid_b32 v164 offset:59856
    ds_write_addtid_b32 v165 offset:61920
    ds_write_addtid_b32 v166 offset:63984
    s_add_u32 s52, s50, 45056
    s_mov_b32 m0, s52
.p2align 3
    v_pk_mul_f32 v[162:163], v[76:77], v[156:157] op_sel:[0,0] op_sel_hi:[0,1] neg_hi:[0,1]
    v_pk_fma_f32 v[78:79], v[76:77], v[156:157], v[162:163] op_sel:[1,1,0] op_sel_hi:[1,0,1]
    v_pk_mul_f32 v[162:163], v[78:79], v[156:157] op_sel:[0,0] op_sel_hi:[0,1] neg_hi:[0,1]
    v_pk_fma_f32 v[80:81], v[78:79], v[156:157], v[162:163] op_sel:[1,1,0] op_sel_hi:[1,0,1]
    v_pk_mul_f32 v[162:163], v[80:81], v[156:157] op_sel:[0,0] op_sel_hi:[0,1] neg_hi:[0,1]
    v_pk_fma_f32 v[82:83], v[80:81], v[156:157], v[162:163] op_sel:[1,1,0] op_sel_hi:[1,0,1]
    v_cvt_pk_bf16_f32 v164, v76, v77
    v_cvt_pk_bf16_f32 v165, v78, v79
    v_cvt_pk_bf16_f32 v166, v80, v81
    v_cvt_pk_bf16_f32 v167, v82, v83
    ds_write_addtid_b32 v164 offset:62272
    ds_write_addtid_b32 v165 offset:20992
    ds_write_addtid_b32 v166 offset:23056
    ds_write_addtid_b32 v167 offset:25120
    v_pk_mul_f32 v[162:163], v[82:83], v[156:157] op_sel:[0,0] op_sel_hi:[0,1] neg_hi:[0,1]
    v_pk_fma_f32 v[84:85], v[82:83], v[156:157], v[162:163] op_sel:[1,1,0] op_sel_hi:[1,0,1]
    v_pk_mul_f32 v[162:163], v[84:85], v[156:157] op_sel:[0,0] op_sel_hi:[0,1] neg_hi:[0,1]
    v_pk_fma_f32 v[86:87], v[84:85], v[156:157], v[162:163] op_sel:[1,1,0] op_sel_hi:[1,0,1]
    v_pk_mul_f32 v[162:163], v[86:87], v[156:157] op_sel:[0,0] op_sel_hi:[0,1] neg_hi:[0,1]
    v_pk_fma_f32 v[88:89], v[86:87], v[156:157], v[162:163] op_sel:[1,1,0] op_sel_hi:[1,0,1]
    v_pk_mul_f32 v[162:163], v[88:89], v[156:157] op_sel:[0,0] op_sel_hi:[0,1] neg_hi:[0,1]
    v_pk_fma_f32 v[90:91], v[88:89], v[156:157], v[162:163] op_sel:[1,1,0] op_sel_hi:[1,0,1]
    v_cvt_pk_bf16_f32 v164, v84, v85
    v_cvt_pk_bf16_f32 v165, v86, v87
    v_cvt_pk_bf16_f32 v166, v88, v89
    v_cvt_pk_bf16_f32 v167, v90, v91
    ds_write_addtid_b32 v164 offset:27184
    ds_write_addtid_b32 v165 offset:29248
    ds_write_addtid_b32 v166 offset:31312
    ds_write_addtid_b32 v167 offset:33376
    v_pk_mul_f32 v[162:163], v[90:91], v[156:157] op_sel:[0,0] op_sel_hi:[0,1] neg_hi:[0,1]
    v_pk_fma_f32 v[92:93], v[90:91], v[156:157], v[162:163] op_sel:[1,1,0] op_sel_hi:[1,0,1]
    v_pk_mul_f32 v[162:163], v[80:81], v[160:161] op_sel:[0,0] op_sel_hi:[0,1] neg_hi:[0,1]
    v_pk_fma_f32 v[94:95], v[80:81], v[160:161], v[162:163] op_sel:[1,1,0] op_sel_hi:[1,0,1]
    v_pk_mul_f32 v[162:163], v[84:85], v[160:161] op_sel:[0,0] op_sel_hi:[0,1] neg_hi:[0,1]
    v_pk_fma_f32 v[96:97], v[84:85], v[160:161], v[162:163] op_sel:[1,1,0] op_sel_hi:[1,0,1]
    v_pk_mul_f32 v[162:163], v[88:89], v[160:161] op_sel:[0,0] op_sel_hi:[0,1] neg_hi:[0,1]
    v_pk_fma_f32 v[98:99], v[88:89], v[160:161], v[162:163] op_sel:[1,1,0] op_sel_hi:[1,0,1]
    v_cvt_pk_bf16_f32 v164, v92, v93
    v_cvt_pk_bf16_f32 v165, v94, v95
    v_cvt_pk_bf16_f32 v166, v96, v97
    v_cvt_pk_bf16_f32 v167, v98, v99
    ds_write_addtid_b32 v164 offset:35440
    ds_write_addtid_b32 v165 offset:37504
    ds_write_addtid_b32 v166 offset:39568
    ds_write_addtid_b32 v167 offset:41632
    v_pk_mul_f32 v[162:163], v[92:93], v[160:161] op_sel:[0,0] op_sel_hi:[0,1] neg_hi:[0,1]
    v_pk_fma_f32 v[100:101], v[92:93], v[160:161], v[162:163] op_sel:[1,1,0] op_sel_hi:[1,0,1]
    v_pk_mul_f32 v[162:163], v[96:97], v[160:161] op_sel:[0,0] op_sel_hi:[0,1] neg_hi:[0,1]
    v_pk_fma_f32 v[102:103], v[96:97], v[160:161], v[162:163] op_sel:[1,1,0] op_sel_hi:[1,0,1]
    v_pk_mul_f32 v[162:163], v[100:101], v[160:161] op_sel:[0,0] op_sel_hi:[0,1] neg_hi:[0,1]
    v_pk_fma_f32 v[104:105], v[100:101], v[160:161], v[162:163] op_sel:[1,1,0] op_sel_hi:[1,0,1]
    v_pk_mul_f32 v[162:163], v[102:103], v[160:161] op_sel:[0,0] op_sel_hi:[0,1] neg_hi:[0,1]
    v_pk_fma_f32 v[106:107], v[102:103], v[160:161], v[162:163] op_sel:[1,1,0] op_sel_hi:[1,0,1]
    v_cvt_pk_bf16_f32 v164, v100, v101
    v_cvt_pk_bf16_f32 v165, v102, v103
    v_cvt_pk_bf16_f32 v166, v104, v105
    v_cvt_pk_bf16_f32 v167, v106, v107
    ds_write_addtid_b32 v164 offset:43696
    ds_write_addtid_b32 v165 offset:45760
    ds_write_addtid_b32 v166 offset:47824
    ds_write_addtid_b32 v167 offset:49888
    v_pk_mul_f32 v[162:163], v[104:105], v[160:161] op_sel:[0,0] op_sel_hi:[0,1] neg_hi:[0,1]
    v_pk_fma_f32 v[108:109], v[104:105], v[160:161], v[162:163] op_sel:[1,1,0] op_sel_hi:[1,0,1]
    v_pk_mul_f32 v[162:163], v[108:109], v[160:161] op_sel:[0,0] op_sel_hi:[0,1] neg_hi:[0,1]
    v_pk_fma_f32 v[110:111], v[108:109], v[160:161], v[162:163] op_sel:[1,1,0] op_sel_hi:[1,0,1]
    v_pk_mul_f32 v[162:163], v[110:111], v[160:161] op_sel:[0,0] op_sel_hi:[0,1] neg_hi:[0,1]
    v_pk_fma_f32 v[112:113], v[110:111], v[160:161], v[162:163] op_sel:[1,1,0] op_sel_hi:[1,0,1]
    v_pk_mul_f32 v[162:163], v[112:113], v[160:161] op_sel:[0,0] op_sel_hi:[0,1] neg_hi:[0,1]
    v_pk_fma_f32 v[94:95], v[112:113], v[160:161], v[162:163] op_sel:[1,1,0] op_sel_hi:[1,0,1]
    v_cvt_pk_bf16_f32 v164, v108, v109
    v_cvt_pk_bf16_f32 v165, v110, v111
    v_cvt_pk_bf16_f32 v166, v112, v113
    v_cvt_pk_bf16_f32 v167, v94, v95
    ds_write_addtid_b32 v164 offset:51952
    ds_write_addtid_b32 v165 offset:54016
    ds_write_addtid_b32 v166 offset:56080
    ds_write_addtid_b32 v167 offset:58144
    v_pk_mul_f32 v[162:163], v[94:95], v[160:161] op_sel:[0,0] op_sel_hi:[0,1] neg_hi:[0,1]
    v_pk_fma_f32 v[96:97], v[94:95], v[160:161], v[162:163] op_sel:[1,1,0] op_sel_hi:[1,0,1]
    v_cvt_pk_bf16_f32 v164, v96, v97
    ds_write_addtid_b32 v164 offset:60208
    ds_read_b128 v[4:7], v209 offset:0
    ds_read_b128 v[8:11], v208 offset:0
    ds_read_b128 v[12:15], v209 offset:32
    ds_read_b128 v[16:19], v208 offset:32
    v_and_b32 v150, 4294901760, v140
    v_and_b32 v151, 4294901760, v141
    v_and_b32 v152, 4294901760, v142
    v_and_b32 v153, 4294901760, v143
    v_and_b32 v154, 4294901760, v144
    v_and_b32 v155, 4294901760, v145
    v_pk_mul_f32 v[150:151], v[150:151], v[148:149] op_sel_hi:[1,0]
    v_mul_f32 v150, 1069066811, v150
    v_mul_f32 v151, 1042479491, v151
    v_mul_f32 v186, 0x41000000, v150
    v_mul_f32 v187, 0x41000000, v151
    v_exp_f32 v186, v186
    v_fract_f32 v187, v187
    v_cos_f32 v158, v187
    v_sin_f32 v159, v187
    v_exp_f32 v190, v150
    v_fract_f32 v191, v151
    v_cos_f32 v156, v191
    v_sin_f32 v157, v191
    v_mul_f32 v194, 0x43800000, v150
    v_mul_f32 v195, 0x43800000, v151
    v_exp_f32 v194, v194
    v_fract_f32 v195, v195
    v_cos_f32 v160, v195
    v_sin_f32 v161, v195
    s_add_u32 s52, s50, 256
    s_mov_b32 m0, s52
.p2align 3
    v_pk_mul_f32 v[162:163], v[154:155], v[152:153] op_sel:[0,0] op_sel_hi:[0,1]
    v_pk_fma_f32 v[76:77], v[154:155], v[152:153], v[162:163] op_sel:[1,1,0] op_sel_hi:[1,0,1] neg_lo:[0,1,0]
    v_pk_mul_f32 v[158:159], v[158:159], v[186:187] op_sel_hi:[1,0]
    v_pk_mul_f32 v[156:157], v[156:157], v[190:191] op_sel_hi:[1,0]
    v_pk_mul_f32 v[160:161], v[160:161], v[194:195] op_sel_hi:[1,0]
    v_pk_mul_f32 v[76:77], v[76:77], v[148:149] op_sel:[0,1] op_sel_hi:[1,1] neg_hi:[0,1]
    v_pk_mul_f32 v[162:163], v[158:159], v[158:159] op_sel:[0,0] op_sel_hi:[0,1]
    v_pk_fma_f32 v[94:95], v[158:159], v[158:159], v[162:163] op_sel:[1,1,0] op_sel_hi:[1,0,1] neg_lo:[0,1,0]
    v_pk_mul_f32 v[162:163], v[94:95], v[158:159] op_sel:[0,0] op_sel_hi:[0,1]
    v_pk_fma_f32 v[96:97], v[94:95], v[158:159], v[162:163] op_sel:[1,1,0] op_sel_hi:[1,0,1] neg_lo:[0,1,0]
    v_pk_mul_f32 v[162:163], v[96:97], v[158:159] op_sel:[0,0] op_sel_hi:[0,1]
    v_pk_fma_f32 v[98:99], v[96:97], v[158:159], v[162:163] op_sel:[1,1,0] op_sel_hi:[1,0,1] neg_lo:[0,1,0]
    v_cvt_pk_bf16_f32 v164, v158, v159
    v_cvt_pk_bf16_f32 v165, v94, v95
    v_cvt_pk_bf16_f32 v166, v96, v97
    v_cvt_pk_bf16_f32 v167, v98, v99
    ds_write_addtid_b32 v164 offset:2064
    ds_write_addtid_b32 v165 offset:4128
    ds_write_addtid_b32 v166 offset:6192
    ds_write_addtid_b32 v167 offset:8256
    ds_read_b128 v[20:23], v209 offset:64
    ds_read_b128 v[24:27], v208 offset:64
    ds_read_b128 v[28:31], v209 offset:96
    v_pk_mul_f32 v[162:163], v[98:99], v[158:159] op_sel:[0,0] op_sel_hi:[0,1]
    v_pk_fma_f32 v[100:101], v[98:99], v[158:159], v[162:163] op_sel:[1,1,0] op_sel_hi:[1,0,1] neg_lo:[0,1,0]
    v_pk_mul_f32 v[162:163], v[100:101], v[158:159] op_sel:[0,0] op_sel_hi:[0,1]
    v_pk_fma_f32 v[102:103], v[100:101], v[158:159], v[162:163] op_sel:[1,1,0] op_sel_hi:[1,0,1] neg_lo:[0,1,0]
    v_pk_mul_f32 v[162:163], v[102:103], v[158:159] op_sel:[0,0] op_sel_hi:[0,1]
    v_pk_fma_f32 v[104:105], v[102:103], v[158:159], v[162:163] op_sel:[1,1,0] op_sel_hi:[1,0,1] neg_lo:[0,1,0]
    v_pk_mul_f32 v[162:163], v[104:105], v[158:159] op_sel:[0,0] op_sel_hi:[0,1]
    v_pk_fma_f32 v[106:107], v[104:105], v[158:159], v[162:163] op_sel:[1,1,0] op_sel_hi:[1,0,1] neg_lo:[0,1,0]
    v_cvt_pk_bf16_f32 v164, v100, v101
    v_cvt_pk_bf16_f32 v165, v102, v103
    v_cvt_pk_bf16_f32 v166, v104, v105
    v_cvt_pk_bf16_f32 v167, v106, v107
    ds_write_addtid_b32 v164 offset:10320
    ds_write_addtid_b32 v165 offset:12384
    ds_write_addtid_b32 v166 offset:14448
    ds_write_addtid_b32 v167 offset:16512
    ds_read_b128 v[32:35], v208 offset:96
    ds_read_b128 v[36:39], v209 offset:128
    ds_read_b128 v[40:43], v208 offset:128
    v_pk_mul_f32 v[162:163], v[106:107], v[158:159] op_sel:[0,0] op_sel_hi:[0,1]
    v_pk_fma_f32 v[108:109], v[106:107], v[158:159], v[162:163] op_sel:[1,1,0] op_sel_hi:[1,0,1] neg_lo:[0,1,0]
    v_pk_mul_f32 v[162:163], v[108:109], v[158:159] op_sel:[0,0] op_sel_hi:[0,1]
    v_pk_fma_f32 v[110:111], v[108:109], v[158:159], v[162:163] op_sel:[1,1,0] op_sel_hi:[1,0,1] neg_lo:[0,1,0]
    v_pk_mul_f32 v[162:163], v[110:111], v[158:159] op_sel:[0,0] op_sel_hi:[0,1]
    v_pk_fma_f32 v[112:113], v[110:111], v[158:159], v[162:163] op_sel:[1,1,0] op_sel_hi:[1,0,1] neg_lo:[0,1,0]
    v_pk_mul_f32 v[162:163], v[112:113], v[158:159] op_sel:[0,0] op_sel_hi:[0,1]
    v_pk_fma_f32 v[94:95], v[112:113], v[158:159], v[162:163] op_sel:[1,1,0] op_sel_hi:[1,0,1] neg_lo:[0,1,0]
    v_cvt_pk_bf16_f32 v164, v108, v109
    v_cvt_pk_bf16_f32 v165, v110, v111
    v_cvt_pk_bf16_f32 v166, v112, v113
    v_cvt_pk_bf16_f32 v167, v94, v95
    ds_write_addtid_b32 v164 offset:18576
    ds_write_addtid_b32 v165 offset:20640
    ds_write_addtid_b32 v166 offset:22704
    ds_write_addtid_b32 v167 offset:24768
    ds_read_b128 v[44:47], v209 offset:160
    ds_read_b128 v[48:51], v208 offset:160
    ds_read_b128 v[52:55], v209 offset:192
    v_pk_mul_f32 v[162:163], v[94:95], v[158:159] op_sel:[0,0] op_sel_hi:[0,1]
    v_pk_fma_f32 v[96:97], v[94:95], v[158:159], v[162:163] op_sel:[1,1,0] op_sel_hi:[1,0,1] neg_lo:[0,1,0]
    v_pk_mul_f32 v[162:163], v[96:97], v[158:159] op_sel:[0,0] op_sel_hi:[0,1]
    v_pk_fma_f32 v[98:99], v[96:97], v[158:159], v[162:163] op_sel:[1,1,0] op_sel_hi:[1,0,1] neg_lo:[0,1,0]
    v_pk_mul_f32 v[162:163], v[98:99], v[158:159] op_sel:[0,0] op_sel_hi:[0,1]
    v_pk_fma_f32 v[100:101], v[98:99], v[158:159], v[162:163] op_sel:[1,1,0] op_sel_hi:[1,0,1] neg_lo:[0,1,0]
    v_pk_mul_f32 v[162:163], v[100:101], v[158:159] op_sel:[0,0] op_sel_hi:[0,1]
    v_pk_fma_f32 v[102:103], v[100:101], v[158:159], v[162:163] op_sel:[1,1,0] op_sel_hi:[1,0,1] neg_lo:[0,1,0]
    v_cvt_pk_bf16_f32 v164, v96, v97
    v_cvt_pk_bf16_f32 v165, v98, v99
    v_cvt_pk_bf16_f32 v166, v100, v101
    v_cvt_pk_bf16_f32 v167, v102, v103
    ds_write_addtid_b32 v164 offset:26832
    ds_write_addtid_b32 v165 offset:28896
    ds_write_addtid_b32 v166 offset:30960
    ds_write_addtid_b32 v167 offset:33024
    ds_read_b128 v[56:59], v208 offset:192
    ds_read_b128 v[60:63], v209 offset:224
    ds_read_b128 v[64:67], v208 offset:224
    v_pk_mul_f32 v[162:163], v[102:103], v[158:159] op_sel:[0,0] op_sel_hi:[0,1]
    v_pk_fma_f32 v[104:105], v[102:103], v[158:159], v[162:163] op_sel:[1,1,0] op_sel_hi:[1,0,1] neg_lo:[0,1,0]
    v_pk_mul_f32 v[162:163], v[104:105], v[158:159] op_sel:[0,0] op_sel_hi:[0,1]
    v_pk_fma_f32 v[106:107], v[104:105], v[158:159], v[162:163] op_sel:[1,1,0] op_sel_hi:[1,0,1] neg_lo:[0,1,0]
    v_pk_mul_f32 v[162:163], v[106:107], v[158:159] op_sel:[0,0] op_sel_hi:[0,1]
    v_pk_fma_f32 v[108:109], v[106:107], v[158:159], v[162:163] op_sel:[1,1,0] op_sel_hi:[1,0,1] neg_lo:[0,1,0]
    v_pk_mul_f32 v[162:163], v[108:109], v[158:159] op_sel:[0,0] op_sel_hi:[0,1]
    v_pk_fma_f32 v[110:111], v[108:109], v[158:159], v[162:163] op_sel:[1,1,0] op_sel_hi:[1,0,1] neg_lo:[0,1,0]
    s_waitcnt lgkmcnt(15)
.p2align 3
    v_mfma_f32_32x32x16_bf16 v[224:239], v[4:7], v[8:11], 0
    v_cvt_pk_bf16_f32 v164, v104, v105
    v_cvt_pk_bf16_f32 v165, v106, v107
    v_cvt_pk_bf16_f32 v166, v108, v109
    v_cvt_pk_bf16_f32 v167, v110, v111
    ds_write_addtid_b32 v164 offset:35088
    ds_write_addtid_b32 v165 offset:37152
    ds_write_addtid_b32 v166 offset:39216
    ds_write_addtid_b32 v167 offset:41280
    v_pk_mul_f32 v[162:163], v[110:111], v[158:159] op_sel:[0,0] op_sel_hi:[0,1]
    v_pk_fma_f32 v[112:113], v[110:111], v[158:159], v[162:163] op_sel:[1,1,0] op_sel_hi:[1,0,1] neg_lo:[0,1,0]
    v_pk_mul_f32 v[162:163], v[112:113], v[158:159] op_sel:[0,0] op_sel_hi:[0,1]
    v_pk_fma_f32 v[94:95], v[112:113], v[158:159], v[162:163] op_sel:[1,1,0] op_sel_hi:[1,0,1] neg_lo:[0,1,0]
    v_pk_mul_f32 v[162:163], v[94:95], v[158:159] op_sel:[0,0] op_sel_hi:[0,1]
    v_pk_fma_f32 v[96:97], v[94:95], v[158:159], v[162:163] op_sel:[1,1,0] op_sel_hi:[1,0,1] neg_lo:[0,1,0]
    v_pk_mul_f32 v[162:163], v[96:97], v[158:159] op_sel:[0,0] op_sel_hi:[0,1]
    v_pk_fma_f32 v[98:99], v[96:97], v[158:159], v[162:163] op_sel:[1,1,0] op_sel_hi:[1,0,1] neg_lo:[0,1,0]
.p2align 3
    v_mfma_f32_32x32x16_bf16 v[224:239], v[12:15], v[16:19], v[224:239]
    v_cvt_pk_bf16_f32 v164, v112, v113
    v_cvt_pk_bf16_f32 v165, v94, v95
    v_cvt_pk_bf16_f32 v166, v96, v97
    v_cvt_pk_bf16_f32 v167, v98, v99
    ds_write_addtid_b32 v164 offset:43344
    ds_write_addtid_b32 v165 offset:45408
    ds_write_addtid_b32 v166 offset:47472
    ds_write_addtid_b32 v167 offset:49536
    v_pk_mul_f32 v[162:163], v[98:99], v[158:159] op_sel:[0,0] op_sel_hi:[0,1]
    v_pk_fma_f32 v[100:101], v[98:99], v[158:159], v[162:163] op_sel:[1,1,0] op_sel_hi:[1,0,1] neg_lo:[0,1,0]
    v_pk_mul_f32 v[162:163], v[100:101], v[158:159] op_sel:[0,0] op_sel_hi:[0,1]
    v_pk_fma_f32 v[102:103], v[100:101], v[158:159], v[162:163] op_sel:[1,1,0] op_sel_hi:[1,0,1] neg_lo:[0,1,0]
    v_pk_mul_f32 v[162:163], v[102:103], v[158:159] op_sel:[0,0] op_sel_hi:[0,1]
    v_pk_fma_f32 v[104:105], v[102:103], v[158:159], v[162:163] op_sel:[1,1,0] op_sel_hi:[1,0,1] neg_lo:[0,1,0]
    v_pk_mul_f32 v[162:163], v[104:105], v[158:159] op_sel:[0,0] op_sel_hi:[0,1]
    v_pk_fma_f32 v[106:107], v[104:105], v[158:159], v[162:163] op_sel:[1,1,0] op_sel_hi:[1,0,1] neg_lo:[0,1,0]
.p2align 3
    v_mfma_f32_32x32x16_bf16 v[224:239], v[20:23], v[24:27], v[224:239]
    v_cvt_pk_bf16_f32 v164, v100, v101
    v_cvt_pk_bf16_f32 v165, v102, v103
    v_cvt_pk_bf16_f32 v166, v104, v105
    v_cvt_pk_bf16_f32 v167, v106, v107
    ds_write_addtid_b32 v164 offset:51600
    ds_write_addtid_b32 v165 offset:53664
    ds_write_addtid_b32 v166 offset:55728
    ds_write_addtid_b32 v167 offset:57792
    v_pk_mul_f32 v[162:163], v[106:107], v[158:159] op_sel:[0,0] op_sel_hi:[0,1]
    v_pk_fma_f32 v[108:109], v[106:107], v[158:159], v[162:163] op_sel:[1,1,0] op_sel_hi:[1,0,1] neg_lo:[0,1,0]
    v_pk_mul_f32 v[162:163], v[108:109], v[158:159] op_sel:[0,0] op_sel_hi:[0,1]
    v_pk_fma_f32 v[110:111], v[108:109], v[158:159], v[162:163] op_sel:[1,1,0] op_sel_hi:[1,0,1] neg_lo:[0,1,0]
    v_pk_mul_f32 v[162:163], v[110:111], v[158:159] op_sel:[0,0] op_sel_hi:[0,1]
    v_pk_fma_f32 v[112:113], v[110:111], v[158:159], v[162:163] op_sel:[1,1,0] op_sel_hi:[1,0,1] neg_lo:[0,1,0]
.p2align 3
    v_mfma_f32_32x32x16_bf16 v[224:239], v[28:31], v[32:35], v[224:239]
    v_cvt_pk_bf16_f32 v164, v108, v109
    v_cvt_pk_bf16_f32 v165, v110, v111
    v_cvt_pk_bf16_f32 v166, v112, v113
    ds_write_addtid_b32 v164 offset:59856
    ds_write_addtid_b32 v165 offset:61920
    ds_write_addtid_b32 v166 offset:63984
    s_add_u32 s52, s50, 45312
    s_mov_b32 m0, s52
.p2align 3
    v_pk_mul_f32 v[162:163], v[76:77], v[156:157] op_sel:[0,0] op_sel_hi:[0,1] neg_hi:[0,1]
    v_pk_fma_f32 v[78:79], v[76:77], v[156:157], v[162:163] op_sel:[1,1,0] op_sel_hi:[1,0,1]
    v_pk_mul_f32 v[162:163], v[78:79], v[156:157] op_sel:[0,0] op_sel_hi:[0,1] neg_hi:[0,1]
    v_pk_fma_f32 v[80:81], v[78:79], v[156:157], v[162:163] op_sel:[1,1,0] op_sel_hi:[1,0,1]
    v_pk_mul_f32 v[162:163], v[80:81], v[156:157] op_sel:[0,0] op_sel_hi:[0,1] neg_hi:[0,1]
    v_pk_fma_f32 v[82:83], v[80:81], v[156:157], v[162:163] op_sel:[1,1,0] op_sel_hi:[1,0,1]
    s_waitcnt lgkmcnt(15)
.p2align 3
    v_mfma_f32_32x32x16_bf16 v[224:239], v[36:39], v[40:43], v[224:239]
    v_cvt_pk_bf16_f32 v164, v76, v77
    v_cvt_pk_bf16_f32 v165, v78, v79
    v_cvt_pk_bf16_f32 v166, v80, v81
    v_cvt_pk_bf16_f32 v167, v82, v83
    ds_write_addtid_b32 v164 offset:62272
    ds_write_addtid_b32 v165 offset:20992
    ds_write_addtid_b32 v166 offset:23056
    ds_write_addtid_b32 v167 offset:25120
    ds_read_b128 v[68:71], v208 offset:256
    ds_read_b128 v[72:75], v208 offset:288
    ds_read_b128 v[116:119], v208 offset:320
    v_pk_mul_f32 v[162:163], v[82:83], v[156:157] op_sel:[0,0] op_sel_hi:[0,1] neg_hi:[0,1]
    v_pk_fma_f32 v[84:85], v[82:83], v[156:157], v[162:163] op_sel:[1,1,0] op_sel_hi:[1,0,1]
    v_pk_mul_f32 v[162:163], v[84:85], v[156:157] op_sel:[0,0] op_sel_hi:[0,1] neg_hi:[0,1]
    v_pk_fma_f32 v[86:87], v[84:85], v[156:157], v[162:163] op_sel:[1,1,0] op_sel_hi:[1,0,1]
    v_pk_mul_f32 v[162:163], v[86:87], v[156:157] op_sel:[0,0] op_sel_hi:[0,1] neg_hi:[0,1]
    v_pk_fma_f32 v[88:89], v[86:87], v[156:157], v[162:163] op_sel:[1,1,0] op_sel_hi:[1,0,1]
    v_pk_mul_f32 v[162:163], v[88:89], v[156:157] op_sel:[0,0] op_sel_hi:[0,1] neg_hi:[0,1]
    v_pk_fma_f32 v[90:91], v[88:89], v[156:157], v[162:163] op_sel:[1,1,0] op_sel_hi:[1,0,1]
.p2align 3
    v_mfma_f32_32x32x16_bf16 v[224:239], v[44:47], v[48:51], v[224:239]
    v_cvt_pk_bf16_f32 v164, v84, v85
    v_cvt_pk_bf16_f32 v165, v86, v87
    v_cvt_pk_bf16_f32 v166, v88, v89
    v_cvt_pk_bf16_f32 v167, v90, v91
    ds_write_addtid_b32 v164 offset:27184
    ds_write_addtid_b32 v165 offset:29248
    ds_write_addtid_b32 v166 offset:31312
    ds_write_addtid_b32 v167 offset:33376
    ds_read_b128 v[120:123], v208 offset:352
    ds_read_b128 v[124:127], v208 offset:384
    ds_read_b128 v[128:131], v208 offset:416
    v_pk_mul_f32 v[162:163], v[90:91], v[156:157] op_sel:[0,0] op_sel_hi:[0,1] neg_hi:[0,1]
    v_pk_fma_f32 v[92:93], v[90:91], v[156:157], v[162:163] op_sel:[1,1,0] op_sel_hi:[1,0,1]
    v_pk_mul_f32 v[162:163], v[80:81], v[160:161] op_sel:[0,0] op_sel_hi:[0,1] neg_hi:[0,1]
    v_pk_fma_f32 v[94:95], v[80:81], v[160:161], v[162:163] op_sel:[1,1,0] op_sel_hi:[1,0,1]
    v_pk_mul_f32 v[162:163], v[84:85], v[160:161] op_sel:[0,0] op_sel_hi:[0,1] neg_hi:[0,1]
    v_pk_fma_f32 v[96:97], v[84:85], v[160:161], v[162:163] op_sel:[1,1,0] op_sel_hi:[1,0,1]
    v_pk_mul_f32 v[162:163], v[88:89], v[160:161] op_sel:[0,0] op_sel_hi:[0,1] neg_hi:[0,1]
    v_pk_fma_f32 v[98:99], v[88:89], v[160:161], v[162:163] op_sel:[1,1,0] op_sel_hi:[1,0,1]
.p2align 3
    v_mfma_f32_32x32x16_bf16 v[224:239], v[52:55], v[56:59], v[224:239]
    v_cvt_pk_bf16_f32 v164, v92, v93
    v_cvt_pk_bf16_f32 v165, v94, v95
    v_cvt_pk_bf16_f32 v166, v96, v97
    v_cvt_pk_bf16_f32 v167, v98, v99
    ds_write_addtid_b32 v164 offset:35440
    ds_write_addtid_b32 v165 offset:37504
    ds_write_addtid_b32 v166 offset:39568
    ds_write_addtid_b32 v167 offset:41632
    ds_read_b128 v[132:135], v208 offset:448
    ds_read_b128 v[136:139], v208 offset:480
    v_pk_mul_f32 v[162:163], v[92:93], v[160:161] op_sel:[0,0] op_sel_hi:[0,1] neg_hi:[0,1]
    v_pk_fma_f32 v[100:101], v[92:93], v[160:161], v[162:163] op_sel:[1,1,0] op_sel_hi:[1,0,1]
    v_pk_mul_f32 v[162:163], v[96:97], v[160:161] op_sel:[0,0] op_sel_hi:[0,1] neg_hi:[0,1]
    v_pk_fma_f32 v[102:103], v[96:97], v[160:161], v[162:163] op_sel:[1,1,0] op_sel_hi:[1,0,1]
    v_pk_mul_f32 v[162:163], v[100:101], v[160:161] op_sel:[0,0] op_sel_hi:[0,1] neg_hi:[0,1]
    v_pk_fma_f32 v[104:105], v[100:101], v[160:161], v[162:163] op_sel:[1,1,0] op_sel_hi:[1,0,1]
    v_pk_mul_f32 v[162:163], v[102:103], v[160:161] op_sel:[0,0] op_sel_hi:[0,1] neg_hi:[0,1]
    v_pk_fma_f32 v[106:107], v[102:103], v[160:161], v[162:163] op_sel:[1,1,0] op_sel_hi:[1,0,1]
.p2align 3
    v_mfma_f32_32x32x16_bf16 v[224:239], v[60:63], v[64:67], v[224:239]
    v_cvt_pk_bf16_f32 v164, v100, v101
    v_cvt_pk_bf16_f32 v165, v102, v103
    v_cvt_pk_bf16_f32 v166, v104, v105
    v_cvt_pk_bf16_f32 v167, v106, v107
    ds_write_addtid_b32 v164 offset:43696
    ds_write_addtid_b32 v165 offset:45760
    ds_write_addtid_b32 v166 offset:47824
    ds_write_addtid_b32 v167 offset:49888
    v_pk_mul_f32 v[162:163], v[104:105], v[160:161] op_sel:[0,0] op_sel_hi:[0,1] neg_hi:[0,1]
    v_pk_fma_f32 v[108:109], v[104:105], v[160:161], v[162:163] op_sel:[1,1,0] op_sel_hi:[1,0,1]
    v_pk_mul_f32 v[162:163], v[108:109], v[160:161] op_sel:[0,0] op_sel_hi:[0,1] neg_hi:[0,1]
    v_pk_fma_f32 v[110:111], v[108:109], v[160:161], v[162:163] op_sel:[1,1,0] op_sel_hi:[1,0,1]
    v_pk_mul_f32 v[162:163], v[110:111], v[160:161] op_sel:[0,0] op_sel_hi:[0,1] neg_hi:[0,1]
    v_pk_fma_f32 v[112:113], v[110:111], v[160:161], v[162:163] op_sel:[1,1,0] op_sel_hi:[1,0,1]
    v_pk_mul_f32 v[162:163], v[112:113], v[160:161] op_sel:[0,0] op_sel_hi:[0,1] neg_hi:[0,1]
    v_pk_fma_f32 v[94:95], v[112:113], v[160:161], v[162:163] op_sel:[1,1,0] op_sel_hi:[1,0,1]
    v_cvt_pk_bf16_f32 v164, v108, v109
    v_cvt_pk_bf16_f32 v165, v110, v111
    v_cvt_pk_bf16_f32 v166, v112, v113
    v_cvt_pk_bf16_f32 v167, v94, v95
    ds_write_addtid_b32 v164 offset:51952
    ds_write_addtid_b32 v165 offset:54016
    ds_write_addtid_b32 v166 offset:56080
    ds_write_addtid_b32 v167 offset:58144
    v_pk_mul_f32 v[162:163], v[94:95], v[160:161] op_sel:[0,0] op_sel_hi:[0,1] neg_hi:[0,1]
    v_pk_fma_f32 v[96:97], v[94:95], v[160:161], v[162:163] op_sel:[1,1,0] op_sel_hi:[1,0,1]
    v_cvt_pk_bf16_f32 v164, v96, v97
    ds_write_addtid_b32 v164 offset:60208
    ds_read_b128 v[168:171], v209 offset:256
    ds_read_b128 v[172:175], v209 offset:288
    ds_read_b128 v[176:179], v209 offset:320
    ds_read_b128 v[180:183], v209 offset:352
    ds_read_b128 v[184:187], v209 offset:384
    ds_read_b128 v[188:191], v209 offset:416
    ds_read_b128 v[192:195], v209 offset:448
    ds_read_b128 v[196:199], v209 offset:480
    v_lshlrev_b32 v210, 4, v200
    v_lshl_add_u32 v203, v201, 3, v210
    v_sub_u32 v203, s48, v203
    v_add_u32 v203, 512, v203
    v_lshrrev_b32 v210, 1, v200
    v_and_b32 v211, 1, v200
    v_lshlrev_b32 v210, 2, v210
    v_sub_u32 v210, s48, v210
    v_lshl_add_u32 v204, v211, 8, v210
    v_lshl_add_u32 v205, v211, 1, v210
    v_mov_b32 v206, 60
    s_movk_i32 s52, 1088
    s_waitcnt lgkmcnt(7)
.p2align 3
    v_mfma_f32_32x32x16_bf16 v[224:239], v[168:171], v[68:71], v[224:239]
    v_writelane_b32 v206, s52, 32
    s_movk_i32 s52, 574
    v_writelane_b32 v206, s52, 63
    v_add_u32 v206, s48, v206
    v_and_b32 v248, 1, v252
    s_waitcnt lgkmcnt(6)
.p2align 3
    v_mfma_f32_32x32x16_bf16 v[224:239], v[172:175], v[72:75], v[224:239]
    v_mul_u32_u24 v248, 1218, v248
    v_lshlrev_b32 v210, 1, v252
    v_sub_u32 v248, v248, v210
    v_lshl_add_u32 v248, v253, 4, v248
    v_add3_u32 v248, v248, s48, 32
    s_waitcnt lgkmcnt(5)
.p2align 3
    v_mfma_f32_32x32x16_bf16 v[224:239], v[176:179], v[116:119], v[224:239]
    v_add_u32 v249, 512, v248
    v_lshlrev_b32 v250, 2, v252
    v_sub_u32 v250, s48, v250
    v_lshl_add_u32 v250, v253, 4, v250
    v_add_u32 v250, 2492, v250
    s_waitcnt lgkmcnt(4)
.p2align 3
    v_mfma_f32_32x32x16_bf16 v[224:239], v[180:183], v[120:123], v[224:239]
    v_lshlrev_b32 v2, 5, v252
    v_lshl_add_u32 v2, v253, 4, v2
    v_add_u32 v2, s49, v2
    v_mul_u32_u24 v3, 320, v253
    v_lshl_add_u32 v3, v252, 4, v3
    s_waitcnt lgkmcnt(3)
.p2align 3
    v_mfma_f32_32x32x16_bf16 v[224:239], v[184:187], v[124:127], v[224:239]
    s_mul_i32 s52, s38, 10240
    v_add_u32 v3, s52, v3
    v_lshlrev_b32 v252, 4, v1
    v_add_u32 v252, 141184, v252
    v_and_b32 v251, 1, v1
    s_waitcnt lgkmcnt(2)
.p2align 3
    v_mfma_f32_32x32x16_bf16 v[224:239], v[188:191], v[128:131], v[224:239]
    v_lshl_add_u32 v251, v251, 2, v253
    v_lshlrev_b32 v251, 4, v251
    s_lshr_b32 s52, s42, 1
    s_and_b32 s53, s42, 1
    s_and_b32 s54, s52, 1
    s_waitcnt lgkmcnt(1)
.p2align 3
    v_mfma_f32_32x32x16_bf16 v[224:239], v[192:195], v[132:135], v[224:239]
    s_andn2_b32 s55, s52, 1
    s_or_b32 s55, s55, s53
    s_cmp_lt_u32 s42, 128
    s_cselect_b32 s52, s55, s52
    s_cselect_b32 s53, s54, s53
    s_waitcnt lgkmcnt(0)
.p2align 3
    v_mfma_f32_32x32x16_bf16 v[224:239], v[196:199], v[136:139], v[224:239]
    s_mul_i32 s52, s52, 9216
    s_lshl_b32 s53, s53, 6
    s_add_u32 s52, s52, s53
    s_add_u32 s52, s52, 1052672
    v_and_b32 v0, 3, v1
    v_lshl_add_u32 v0, v0, 4, s52
    v_lshrrev_b32 v210, 2, v1
    v_lshl_add_u32 v0, v210, 7, v0
    v_add_u32 v251, 77824, v251
    s_waitcnt vmcnt(2)
    v_mul_u32_u24 v207, v207, v201
    v_lshlrev_b32 v207, 16, v207
    v_mul_f32 v207, 1056308720, v207
    v_cvt_pk_bf16_f32 v164, v227, v226
    v_cvt_pk_bf16_f32 v165, v225, v224
    v_cvt_pk_bf16_f32 v166, v226, v225
    v_add_f32 v232, v232, v207
    v_cvt_pk_bf16_f32 v168, v231, v231
    v_cvt_pk_bf16_f32 v169, v231, v230
    v_cvt_pk_bf16_f32 v170, v229, v229
    v_cvt_pk_bf16_f32 v171, v229, v228
    v_mov_b32 v172, v168
    v_cvt_pk_bf16_f32 v173, v230, v229
    v_mov_b32 v174, v170
    v_cvt_pk_bf16_f32 v176, v232, v233
    v_readlane_b32 s52, v168, 63
    v_readlane_b32 s56, v164, 63
    v_mov_b32 v167, v168
    v_readlane_b32 s57, v176, 32
    v_cvt_pk_bf16_f32 v177, v234, v235
    v_cvt_pk_bf16_f32 v178, v228, v229
    v_cvt_pk_bf16_f32 v179, v230, v231
    v_writelane_b32 v167, s56, 63
    v_writelane_b32 v167, s57, 32
    ds_write_b64 v203, v[164:165] offset:568
    ds_write_b16 v203, v164 offset:1786
    ds_write_b32 v203, v166 offset:1788
    ds_write_b16_d16_hi v203, v165 offset:1792
    s_mov_b32 exec_hi, 0
    ds_write_b128 v203, v[168:171] offset:1264
    ds_write_b16 v203, v168 offset:46
    ds_write_b96 v203, v[172:174] offset:48
    ds_write_b16_d16_hi v203, v171 offset:60
    s_mov_b32 exec_lo, 0x80000000
    s_mov_b32 exec_hi, 0x80000001
    ds_write_b16 v206, v167
    ds_write_b16 v206, v167 offset:1218
    s_mov_b64 exec, -1
    ds_read2_b32 v[32:33], v249 offset0:16 offset1:17
    ds_read2_b32 v[34:35], v249 offset0:18 offset1:19
    ds_read2_b32 v[64:65], v248 offset0:16 offset1:17
    ds_read2_b32 v[66:67], v248 offset0:18 offset1:19
    ds_read2_b32 v[28:29], v249 offset0:32 offset1:33
    ds_read2_b32 v[30:31], v249 offset0:34 offset1:35
    ds_read2_b32 v[60:61], v248 offset0:32 offset1:33
    ds_read2_b32 v[62:63], v248 offset0:34 offset1:35
    ds_read2_b32 v[24:25], v249 offset0:48 offset1:49
    ds_read2_b32 v[26:27], v249 offset0:50 offset1:51
    ds_read2_b32 v[56:57], v248 offset0:48 offset1:49
    ds_read2_b32 v[58:59], v248 offset0:50 offset1:51
    ds_read2_b32 v[20:21], v249 offset0:64 offset1:65
    ds_read2_b32 v[22:23], v249 offset0:66 offset1:67
    ds_read2_b32 v[52:53], v248 offset0:64 offset1:65
    ds_read2_b32 v[54:55], v248 offset0:66 offset1:67
    ds_read2_b32 v[16:17], v249 offset0:80 offset1:81
    ds_read2_b32 v[18:19], v249 offset0:82 offset1:83
    ds_read2_b32 v[48:49], v248 offset0:80 offset1:81
    ds_read2_b32 v[50:51], v248 offset0:82 offset1:83
    ds_read2_b32 v[12:13], v249 offset0:96 offset1:97
    ds_read2_b32 v[14:15], v249 offset0:98 offset1:99
    ds_read2_b32 v[44:45], v248 offset0:96 offset1:97
    ds_read2_b32 v[46:47], v248 offset0:98 offset1:99
    ds_read2_b32 v[8:9], v249 offset0:112 offset1:113
    ds_read2_b32 v[10:11], v249 offset0:114 offset1:115
    ds_read2_b32 v[40:41], v248 offset0:112 offset1:113
    ds_read2_b32 v[42:43], v248 offset0:114 offset1:115
    ds_read2_b32 v[4:5], v249 offset0:128 offset1:129
    ds_read2_b32 v[6:7], v249 offset0:130 offset1:131
    ds_read2_b32 v[36:37], v248 offset0:128 offset1:129
    ds_read2_b32 v[38:39], v248 offset0:130 offset1:131
    s_mov_b32 exec_hi, 0
    ds_write_b16 v205, v176 offset:3196
    ds_write_b16_d16_hi v205, v176 offset:3132
    ds_write_b16 v205, v177 offset:3068
    ds_write_b16_d16_hi v205, v177 offset:3004
    s_mov_b32 exec_lo, 0
    s_mov_b32 exec_hi, -1
    ds_write_b32 v204, v178 offset:2620
    ds_write_b32 v204, v179 offset:2556
    s_mov_b64 exec, -1
    s_barrier
    ds_read_b128 v[184:187], v2 offset:32
    ds_read_b128 v[188:191], v2 offset:96
    ds_read_b128 v[192:195], v2 offset:160
    ds_read_b128 v[196:199], v2 offset:224
    ds_read_b128 v[200:203], v2 offset:288
    ds_read_b128 v[204:207], v2 offset:352
    ds_read_b128 v[208:211], v2 offset:416
    s_waitcnt lgkmcnt(5)
    v_mfma_f32_16x16x32_bf16 v[240:243], v[32:35], v[184:187], 0
    ds_read2_b32 v[68:69], v248 offset0:0 offset1:1
    v_mfma_f32_16x16x32_bf16 v[244:247], v[64:67], v[184:187], 0
    ds_read_b128 v[184:187], v2 offset:480
    v_mfma_f32_16x16x32_bf16 v[240:243], v[28:31], v[188:191], v[240:243]
    ds_read2_b32 v[70:71], v248 offset0:2 offset1:3
    v_mfma_f32_16x16x32_bf16 v[244:247], v[60:63], v[188:191], v[244:247]
    ds_read_b128 v[188:191], v2 offset:464
    s_waitcnt lgkmcnt(5)
    v_mfma_f32_16x16x32_bf16 v[240:243], v[24:27], v[192:195], v[240:243]
    ds_read_b128 v[116:119], v252 offset:0
    v_mfma_f32_16x16x32_bf16 v[244:247], v[56:59], v[192:195], v[244:247]
    ds_read_b128 v[192:195], v2 offset:544
    v_mfma_f32_16x16x32_bf16 v[240:243], v[20:23], v[196:199], v[240:243]
    ds_read_b128 v[120:123], v252 offset:1024
    v_mfma_f32_16x16x32_bf16 v[244:247], v[52:55], v[196:199], v[244:247]
    ds_read_b128 v[196:199], v2 offset:608
    v_mfma_f32_16x16x32_bf16 v[240:243], v[16:19], v[200:203], v[240:243]
    ds_read_b128 v[124:127], v252 offset:2048
    v_mfma_f32_16x16x32_bf16 v[244:247], v[48:51], v[200:203], v[244:247]
    ds_read_b128 v[200:203], v2 offset:672
    v_mfma_f32_16x16x32_bf16 v[240:243], v[12:15], v[204:207], v[240:243]
    ds_read_b128 v[128:131], v252 offset:3072
    v_mfma_f32_16x16x32_bf16 v[244:247], v[44:47], v[204:207], v[244:247]
    ds_read_b128 v[204:207], v2 offset:736
    s_waitcnt lgkmcnt(6)
    v_mfma_f32_16x16x32_bf16 v[240:243], v[8:11], v[208:211], v[240:243]
    ds_read_b128 v[132:135], v252 offset:4096
    v_mfma_f32_16x16x32_bf16 v[244:247], v[40:43], v[208:211], v[244:247]
    ds_read_b128 v[208:211], v2 offset:800
    v_mfma_f32_16x16x32_bf16 v[240:243], v[4:7], v[184:187], v[240:243]
    ds_read_b128 v[72:75], v252 offset:5120
    v_mfma_f32_16x16x32_bf16 v[244:247], v[36:39], v[184:187], v[244:247]
    v_mfma_f32_16x16x32_bf16 v[212:215], v[68:71], v[184:187], 0
    ds_read2_b32 v[76:77], v250 offset0:32 offset1:33
    v_mfma_f32_16x16x32_bf16 v[216:219], v[184:187], v[116:119], 0
    s_waitcnt lgkmcnt(9)
    v_mfma_f32_16x16x32_bf16 v[220:223], v[184:187], v[120:123], 0
    ds_read2_b32 v[78:79], v250 offset0:34 offset1:35
    s_waitcnt lgkmcnt(8)
    v_mfma_f32_16x16x32_bf16 v[224:227], v[184:187], v[124:127], 0
    ds_write_b128 v3, v[240:243] offset:0
    s_waitcnt lgkmcnt(7)
    v_mfma_f32_16x16x32_bf16 v[232:235], v[184:187], v[128:131], 0
    ds_read_b128 v[184:187], v2 offset:864
    v_mfma_f32_16x16x32_bf16 v[228:231], v[188:191], v[120:123], 0
    v_cvt_pk_bf16_f32 v136, v216, v220
    v_cvt_pk_bf16_f32 v137, v217, v221
    s_waitcnt lgkmcnt(6)
    v_mfma_f32_16x16x32_bf16 v[236:239], v[188:191], v[132:135], 0
    ds_read_b128 v[188:191], v2 offset:928
    v_cvt_pk_bf16_f32 v138, v218, v222
    v_mfma_f32_16x16x32_bf16 v[244:247], v[32:35], v[192:195], v[244:247]
    v_cvt_pk_bf16_f32 v139, v219, v223
    v_cvt_pk_bf16_f32 v140, v224, v228
    v_mfma_f32_16x16x32_bf16 v[212:215], v[64:67], v[192:195], v[212:215]
    ds_read_b128 v[192:195], v2 offset:992
    v_cvt_pk_bf16_f32 v141, v225, v229
    v_mfma_f32_16x16x32_bf16 v[244:247], v[28:31], v[196:199], v[244:247]
    v_cvt_pk_bf16_f32 v142, v226, v230
    v_cvt_pk_bf16_f32 v143, v227, v231
    v_mfma_f32_16x16x32_bf16 v[212:215], v[60:63], v[196:199], v[212:215]
    ds_read_b128 v[196:199], v2 offset:976
    v_cvt_pk_bf16_f32 v168, v232, v236
    v_mfma_f32_16x16x32_bf16 v[244:247], v[24:27], v[200:203], v[244:247]
    v_cvt_pk_bf16_f32 v169, v233, v237
    v_cvt_pk_bf16_f32 v170, v234, v238
    v_mfma_f32_16x16x32_bf16 v[212:215], v[56:59], v[200:203], v[212:215]
    ds_read_b128 v[200:203], v2 offset:1056
    v_cvt_pk_bf16_f32 v171, v235, v239
    v_mfma_f32_16x16x32_bf16 v[244:247], v[20:23], v[204:207], v[244:247]
    v_mfma_f32_16x16x32_bf16 v[212:215], v[52:55], v[204:207], v[212:215]
    ds_read_b128 v[204:207], v2 offset:1120
    s_waitcnt lgkmcnt(3)
    v_mfma_f32_16x16x32_bf16 v[244:247], v[16:19], v[208:211], v[244:247]
    v_mfma_f32_16x16x32_bf16 v[212:215], v[48:51], v[208:211], v[212:215]
    ds_read_b128 v[208:211], v2 offset:1184
    v_mfma_f32_16x16x32_bf16 v[244:247], v[12:15], v[184:187], v[244:247]
    v_mfma_f32_16x16x32_bf16 v[212:215], v[44:47], v[184:187], v[212:215]
    ds_read_b128 v[184:187], v2 offset:1248
    v_mfma_f32_16x16x32_bf16 v[244:247], v[8:11], v[188:191], v[244:247]
    v_mfma_f32_16x16x32_bf16 v[212:215], v[40:43], v[188:191], v[212:215]
    ds_read_b128 v[188:191], v2 offset:1312
    v_mfma_f32_16x16x32_bf16 v[244:247], v[4:7], v[192:195], v[244:247]
    v_mfma_f32_16x16x32_bf16 v[212:215], v[36:39], v[192:195], v[212:215]
    ds_read2_b32 v[88:89], v250 offset0:96 offset1:97
    v_mfma_f32_16x16x32_bf16 v[240:243], v[68:71], v[192:195], 0
    v_mfma_f32_16x16x32_bf16 v[216:219], v[192:195], v[116:119], 0
    ds_read2_b32 v[90:91], v250 offset0:98 offset1:99
    v_mfma_f32_16x16x32_bf16 v[220:223], v[192:195], v[120:123], 0
    v_mfma_f32_16x16x32_bf16 v[224:227], v[192:195], v[124:127], 0
    v_mfma_f32_16x16x32_bf16 v[232:235], v[192:195], v[128:131], 0
    ds_write_b128 v3, v[244:247] offset:1280
    s_waitcnt lgkmcnt(3)
    v_mfma_f32_16x16x32_bf16 v[228:231], v[196:199], v[120:123], 0
    ds_read_b128 v[192:195], v2 offset:1376
    v_mfma_f32_16x16x32_bf16 v[236:239], v[196:199], v[132:135], 0
    ds_read_b128 v[196:199], v2 offset:1440
    v_cvt_pk_bf16_f32 v144, v216, v220
    v_mfma_f32_16x16x32_bf16 v[212:215], v[32:35], v[200:203], v[212:215]
    ds_read2_b32 v[80:81], v250 offset0:16 offset1:17
    v_cvt_pk_bf16_f32 v145, v217, v221
    v_mfma_f32_16x16x32_bf16 v[240:243], v[64:67], v[200:203], v[240:243]
    s_waitcnt lgkmcnt(3)
    s_barrier
    v_mfma_f32_16x16x32_bf16 v[212:215], v[136:139], v[76:79], v[212:215]
    ds_read_b128 v[200:203], v2 offset:1504
    v_cvt_pk_bf16_f32 v146, v218, v222
    v_mfma_f32_16x16x32_bf16 v[212:215], v[28:31], v[204:207], v[212:215]
    v_cvt_pk_bf16_f32 v147, v219, v223
    v_cvt_pk_bf16_f32 v148, v224, v228
    v_mfma_f32_16x16x32_bf16 v[240:243], v[60:63], v[204:207], v[240:243]
    ds_read_b128 v[204:207], v2 offset:1488
    v_cvt_pk_bf16_f32 v149, v225, v229
    v_mfma_f32_16x16x32_bf16 v[212:215], v[140:143], v[88:91], v[212:215]
    v_cvt_pk_bf16_f32 v150, v226, v230
    v_cvt_pk_bf16_f32 v151, v227, v231
    v_mfma_f32_16x16x32_bf16 v[212:215], v[24:27], v[208:211], v[212:215]
    ds_read2_b32 v[82:83], v250 offset0:18 offset1:19
    v_cvt_pk_bf16_f32 v172, v232, v236
    v_mfma_f32_16x16x32_bf16 v[240:243], v[56:59], v[208:211], v[240:243]
    ds_read_b128 v[208:211], v2 offset:1568
    v_cvt_pk_bf16_f32 v173, v233, v237
    v_mfma_f32_16x16x32_bf16 v[212:215], v[20:23], v[184:187], v[212:215]
    ds_read2_b32 v[92:93], v250 offset0:80 offset1:81
    v_cvt_pk_bf16_f32 v174, v234, v238
    v_mfma_f32_16x16x32_bf16 v[240:243], v[52:55], v[184:187], v[240:243]
    ds_read_b128 v[184:187], v2 offset:1632
    v_cvt_pk_bf16_f32 v175, v235, v239
    v_mfma_f32_16x16x32_bf16 v[212:215], v[16:19], v[188:191], v[212:215]
    ds_read2_b32 v[94:95], v250 offset0:82 offset1:83
    v_and_b32 v72, s52, v72
    v_mfma_f32_16x16x32_bf16 v[240:243], v[48:51], v[188:191], v[240:243]
    ds_read_b128 v[188:191], v2 offset:1696
    s_waitcnt lgkmcnt(6)
    v_mfma_f32_16x16x32_bf16 v[212:215], v[12:15], v[192:195], v[212:215]
    ds_read2_b32 v[100:101], v250 offset0:176 offset1:177
    v_and_b32 v73, s52, v73
    v_mfma_f32_16x16x32_bf16 v[240:243], v[44:47], v[192:195], v[240:243]
    ds_read_b128 v[192:195], v2 offset:1760
    v_and_b32 v74, s52, v74
    v_mfma_f32_16x16x32_bf16 v[212:215], v[8:11], v[196:199], v[212:215]
    ds_read2_b32 v[102:103], v250 offset0:178 offset1:179
    v_and_b32 v75, s52, v75
    v_mfma_f32_16x16x32_bf16 v[240:243], v[40:43], v[196:199], v[240:243]
    ds_read_b128 v[196:199], v2 offset:1824
    v_mfma_f32_16x16x32_bf16 v[212:215], v[4:7], v[200:203], v[212:215]
    ds_read2_b32 v[84:85], v250 offset0:0 offset1:1
    v_mfma_f32_16x16x32_bf16 v[240:243], v[36:39], v[200:203], v[240:243]
    v_mfma_f32_16x16x32_bf16 v[244:247], v[68:71], v[200:203], 0
    ds_read2_b32 v[86:87], v250 offset0:2 offset1:3
    v_mfma_f32_16x16x32_bf16 v[216:219], v[200:203], v[116:119], 0
    v_mfma_f32_16x16x32_bf16 v[220:223], v[200:203], v[120:123], 0
    ds_read2_b32 v[96:97], v250 offset0:64 offset1:65
    v_mfma_f32_16x16x32_bf16 v[224:227], v[200:203], v[124:127], 0
    ds_write_b128 v3, v[212:215] offset:2560
    v_mfma_f32_16x16x32_bf16 v[232:235], v[200:203], v[128:131], 0
    ds_read_b128 v[200:203], v2 offset:1888
    v_mfma_f32_16x16x32_bf16 v[228:231], v[204:207], v[120:123], 0
    v_mfma_f32_16x16x32_bf16 v[236:239], v[204:207], v[132:135], 0
    ds_read_b128 v[204:207], v2 offset:1952
    s_waitcnt lgkmcnt(6)
    v_mfma_f32_16x16x32_bf16 v[240:243], v[32:35], v[208:211], v[240:243]
    v_cvt_pk_bf16_f32 v152, v216, v220
    v_cvt_pk_bf16_f32 v153, v217, v221
    v_mfma_f32_16x16x32_bf16 v[244:247], v[64:67], v[208:211], v[244:247]
    ds_read_b128 v[208:211], v2 offset:2016
    v_cvt_pk_bf16_f32 v154, v218, v222
    v_mfma_f32_16x16x32_bf16 v[240:243], v[136:139], v[80:83], v[240:243]
    v_cvt_pk_bf16_f32 v155, v219, v223
    v_cvt_pk_bf16_f32 v156, v224, v228
    v_mfma_f32_16x16x32_bf16 v[240:243], v[28:31], v[184:187], v[240:243]
    ds_read2_b32 v[98:99], v250 offset0:66 offset1:67
    v_cvt_pk_bf16_f32 v157, v225, v229
    v_mfma_f32_16x16x32_bf16 v[244:247], v[60:63], v[184:187], v[244:247]
    ds_read_b128 v[184:187], v2 offset:2000
    v_cvt_pk_bf16_f32 v158, v226, v230
    v_mfma_f32_16x16x32_bf16 v[240:243], v[140:143], v[92:95], v[240:243]
    ds_read2_b32 v[104:105], v250 offset0:160 offset1:161
    v_cvt_pk_bf16_f32 v159, v227, v231
    v_mfma_f32_16x16x32_bf16 v[240:243], v[24:27], v[188:191], v[240:243]
    v_cvt_pk_bf16_f32 v176, v232, v236
    v_cvt_pk_bf16_f32 v177, v233, v237
    v_mfma_f32_16x16x32_bf16 v[244:247], v[56:59], v[188:191], v[244:247]
    ds_read_b128 v[188:191], v2 offset:2080
    v_cvt_pk_bf16_f32 v178, v234, v238
    v_mfma_f32_16x16x32_bf16 v[240:243], v[144:147], v[76:79], v[240:243]
    v_cvt_pk_bf16_f32 v179, v235, v239
    v_mfma_f32_16x16x32_bf16 v[240:243], v[20:23], v[192:195], v[240:243]
    ds_read2_b32 v[106:107], v250 offset0:162 offset1:163
    v_mfma_f32_16x16x32_bf16 v[244:247], v[52:55], v[192:195], v[244:247]
    ds_read_b128 v[192:195], v2 offset:2144
    v_mfma_f32_16x16x32_bf16 v[240:243], v[148:151], v[88:91], v[240:243]
    v_mfma_f32_16x16x32_bf16 v[240:243], v[16:19], v[196:199], v[240:243]
    v_mfma_f32_16x16x32_bf16 v[244:247], v[48:51], v[196:199], v[244:247]
    ds_read_b128 v[196:199], v2 offset:2208
    s_waitcnt lgkmcnt(3)
    v_mfma_f32_16x16x32_bf16 v[240:243], v[12:15], v[200:203], v[240:243]
    v_mfma_f32_16x16x32_bf16 v[244:247], v[44:47], v[200:203], v[244:247]
    ds_read_b128 v[200:203], v2 offset:2272
    v_mfma_f32_16x16x32_bf16 v[240:243], v[8:11], v[204:207], v[240:243]
    v_mfma_f32_16x16x32_bf16 v[244:247], v[40:43], v[204:207], v[244:247]
    ds_read_b128 v[204:207], v2 offset:480
    v_mfma_f32_16x16x32_bf16 v[240:243], v[4:7], v[208:211], v[240:243]
    v_mfma_f32_16x16x32_bf16 v[244:247], v[36:39], v[208:211], v[244:247]
    v_mfma_f32_16x16x32_bf16 v[212:215], v[68:71], v[208:211], 0
    v_mfma_f32_16x16x32_bf16 v[216:219], v[208:211], v[116:119], 0
    v_mfma_f32_16x16x32_bf16 v[220:223], v[208:211], v[120:123], 0
    v_mfma_f32_16x16x32_bf16 v[224:227], v[208:211], v[124:127], 0
    v_mfma_f32_16x16x32_bf16 v[232:235], v[208:211], v[128:131], 0
    ds_read_b128 v[208:211], v2 offset:2336
    v_mfma_f32_16x16x32_bf16 v[228:231], v[184:187], v[120:123], 0
    ds_write_b128 v3, v[240:243] offset:3840
    v_mfma_f32_16x16x32_bf16 v[236:239], v[184:187], v[132:135], 0
    ds_read_b128 v[184:187], v2 offset:2400
    v_mfma_f32_16x16x32_bf16 v[244:247], v[32:35], v[188:191], v[244:247]
    ds_read2_b32 v[108:109], v250 offset0:144 offset1:145
    v_cvt_pk_bf16_f32 v160, v216, v220
    v_mfma_f32_16x16x32_bf16 v[212:215], v[64:67], v[188:191], v[212:215]
    ds_read_b128 v[188:191], v2 offset:2464
    v_cvt_pk_bf16_f32 v161, v217, v221
    v_mfma_f32_16x16x32_bf16 v[244:247], v[168:171], v[100:103], v[244:247]
    s_waitcnt lgkmcnt(3)
    global_load_dwordx4 v[252:255], v251, s[36:37] sc1
    s_barrier
    v_mfma_f32_16x16x32_bf16 v[244:247], v[28:31], v[192:195], v[244:247]
    v_cvt_pk_bf16_f32 v162, v218, v222
    v_cvt_pk_bf16_f32 v163, v219, v223
    v_mfma_f32_16x16x32_bf16 v[212:215], v[60:63], v[192:195], v[212:215]
    ds_read_b128 v[192:195], v2 offset:2528
    v_cvt_pk_bf16_f32 v164, v224, v228
    v_mfma_f32_16x16x32_bf16 v[244:247], v[136:139], v[84:87], v[244:247]
    v_cvt_pk_bf16_f32 v165, v225, v229
    v_cvt_pk_bf16_f32 v166, v226, v230
    v_mfma_f32_16x16x32_bf16 v[244:247], v[24:27], v[196:199], v[244:247]
    ds_read2_b32 v[110:111], v250 offset0:146 offset1:147
    v_cvt_pk_bf16_f32 v167, v227, v231
    v_mfma_f32_16x16x32_bf16 v[212:215], v[56:59], v[196:199], v[212:215]
    ds_read_b128 v[196:199], v2 offset:2512
    v_cvt_pk_bf16_f32 v180, v232, v236
    v_mfma_f32_16x16x32_bf16 v[244:247], v[140:143], v[96:99], v[244:247]
    ds_read2_b32 v[112:113], v250 offset0:128 offset1:129
    v_cvt_pk_bf16_f32 v181, v233, v237
    v_mfma_f32_16x16x32_bf16 v[244:247], v[20:23], v[200:203], v[244:247]
    v_cvt_pk_bf16_f32 v182, v234, v238
    v_cvt_pk_bf16_f32 v183, v235, v239
    v_mfma_f32_16x16x32_bf16 v[212:215], v[52:55], v[200:203], v[212:215]
    ds_read_b128 v[200:203], v2 offset:2592
    v_mfma_f32_16x16x32_bf16 v[244:247], v[144:147], v[80:83], v[244:247]
    v_mfma_f32_16x16x32_bf16 v[244:247], v[72:75], v[204:207], v[244:247]
    ds_read_b128 v[204:207], v2 offset:2656
    v_mfma_f32_16x16x32_bf16 v[244:247], v[16:19], v[208:211], v[244:247]
    v_mfma_f32_16x16x32_bf16 v[212:215], v[48:51], v[208:211], v[212:215]
    ds_read_b128 v[208:211], v2 offset:2720
    v_mfma_f32_16x16x32_bf16 v[244:247], v[148:151], v[92:95], v[244:247]
    s_waitcnt lgkmcnt(2)
    v_mfma_f32_16x16x32_bf16 v[244:247], v[12:15], v[184:187], v[244:247]
    ds_read2_b32 v[114:115], v250 offset0:130 offset1:131
    v_mfma_f32_16x16x32_bf16 v[212:215], v[44:47], v[184:187], v[212:215]
    ds_read_b128 v[184:187], v2 offset:2784
    v_mfma_f32_16x16x32_bf16 v[244:247], v[152:155], v[76:79], v[244:247]
    v_mfma_f32_16x16x32_bf16 v[244:247], v[8:11], v[188:191], v[244:247]
    v_mfma_f32_16x16x32_bf16 v[212:215], v[40:43], v[188:191], v[212:215]
    ds_read_b128 v[188:191], v2 offset:992
    v_mfma_f32_16x16x32_bf16 v[244:247], v[156:159], v[88:91], v[244:247]
    v_mfma_f32_16x16x32_bf16 v[244:247], v[4:7], v[192:195], v[244:247]
    v_mfma_f32_16x16x32_bf16 v[212:215], v[36:39], v[192:195], v[212:215]
    v_mfma_f32_16x16x32_bf16 v[240:243], v[68:71], v[192:195], 0
    v_mfma_f32_16x16x32_bf16 v[216:219], v[192:195], v[116:119], 0
    v_mfma_f32_16x16x32_bf16 v[220:223], v[192:195], v[120:123], 0
    v_mfma_f32_16x16x32_bf16 v[224:227], v[192:195], v[124:127], 0
    ds_read_b128 v[192:195], v2 offset:2848
    v_mfma_f32_16x16x32_bf16 v[228:231], v[196:199], v[120:123], 0
    ds_read_b128 v[196:199], v2 offset:2912
    v_mfma_f32_16x16x32_bf16 v[212:215], v[32:35], v[200:203], v[212:215]
    ds_write_b128 v3, v[244:247] offset:5120
    v_mfma_f32_16x16x32_bf16 v[240:243], v[64:67], v[200:203], v[240:243]
    ds_read_b128 v[200:203], v2 offset:2976
    v_cvt_pk_bf16_f32 v136, v216, v220
    v_mfma_f32_16x16x32_bf16 v[212:215], v[168:171], v[104:107], v[212:215]
    v_cvt_pk_bf16_f32 v137, v217, v221
    v_cvt_pk_bf16_f32 v138, v218, v222
    v_mfma_f32_16x16x32_bf16 v[212:215], v[172:175], v[100:103], v[212:215]
    v_cvt_pk_bf16_f32 v139, v219, v223
    s_waitcnt lgkmcnt(3)
    v_mfma_f32_16x16x32_bf16 v[212:215], v[28:31], v[204:207], v[212:215]
    v_cvt_pk_bf16_f32 v140, v224, v228
    v_cvt_pk_bf16_f32 v141, v225, v229
    v_mfma_f32_16x16x32_bf16 v[240:243], v[60:63], v[204:207], v[240:243]
    ds_read_b128 v[204:207], v2 offset:3040
    v_cvt_pk_bf16_f32 v142, v226, v230
    v_mfma_f32_16x16x32_bf16 v[212:215], v[144:147], v[84:87], v[212:215]
    v_cvt_pk_bf16_f32 v143, v227, v231
    v_mfma_f32_16x16x32_bf16 v[212:215], v[24:27], v[208:211], v[212:215]
    v_mfma_f32_16x16x32_bf16 v[240:243], v[56:59], v[208:211], v[240:243]
    ds_read_b128 v[208:211], v2 offset:3024
    v_mfma_f32_16x16x32_bf16 v[212:215], v[148:151], v[96:99], v[212:215]
    v_mfma_f32_16x16x32_bf16 v[212:215], v[20:23], v[184:187], v[212:215]
    v_mfma_f32_16x16x32_bf16 v[240:243], v[52:55], v[184:187], v[240:243]
    ds_read_b128 v[184:187], v2 offset:3104
    v_mfma_f32_16x16x32_bf16 v[212:215], v[152:155], v[80:83], v[212:215]
    v_mfma_f32_16x16x32_bf16 v[212:215], v[72:75], v[188:191], v[212:215]
    ds_read_b128 v[188:191], v2 offset:3168
    v_mfma_f32_16x16x32_bf16 v[212:215], v[16:19], v[192:195], v[212:215]
    v_mfma_f32_16x16x32_bf16 v[240:243], v[48:51], v[192:195], v[240:243]
    ds_read_b128 v[192:195], v2 offset:3232
    v_mfma_f32_16x16x32_bf16 v[212:215], v[156:159], v[92:95], v[212:215]
    s_waitcnt lgkmcnt(2)
    v_mfma_f32_16x16x32_bf16 v[212:215], v[12:15], v[196:199], v[212:215]
    v_mfma_f32_16x16x32_bf16 v[240:243], v[44:47], v[196:199], v[240:243]
    ds_read_b128 v[196:199], v2 offset:3296
    v_mfma_f32_16x16x32_bf16 v[212:215], v[160:163], v[76:79], v[212:215]
    v_mfma_f32_16x16x32_bf16 v[212:215], v[8:11], v[200:203], v[212:215]
    v_mfma_f32_16x16x32_bf16 v[240:243], v[40:43], v[200:203], v[240:243]
    ds_read_b128 v[200:203], v2 offset:1504
    v_mfma_f32_16x16x32_bf16 v[212:215], v[164:167], v[88:91], v[212:215]
    v_mfma_f32_16x16x32_bf16 v[212:215], v[4:7], v[204:207], v[212:215]
    v_mfma_f32_16x16x32_bf16 v[240:243], v[36:39], v[204:207], v[240:243]
    v_mfma_f32_16x16x32_bf16 v[244:247], v[68:71], v[204:207], 0
    v_mfma_f32_16x16x32_bf16 v[216:219], v[204:207], v[116:119], 0
    v_mfma_f32_16x16x32_bf16 v[220:223], v[204:207], v[120:123], 0
    v_mfma_f32_16x16x32_bf16 v[224:227], v[204:207], v[124:127], 0
    ds_read_b128 v[204:207], v2 offset:3360
    v_mfma_f32_16x16x32_bf16 v[228:231], v[208:211], v[120:123], 0
    ds_read_b128 v[208:211], v2 offset:3424
    v_mfma_f32_16x16x32_bf16 v[240:243], v[32:35], v[184:187], v[240:243]
    ds_write_b128 v3, v[212:215] offset:6400
    v_mfma_f32_16x16x32_bf16 v[244:247], v[64:67], v[184:187], v[244:247]
    ds_read_b128 v[184:187], v2 offset:3488
    v_cvt_pk_bf16_f32 v144, v216, v220
    v_mfma_f32_16x16x32_bf16 v[240:243], v[168:171], v[108:111], v[240:243]
    v_cvt_pk_bf16_f32 v145, v217, v221
    v_cvt_pk_bf16_f32 v146, v218, v222
    v_mfma_f32_16x16x32_bf16 v[240:243], v[172:175], v[104:107], v[240:243]
    v_cvt_pk_bf16_f32 v147, v219, v223
    s_waitcnt lgkmcnt(3)
    v_mfma_f32_16x16x32_bf16 v[240:243], v[28:31], v[188:191], v[240:243]
    s_waitcnt lgkmcnt(1)
    s_barrier
    v_mfma_f32_16x16x32_bf16 v[244:247], v[60:63], v[188:191], v[244:247]
    ds_read_b128 v[188:191], v2 offset:3552
    v_cvt_pk_bf16_f32 v148, v224, v228
    v_mfma_f32_16x16x32_bf16 v[240:243], v[176:179], v[100:103], v[240:243]
    v_cvt_pk_bf16_f32 v149, v225, v229
    v_cvt_pk_bf16_f32 v150, v226, v230
    v_mfma_f32_16x16x32_bf16 v[240:243], v[152:155], v[84:87], v[240:243]
    v_cvt_pk_bf16_f32 v151, v227, v231
    v_mov_b32 v232, 147328
    v_mfma_f32_16x16x32_bf16 v[240:243], v[24:27], v[192:195], v[240:243]
    v_bfe_u32 v234, v1, 1, 2
    ds_read_b32 v232, v232
    v_mfma_f32_16x16x32_bf16 v[244:247], v[56:59], v[192:195], v[244:247]
    ds_read_b128 v[192:195], v2 offset:3616
    s_lshl_b32 s44, s42, 3
    v_mfma_f32_16x16x32_bf16 v[240:243], v[156:159], v[96:99], v[240:243]
    v_lshl_add_u32 v235, v234, 1, s44
    v_mul_u32_u24 v236, 4608, v234
    v_mfma_f32_16x16x32_bf16 v[240:243], v[20:23], v[196:199], v[240:243]
    v_mul_u32_u24 v237, 10240, v234
    s_movk_i32 s44, 1152
    v_mfma_f32_16x16x32_bf16 v[244:247], v[52:55], v[196:199], v[244:247]
    ds_read_b128 v[196:199], v2 offset:3680
    s_waitcnt lgkmcnt(2)
    s_waitcnt vmcnt(0)
    v_cmp_ne_u32 vcc, v232, v255
    s_cbranch_vccnz L_pollH
L_pollH_done:
    v_mfma_f32_16x16x32_bf16 v[240:243], v[160:163], v[80:83], v[240:243]
    v_readfirstlane_b32 s41, v232
    v_and_b32 v252, 2047, v252
    v_mfma_f32_16x16x32_bf16 v[240:243], v[72:75], v[200:203], v[240:243]
    ds_read_b128 v[200:203], v2 offset:3744
    v_add_u32 v233, 147392, v252
    v_mfma_f32_16x16x32_bf16 v[240:243], v[16:19], v[204:207], v[240:243]
    v_mov_b32 v232, 1
    v_mad_u32_u24 v235, v252, s44, v235
    v_mfma_f32_16x16x32_bf16 v[244:247], v[48:51], v[204:207], v[244:247]
    ds_read_b128 v[204:207], v2 offset:3808
    ds_write_b8 v233, v232
    v_mfma_f32_16x16x32_bf16 v[240:243], v[164:167], v[92:95], v[240:243]
    v_lshl_add_u32 v236, v252, 1, v236
    v_add_u32 v236, 109952, v236
    v_mfma_f32_16x16x32_bf16 v[240:243], v[12:15], v[208:211], v[240:243]
    v_lshrrev_b32 v239, 8, v252
    v_mul_u32_u24 v239, 1280, v239
    v_mfma_f32_16x16x32_bf16 v[244:247], v[44:47], v[208:211], v[244:247]
    ds_read_b128 v[208:211], v2 offset:2016
    v_add_u32 v237, v237, v239
    v_mfma_f32_16x16x32_bf16 v[240:243], v[136:139], v[76:79], v[240:243]
    v_bfe_u32 v239, v252, 2, 2
    v_mul_u32_u24 v239, 320, v239
    v_mfma_f32_16x16x32_bf16 v[240:243], v[8:11], v[184:187], v[240:243]
    v_add_u32 v237, v237, v239
    v_bfe_u32 v239, v252, 4, 4
    v_mfma_f32_16x16x32_bf16 v[244:247], v[40:43], v[184:187], v[244:247]
    ds_read_b128 v[184:187], v2 offset:3872
    v_lshl_add_u32 v237, v239, 4, v237
    v_mfma_f32_16x16x32_bf16 v[240:243], v[140:143], v[88:91], v[240:243]
    v_and_b32 v239, 3, v252
    v_lshl_add_u32 v237, v239, 2, v237
    v_mfma_f32_16x16x32_bf16 v[240:243], v[4:7], v[188:191], v[240:243]
    v_mul_f32 v254, 4021856827, v254
    v_add_u32 v239, 4096, v0
    v_mfma_f32_16x16x32_bf16 v[244:247], v[36:39], v[188:191], v[244:247]
    ds_read_b128 v[188:191], v2 offset:3936
    s_waitcnt lgkmcnt(2)
    v_mfma_f32_16x16x32_bf16 v[244:247], v[32:35], v[192:195], v[244:247]
    ds_read_b128 v[192:195], v2 offset:4000
    s_mov_b32 s45, 0
    v_mfma_f32_16x16x32_bf16 v[244:247], v[168:171], v[112:115], v[244:247]
    ds_write_b128 v3, v[240:243] offset:7680
    s_lshr_b32 s60, s41, 4
    v_mfma_f32_16x16x32_bf16 v[244:247], v[172:175], v[108:111], v[244:247]
    s_xor_b32 s60, s60, s41
    s_and_b32 s60, s60, 15
    v_mfma_f32_16x16x32_bf16 v[244:247], v[28:31], v[196:199], v[244:247]
    ds_read_b128 v[196:199], v2 offset:4064
    s_cselect_b32 s60, 0, 16
    v_mfma_f32_16x16x32_bf16 v[244:247], v[176:179], v[104:107], v[244:247]
    s_xor_b32 s60, s60, s41
    s_bfe_u32 s56, s60, 0x40000
    v_mfma_f32_16x16x32_bf16 v[244:247], v[180:183], v[100:103], v[244:247]
    s_waitcnt lgkmcnt(1)
    s_barrier
    v_mfma_f32_16x16x32_bf16 v[244:247], v[24:27], v[200:203], v[244:247]
    s_mul_i32 s56, s56, 0x08002000
    s_and_b32 s56, s56, 0x60006000
    v_mfma_f32_16x16x32_bf16 v[244:247], v[160:163], v[84:87], v[244:247]
    s_bfe_u32 s57, s60, 0x40004
    s_mul_i32 s57, s57, 0x08002000
    v_mfma_f32_16x16x32_bf16 v[244:247], v[164:167], v[96:99], v[244:247]
    s_and_b32 s57, s57, 0x60006000
    s_bfe_u32 s58, s60, 0x40008
    v_mfma_f32_16x16x32_bf16 v[244:247], v[20:23], v[204:207], v[244:247]
    s_mul_i32 s58, s58, 0x08002000
    s_and_b32 s58, s58, 0x60006000
    v_mfma_f32_16x16x32_bf16 v[244:247], v[136:139], v[80:83], v[244:247]
    s_bfe_u32 s59, s60, 0x4000c
    s_mul_i32 s59, s59, 0x08002000
    v_mfma_f32_16x16x32_bf16 v[244:247], v[72:75], v[208:211], v[244:247]
    s_and_b32 s59, s59, 0x60006000
    v_mfma_f32_16x16x32_bf16 v[244:247], v[16:19], v[184:187], v[244:247]
    v_mfma_f32_16x16x32_bf16 v[244:247], v[140:143], v[92:95], v[244:247]
    v_mfma_f32_16x16x32_bf16 v[244:247], v[12:15], v[188:191], v[244:247]
    v_mfma_f32_16x16x32_bf16 v[244:247], v[144:147], v[76:79], v[244:247]
    v_mfma_f32_16x16x32_bf16 v[244:247], v[8:11], v[192:195], v[244:247]
    v_mfma_f32_16x16x32_bf16 v[244:247], v[148:151], v[88:91], v[244:247]
    s_waitcnt lgkmcnt(0)
    v_mfma_f32_16x16x32_bf16 v[244:247], v[4:7], v[196:199], v[244:247]
    s_nop 7
    ds_write_b128 v3, v[244:247] offset:8960
    s_waitcnt lgkmcnt(0)
    s_barrier
    s_cmp_lg_u32 s38, 0
    s_cbranch_scc1 L_fin_done
    global_load_ushort v238, v235, s[4:5]
    ds_read_u16 v14, v236
    ds_read_b32 v13, v237
    v_and_b32 v4, 1, v1
    v_lshlrev_b32 v4, 4, v4
    v_mov_b32 v5, 0x3f80
    v_lshlrev_b32 v4, v4, v5
    v_bfe_u32 v5, v1, 1, 3
    v_cmp_eq_u32 vcc, 0, v5
    s_nop 1
    v_cndmask_b32 v8, 0, v4, vcc
    v_cmp_eq_u32 vcc, 1, v5
    s_nop 1
    v_cndmask_b32 v9, 0, v4, vcc
    v_cmp_eq_u32 vcc, 2, v5
    s_nop 1
    v_cndmask_b32 v10, 0, v4, vcc
    v_cmp_eq_u32 vcc, 3, v5
    s_nop 1
    v_cndmask_b32 v11, 0, v4, vcc
    v_mov_b32 v36, s56
    v_mov_b32 v37, s57
    v_mov_b32 v38, s58
    v_mov_b32 v39, s59
    s_mov_b32 s44, 0x00ff00ff
    v_mov_b32 v2, 278528
    s_mov_b64 exec, 1
L_go:
    global_load_dword v3, v2, s[36:37] sc1
    s_add_u32 s45, s45, 1
    s_cmp_ge_u32 s45, 65536
    s_cbranch_scc1 L_go_done
    s_waitcnt vmcnt(0)
    v_cmp_ne_u32 vcc, s41, v3
    s_cbranch_vccnz L_go
L_go_done:
    s_mov_b64 exec, -1
    s_mov_b32 s45, 0
    s_waitcnt vmcnt(0)
    global_load_dwordx4 v[20:23], v0, s[36:37] offset:-4096 sc1
    global_load_dwordx4 v[24:27], v0, s[36:37] offset:-2048 sc1
    global_load_dwordx4 v[28:31], v0, s[36:37] offset:0 sc1
    global_load_dwordx4 v[32:35], v0, s[36:37] offset:2048 sc1
    s_mov_b32 exec_hi, 0
    global_load_dwordx4 v[36:39], v239, s[36:37] sc1
    s_mov_b32 exec_hi, -1
    s_waitcnt lgkmcnt(0)
    v_lshlrev_b32 v14, 16, v14
    v_lshlrev_b32 v238, 16, v238
    s_waitcnt vmcnt(4)
    v_xor_b32 v20, s56, v20
    v_xor_b32 v21, s57, v21
    v_xor_b32 v22, s58, v22
    v_xor_b32 v23, s59, v23
    v_or3_b32 v17, 0, v20, v21
    v_or3_b32 v17, v17, v22, v23
    v_mfma_f32_16x16x32_bf16 v[44:47], v[20:23], v[8:11], 0
    s_waitcnt vmcnt(3)
    v_xor_b32 v24, s56, v24
    v_xor_b32 v25, s57, v25
    v_xor_b32 v26, s58, v26
    v_xor_b32 v27, s59, v27
    v_or3_b32 v17, v17, v24, v25
    v_or3_b32 v17, v17, v26, v27
    v_mfma_f32_16x16x32_bf16 v[44:47], v[24:27], v[8:11], v[44:47]
    s_waitcnt vmcnt(2)
    v_xor_b32 v28, s56, v28
    v_xor_b32 v29, s57, v29
    v_xor_b32 v30, s58, v30
    v_xor_b32 v31, s59, v31
    v_or3_b32 v17, v17, v28, v29
    v_or3_b32 v17, v17, v30, v31
    v_mfma_f32_16x16x32_bf16 v[44:47], v[28:31], v[8:11], v[44:47]
    s_waitcnt vmcnt(1)
    v_xor_b32 v32, s56, v32
    v_xor_b32 v33, s57, v33
    v_xor_b32 v34, s58, v34
    v_xor_b32 v35, s59, v35
    v_or3_b32 v17, v17, v32, v33
    v_or3_b32 v17, v17, v34, v35
    v_mfma_f32_16x16x32_bf16 v[44:47], v[32:35], v[8:11], v[44:47]
    s_waitcnt vmcnt(0)
    v_xor_b32 v36, s56, v36
    v_xor_b32 v37, s57, v37
    v_xor_b32 v38, s58, v38
    v_xor_b32 v39, s59, v39
    v_or3_b32 v17, v17, v36, v37
    v_or3_b32 v17, v17, v38, v39
    v_mfma_f32_16x16x32_bf16 v[44:47], v[36:39], v[8:11], v[44:47]
    v_and_b32 v17, 0x60006000, v17
    v_cmp_ne_u32 vcc, 0, v17
    s_cbranch_vccnz L_pollB
L_pollB_done:
    s_nop 4
    v_permlane32_swap_b32 v44, v46
    v_permlane32_swap_b32 v45, v47
    v_pk_add_f32 v[44:45], v[44:45], v[46:47]
    s_nop 1
    v_permlane16_swap_b32 v44, v45
    v_add_f32 v44, v44, v45
    v_fma_f32 v18, v44, v254, v14
    v_exp_f32 v19, v18
    v_mul_f32 v18, v18, v13
    v_add_f32 v19, 1.0, v19
    v_rcp_f32 v19, v19
    s_mov_b32 exec_lo, s44
    s_mov_b32 exec_hi, s44
    v_fma_f32 v18, v18, v19, v238
    v_cvt_pk_bf16_f32 v18, v18, v18
    s_barrier
    global_store_short v235, v18, s[32:33]
    s_cmp_lg_u32 s2, 8
    s_cbranch_scc1 L_fin_done
    s_mov_b64 exec, 1
    v_mov_b32 v2, 0
    v_mov_b32 v3, s41
    global_store_dword v2, v3, s[36:37]
L_fin_done:
    s_endpgm
L_pollB:
    v_mov_b32 v36, s56
    v_mov_b32 v37, s57
    v_mov_b32 v38, s58
    v_mov_b32 v39, s59
    global_load_dwordx4 v[20:23], v0, s[36:37] offset:-4096 sc1
    global_load_dwordx4 v[24:27], v0, s[36:37] offset:-2048 sc1
    global_load_dwordx4 v[28:31], v0, s[36:37] offset:0 sc1
    global_load_dwordx4 v[32:35], v0, s[36:37] offset:2048 sc1
    s_mov_b32 exec_hi, 0
    global_load_dwordx4 v[36:39], v239, s[36:37] sc1
    s_mov_b32 exec_hi, -1
    s_add_u32 s45, s45, 1
    s_waitcnt vmcnt(4)
    v_xor_b32 v20, s56, v20
    v_xor_b32 v21, s57, v21
    v_xor_b32 v22, s58, v22
    v_xor_b32 v23, s59, v23
    v_or3_b32 v17, 0, v20, v21
    v_or3_b32 v17, v17, v22, v23
    v_mfma_f32_16x16x32_bf16 v[44:47], v[20:23], v[8:11], 0
    s_waitcnt vmcnt(3)
    v_xor_b32 v24, s56, v24
    v_xor_b32 v25, s57, v25
    v_xor_b32 v26, s58, v26
    v_xor_b32 v27, s59, v27
    v_or3_b32 v17, v17, v24, v25
    v_or3_b32 v17, v17, v26, v27
    v_mfma_f32_16x16x32_bf16 v[44:47], v[24:27], v[8:11], v[44:47]
    s_waitcnt vmcnt(2)
    v_xor_b32 v28, s56, v28
    v_xor_b32 v29, s57, v29
    v_xor_b32 v30, s58, v30
    v_xor_b32 v31, s59, v31
    v_or3_b32 v17, v17, v28, v29
    v_or3_b32 v17, v17, v30, v31
    v_mfma_f32_16x16x32_bf16 v[44:47], v[28:31], v[8:11], v[44:47]
    s_waitcnt vmcnt(1)
    v_xor_b32 v32, s56, v32
    v_xor_b32 v33, s57, v33
    v_xor_b32 v34, s58, v34
    v_xor_b32 v35, s59, v35
    v_or3_b32 v17, v17, v32, v33
    v_or3_b32 v17, v17, v34, v35
    v_mfma_f32_16x16x32_bf16 v[44:47], v[32:35], v[8:11], v[44:47]
    s_waitcnt vmcnt(0)
    v_xor_b32 v36, s56, v36
    v_xor_b32 v37, s57, v37
    v_xor_b32 v38, s58, v38
    v_xor_b32 v39, s59, v39
    v_or3_b32 v17, v17, v36, v37
    v_or3_b32 v17, v17, v38, v39
    v_mfma_f32_16x16x32_bf16 v[44:47], v[36:39], v[8:11], v[44:47]
    v_and_b32 v17, 0x60006000, v17
    v_cmp_ne_u32 vcc, 0, v17
    s_mov_b64 exec, -1
    s_cbranch_vccz L_pollB_done
    s_cmp_lt_u32 s45, 65536
    s_cbranch_scc1 L_pollB
    s_branch L_pollB_done
L_pollH:
    s_mov_b32 s45, 0
L_pollH2:
    global_load_dwordx4 v[252:255], v251, s[36:37] sc1
    s_add_u32 s45, s45, 1
    s_waitcnt vmcnt(0)
    v_cmp_ne_u32 vcc, v232, v255
    s_cbranch_vccz L_pollH_done
    s_cmp_lt_u32 s45, 65536
    s_cbranch_scc1 L_pollH2
    s_branch L_pollH_done
L_codeend:
    s_endpgm
.section .rodata,"a"
.p2align 6
.amdhsa_kernel recurrent_scan__ssm_conv_s4__moe_arch_mod__prompt_kernel
  .amdhsa_next_free_vgpr 256
  .amdhsa_next_free_sgpr 96
  .amdhsa_accum_offset 256
  .amdhsa_group_segment_fixed_size 0
  .amdhsa_kernarg_size 136
  .amdhsa_user_sgpr_count 2
  .amdhsa_user_sgpr_kernarg_segment_ptr 1
  .amdhsa_system_sgpr_workgroup_id_x 1
.end_amdhsa_kernel
```
